```python
import torch

def _softmax(x, axis=-1):
    return torch.softmax(x, dim=axis)

def _gelu(x):
    return torch.nn.functional.gelu(x, approximate='tanh')

def _silu(x):
    return torch.nn.functional.silu(x)

def _sigmoid(x):
    return torch.sigmoid(x)

def _layernorm(x, axis=-1, eps=1e-05):
    m = x.mean(dim=axis, keepdim=True)
    v = x.var(dim=axis, keepdim=True, unbiased=False)
    return (x - m) / torch.sqrt(v + eps)

def _scatter_add(tgt, idx, src, axis=0):
    return tgt.clone().index_add_(axis, idx, src)

def _segment_sum(src, seg, n):
    out = torch.zeros((n,) + src.shape[1:], dtype=src.dtype)
    return out.index_add_(0, seg, src)

def _pad(x, pw):
    flat = tuple((v for pair in reversed(pw) for v in pair))
    return torch.nn.functional.pad(x, flat)
kernel_name = 'adaLN_cond__memory_aug_recurrent_mem_tr__mixer_channel_mlp__prompt'

def setup_inputs():

    _w = lambda a: (lambda t: t.to(torch.bfloat16) if t.is_floating_point() else t)(torch.as_tensor(a))

    def _A_setup():
        B, S, Dm = (1, 2048, 512)
        H, Dh = (32, 128)
        M, seg = (8, 32)
        seg = min(seg, S)
        S = S // seg * seg
        return {'x': _w((lambda *s: torch.randn(*s, dtype=torch.bfloat16) * 0.05)(B, S, Dm)), 'mem0': _w((lambda *s: torch.randn(*s, dtype=torch.bfloat16) * 0.4)(B, M, Dm)), 'Wq': _w((lambda *s: torch.randn(*s, dtype=torch.bfloat16) * 3.2)(Dm, H, Dh) * Dm ** (-0.5)), 'Wk': _w((lambda *s: torch.randn(*s, dtype=torch.bfloat16) * 3.2)(Dm, H, Dh) * Dm ** (-0.5)), 'Wv': _w((lambda *s: torch.randn(*s, dtype=torch.bfloat16) * 0.4)(Dm, H, Dh) * Dm ** (-0.5)), 'Wo': _w((lambda *s: torch.randn(*s, dtype=torch.bfloat16) * 0.4)(H, Dh, Dm) * (H * Dh) ** (-0.5)), 'seg_len': seg}
    _A_in = _A_setup()

    def _B_setup():
        B, S, D, F = (1, 2048, 512, 1792)
        return {'x': _w((lambda *s: torch.randn(*s, dtype=torch.bfloat16) * 0.05)(B, S, D)), 'w1': _w((lambda *s: torch.randn(*s, dtype=torch.bfloat16) * 3.2)(D, F) * D ** (-0.5)), 'b1': _w((lambda *s: torch.randn(*s, dtype=torch.bfloat16) * 0.1)(F)), 'w2': _w((lambda *s: torch.randn(*s, dtype=torch.bfloat16) * 0.1)(F, D) * F ** (-0.5)), 'b2': _w((lambda *s: torch.randn(*s, dtype=torch.bfloat16) * 0.1)(D))}
    _B_in = _B_setup()
    return {'A_x': _A_in['x'], 'A_mem0': _A_in['mem0'], 'A_Wq': _A_in['Wq'], 'A_Wk': _A_in['Wk'], 'A_Wv': _A_in['Wv'], 'A_Wo': _A_in['Wo'], 'A_seg_len': _A_in['seg_len'], 'B_x': _B_in['x'], 'B_w1': _B_in['w1'], 'B_b1': _B_in['b1'], 'B_w2': _B_in['w2'], 'B_b2': _B_in['b2'], 'c': _w((lambda *s: torch.randn(*s, dtype=torch.bfloat16) * 0.05)(1, 512) * 8.0), 'w_mod': _w((lambda *s: torch.randn(*s, dtype=torch.bfloat16) * 0.05)(512, 6 * 512) * 512 ** (-0.5) * 8.0)}

def reference(A_x, A_mem0, A_Wq, A_Wk, A_Wv, A_Wo, A_seg_len, B_x, B_w1, B_b1, B_w2, B_b2, c, w_mod):

    def _A_ref(x, mem0, Wq, Wk, Wv, Wo, seg_len):
        B, S, Dm = x.shape
        H, Dh = (Wq.shape[1], Wq.shape[2])
        M = mem0.shape[1]
        scale = Dh ** (-0.5)
        n_seg = S // seg_len
        L = M + seg_len
        idx = torch.arange(L)
        mask = (idx[:, None] < M) | (idx[:, None] >= idx[None, :])
        mem = mem0
        outs = []
        for s in range(n_seg):
            xs = x[:, s * seg_len:(s + 1) * seg_len, :].clone()
            h = torch.concatenate([mem, xs], axis=1)
            q = torch.einsum('btd,dhe->bhte', h, Wq)
            k = torch.einsum('btd,dhe->bhte', h, Wk)
            v = torch.einsum('btd,dhe->bhte', h, Wv)
            scores = torch.einsum('bhqe,bhke->bhqk', q, k) * scale
            scores = torch.where(mask[None, None], scores, -1000000000.0)
            p = _softmax(scores, axis=-1)
            o = torch.einsum('bhqk,bhke->bhqe', p, v)
            o = torch.einsum('bhte,hed->btd', o, Wo)
            mem = o[:, :M, :].clone()
            outs.append(o[:, M:, :])
        return torch.concatenate(outs, axis=1)

    def _B_ref(x, w1, b1, w2, b2):
        y = _layernorm(x, axis=-1)
        h = _gelu(torch.einsum('bsd,df->bsf', y, w1) + b1)
        return torch.einsum('bsf,fd->bsd', h, w2) + b2
    x = A_x
    mod = (_silu(c) @ w_mod).reshape(c.shape[0], 6, 1, -1)
    sa, ca, ga, sb, cb, gb = (mod[:, 0].clone(), mod[:, 1].clone(), mod[:, 2].clone(), mod[:, 3].clone(), mod[:, 4].clone(), mod[:, 5].clone())
    h = _layernorm(x, axis=-1) * (1 + ca) + sa
    x = x + ga * _A_ref(h, A_mem0, A_Wq, A_Wk, A_Wv, A_Wo, A_seg_len)
    h = _layernorm(x, axis=-1) * (1 + cb) + sb
    x = x + gb * _B_ref(h, B_w1, B_b1, B_w2, B_b2)
    return x
```

```asm
; @launch kernel=prep_kernel grid=(1304,1,1) block=(256,1,1) lds=16384
; @launch kernel=ln1_kernel grid=(128,1,1) block=(256,1,1) lds=16384
; @launch kernel=main_kernel grid=(256,1,1) block=(256,1,1) lds=156672
; @launch kernel=oproj_kernel grid=(256,1,1) block=(256,1,1) lds=65536
; @launch kernel=ln2_kernel grid=(128,1,1) block=(256,1,1) lds=16384
; @launch kernel=mlp1_kernel grid=(224,1,1) block=(256,1,1) lds=131072
; @launch kernel=mlp2_kernel grid=(256,1,1) block=(256,1,1) lds=65536
.amdgcn_target "amdgcn-amd-amdhsa--gfx950"
.text
.globl prep_kernel
.p2align 8
.type prep_kernel,@function
prep_kernel:
    s_load_dwordx2 s[4:5], s[0:1], 128
    s_cmp_ge_u32 s2, 1304
    s_cbranch_scc1 prep_end
    v_lshrrev_b32 v1, 6, v0
    v_and_b32 v2, 63, v0
    s_nop 0
    v_readfirstlane_b32 s3, v1
    s_cmp_ge_u32 s2, 24
    s_cbranch_scc1 prep_not_mod
    s_load_dwordx2 s[6:7], s[0:1], 96
    s_load_dwordx2 s[8:9], s[0:1], 104
    s_waitcnt lgkmcnt(0)
    s_mov_b32 s12, s6
    s_mov_b32 s13, s7
    s_and_b32 s13, s13, 0xffff
    s_mov_b32 s14, 1024
    s_mov_b32 s15, 0x00020000
    s_mov_b32 s16, s8
    s_mov_b32 s17, s9
    s_and_b32 s17, s17, 0xffff
    s_mov_b32 s18, 3145728
    s_mov_b32 s19, 0x00020000
    s_mov_b32 s20, s4
    s_mov_b32 s21, s5
    s_and_b32 s21, s21, 0xffff
    s_mov_b32 s22, 12288
    s_mov_b32 s23, 0x00020000
    s_lshl_b32 s24, s3, 8
    v_lshlrev_b32 v3, 1, v2
    buffer_load_ushort v4, v3, s[12:15], s24 offen
    buffer_load_ushort v5, v3, s[12:15], s24 offen offset:128
    s_waitcnt vmcnt(0)
    v_lshlrev_b32 v4, 16, v4
    v_mul_f32 v6, 0xbfb8aa3b, v4
    v_exp_f32 v6, v6
    s_nop 0
    v_add_f32 v6, 1.0, v6
    v_rcp_f32 v6, v6
    s_nop 0
    v_mul_f32 v4, v4, v6
    v_cvt_pk_bf16_f32 v6, v4, v4
    v_lshlrev_b32 v4, 16, v6
    v_lshlrev_b32 v5, 16, v5
    v_mul_f32 v6, 0xbfb8aa3b, v5
    v_exp_f32 v6, v6
    s_nop 0
    v_add_f32 v6, 1.0, v6
    v_rcp_f32 v6, v6
    s_nop 0
    v_mul_f32 v5, v5, v6
    v_cvt_pk_bf16_f32 v6, v5, v5
    v_lshlrev_b32 v5, 16, v6
    s_lshl_b32 s25, s2, 8
    v_lshl_add_u32 v3, v2, 2, s25
    s_mul_i32 s26, s3, 786432
    v_mov_b32 v10, 0
    v_mov_b32 v11, 0
    buffer_load_dword v16, v3, s[16:19], s26 offen
    s_add_u32 s26, s26, 6144
    buffer_load_dword v17, v3, s[16:19], s26 offen
    s_add_u32 s26, s26, 6144
    buffer_load_dword v18, v3, s[16:19], s26 offen
    s_add_u32 s26, s26, 6144
    buffer_load_dword v19, v3, s[16:19], s26 offen
    s_add_u32 s26, s26, 6144
    buffer_load_dword v20, v3, s[16:19], s26 offen
    s_add_u32 s26, s26, 6144
    buffer_load_dword v21, v3, s[16:19], s26 offen
    s_add_u32 s26, s26, 6144
    buffer_load_dword v22, v3, s[16:19], s26 offen
    s_add_u32 s26, s26, 6144
    buffer_load_dword v23, v3, s[16:19], s26 offen
    s_add_u32 s26, s26, 6144
    buffer_load_dword v24, v3, s[16:19], s26 offen
    s_add_u32 s26, s26, 6144
    buffer_load_dword v25, v3, s[16:19], s26 offen
    s_add_u32 s26, s26, 6144
    buffer_load_dword v26, v3, s[16:19], s26 offen
    s_add_u32 s26, s26, 6144
    buffer_load_dword v27, v3, s[16:19], s26 offen
    s_add_u32 s26, s26, 6144
    buffer_load_dword v28, v3, s[16:19], s26 offen
    s_add_u32 s26, s26, 6144
    buffer_load_dword v29, v3, s[16:19], s26 offen
    s_add_u32 s26, s26, 6144
    buffer_load_dword v30, v3, s[16:19], s26 offen
    s_add_u32 s26, s26, 6144
    buffer_load_dword v31, v3, s[16:19], s26 offen
    s_add_u32 s26, s26, 6144
    buffer_load_dword v32, v3, s[16:19], s26 offen
    s_add_u32 s26, s26, 6144
    buffer_load_dword v33, v3, s[16:19], s26 offen
    s_add_u32 s26, s26, 6144
    buffer_load_dword v34, v3, s[16:19], s26 offen
    s_add_u32 s26, s26, 6144
    buffer_load_dword v35, v3, s[16:19], s26 offen
    s_add_u32 s26, s26, 6144
    buffer_load_dword v36, v3, s[16:19], s26 offen
    s_add_u32 s26, s26, 6144
    buffer_load_dword v37, v3, s[16:19], s26 offen
    s_add_u32 s26, s26, 6144
    buffer_load_dword v38, v3, s[16:19], s26 offen
    s_add_u32 s26, s26, 6144
    buffer_load_dword v39, v3, s[16:19], s26 offen
    s_add_u32 s26, s26, 6144
    buffer_load_dword v40, v3, s[16:19], s26 offen
    s_add_u32 s26, s26, 6144
    buffer_load_dword v41, v3, s[16:19], s26 offen
    s_add_u32 s26, s26, 6144
    buffer_load_dword v42, v3, s[16:19], s26 offen
    s_add_u32 s26, s26, 6144
    buffer_load_dword v43, v3, s[16:19], s26 offen
    s_add_u32 s26, s26, 6144
    buffer_load_dword v44, v3, s[16:19], s26 offen
    s_add_u32 s26, s26, 6144
    buffer_load_dword v45, v3, s[16:19], s26 offen
    s_add_u32 s26, s26, 6144
    buffer_load_dword v46, v3, s[16:19], s26 offen
    s_add_u32 s26, s26, 6144
    buffer_load_dword v47, v3, s[16:19], s26 offen
    s_add_u32 s26, s26, 6144
    buffer_load_dword v48, v3, s[16:19], s26 offen
    s_add_u32 s26, s26, 6144
    buffer_load_dword v49, v3, s[16:19], s26 offen
    s_add_u32 s26, s26, 6144
    buffer_load_dword v50, v3, s[16:19], s26 offen
    s_add_u32 s26, s26, 6144
    buffer_load_dword v51, v3, s[16:19], s26 offen
    s_add_u32 s26, s26, 6144
    buffer_load_dword v52, v3, s[16:19], s26 offen
    s_add_u32 s26, s26, 6144
    buffer_load_dword v53, v3, s[16:19], s26 offen
    s_add_u32 s26, s26, 6144
    buffer_load_dword v54, v3, s[16:19], s26 offen
    s_add_u32 s26, s26, 6144
    buffer_load_dword v55, v3, s[16:19], s26 offen
    s_add_u32 s26, s26, 6144
    buffer_load_dword v56, v3, s[16:19], s26 offen
    s_add_u32 s26, s26, 6144
    buffer_load_dword v57, v3, s[16:19], s26 offen
    s_add_u32 s26, s26, 6144
    buffer_load_dword v58, v3, s[16:19], s26 offen
    s_add_u32 s26, s26, 6144
    buffer_load_dword v59, v3, s[16:19], s26 offen
    s_add_u32 s26, s26, 6144
    buffer_load_dword v60, v3, s[16:19], s26 offen
    s_add_u32 s26, s26, 6144
    buffer_load_dword v61, v3, s[16:19], s26 offen
    s_add_u32 s26, s26, 6144
    buffer_load_dword v62, v3, s[16:19], s26 offen
    s_add_u32 s26, s26, 6144
    buffer_load_dword v63, v3, s[16:19], s26 offen
    s_add_u32 s26, s26, 6144
    buffer_load_dword v64, v3, s[16:19], s26 offen
    s_add_u32 s26, s26, 6144
    buffer_load_dword v65, v3, s[16:19], s26 offen
    s_add_u32 s26, s26, 6144
    buffer_load_dword v66, v3, s[16:19], s26 offen
    s_add_u32 s26, s26, 6144
    buffer_load_dword v67, v3, s[16:19], s26 offen
    s_add_u32 s26, s26, 6144
    buffer_load_dword v68, v3, s[16:19], s26 offen
    s_add_u32 s26, s26, 6144
    buffer_load_dword v69, v3, s[16:19], s26 offen
    s_add_u32 s26, s26, 6144
    buffer_load_dword v70, v3, s[16:19], s26 offen
    s_add_u32 s26, s26, 6144
    buffer_load_dword v71, v3, s[16:19], s26 offen
    s_add_u32 s26, s26, 6144
    buffer_load_dword v72, v3, s[16:19], s26 offen
    s_add_u32 s26, s26, 6144
    buffer_load_dword v73, v3, s[16:19], s26 offen
    s_add_u32 s26, s26, 6144
    buffer_load_dword v74, v3, s[16:19], s26 offen
    s_add_u32 s26, s26, 6144
    buffer_load_dword v75, v3, s[16:19], s26 offen
    s_add_u32 s26, s26, 6144
    buffer_load_dword v76, v3, s[16:19], s26 offen
    s_add_u32 s26, s26, 6144
    buffer_load_dword v77, v3, s[16:19], s26 offen
    s_add_u32 s26, s26, 6144
    buffer_load_dword v78, v3, s[16:19], s26 offen
    s_add_u32 s26, s26, 6144
    buffer_load_dword v79, v3, s[16:19], s26 offen
    s_add_u32 s26, s26, 6144
    buffer_load_dword v80, v3, s[16:19], s26 offen
    s_add_u32 s26, s26, 6144
    buffer_load_dword v81, v3, s[16:19], s26 offen
    s_add_u32 s26, s26, 6144
    buffer_load_dword v82, v3, s[16:19], s26 offen
    s_add_u32 s26, s26, 6144
    buffer_load_dword v83, v3, s[16:19], s26 offen
    s_add_u32 s26, s26, 6144
    buffer_load_dword v84, v3, s[16:19], s26 offen
    s_add_u32 s26, s26, 6144
    buffer_load_dword v85, v3, s[16:19], s26 offen
    s_add_u32 s26, s26, 6144
    buffer_load_dword v86, v3, s[16:19], s26 offen
    s_add_u32 s26, s26, 6144
    buffer_load_dword v87, v3, s[16:19], s26 offen
    s_add_u32 s26, s26, 6144
    buffer_load_dword v88, v3, s[16:19], s26 offen
    s_add_u32 s26, s26, 6144
    buffer_load_dword v89, v3, s[16:19], s26 offen
    s_add_u32 s26, s26, 6144
    buffer_load_dword v90, v3, s[16:19], s26 offen
    s_add_u32 s26, s26, 6144
    buffer_load_dword v91, v3, s[16:19], s26 offen
    s_add_u32 s26, s26, 6144
    buffer_load_dword v92, v3, s[16:19], s26 offen
    s_add_u32 s26, s26, 6144
    buffer_load_dword v93, v3, s[16:19], s26 offen
    s_add_u32 s26, s26, 6144
    buffer_load_dword v94, v3, s[16:19], s26 offen
    s_add_u32 s26, s26, 6144
    buffer_load_dword v95, v3, s[16:19], s26 offen
    s_add_u32 s26, s26, 6144
    buffer_load_dword v96, v3, s[16:19], s26 offen
    s_add_u32 s26, s26, 6144
    buffer_load_dword v97, v3, s[16:19], s26 offen
    s_add_u32 s26, s26, 6144
    buffer_load_dword v98, v3, s[16:19], s26 offen
    s_add_u32 s26, s26, 6144
    buffer_load_dword v99, v3, s[16:19], s26 offen
    s_add_u32 s26, s26, 6144
    buffer_load_dword v100, v3, s[16:19], s26 offen
    s_add_u32 s26, s26, 6144
    buffer_load_dword v101, v3, s[16:19], s26 offen
    s_add_u32 s26, s26, 6144
    buffer_load_dword v102, v3, s[16:19], s26 offen
    s_add_u32 s26, s26, 6144
    buffer_load_dword v103, v3, s[16:19], s26 offen
    s_add_u32 s26, s26, 6144
    buffer_load_dword v104, v3, s[16:19], s26 offen
    s_add_u32 s26, s26, 6144
    buffer_load_dword v105, v3, s[16:19], s26 offen
    s_add_u32 s26, s26, 6144
    buffer_load_dword v106, v3, s[16:19], s26 offen
    s_add_u32 s26, s26, 6144
    buffer_load_dword v107, v3, s[16:19], s26 offen
    s_add_u32 s26, s26, 6144
    buffer_load_dword v108, v3, s[16:19], s26 offen
    s_add_u32 s26, s26, 6144
    buffer_load_dword v109, v3, s[16:19], s26 offen
    s_add_u32 s26, s26, 6144
    buffer_load_dword v110, v3, s[16:19], s26 offen
    s_add_u32 s26, s26, 6144
    buffer_load_dword v111, v3, s[16:19], s26 offen
    s_add_u32 s26, s26, 6144
    buffer_load_dword v112, v3, s[16:19], s26 offen
    s_add_u32 s26, s26, 6144
    buffer_load_dword v113, v3, s[16:19], s26 offen
    s_add_u32 s26, s26, 6144
    buffer_load_dword v114, v3, s[16:19], s26 offen
    s_add_u32 s26, s26, 6144
    buffer_load_dword v115, v3, s[16:19], s26 offen
    s_add_u32 s26, s26, 6144
    buffer_load_dword v116, v3, s[16:19], s26 offen
    s_add_u32 s26, s26, 6144
    buffer_load_dword v117, v3, s[16:19], s26 offen
    s_add_u32 s26, s26, 6144
    buffer_load_dword v118, v3, s[16:19], s26 offen
    s_add_u32 s26, s26, 6144
    buffer_load_dword v119, v3, s[16:19], s26 offen
    s_add_u32 s26, s26, 6144
    buffer_load_dword v120, v3, s[16:19], s26 offen
    s_add_u32 s26, s26, 6144
    buffer_load_dword v121, v3, s[16:19], s26 offen
    s_add_u32 s26, s26, 6144
    buffer_load_dword v122, v3, s[16:19], s26 offen
    s_add_u32 s26, s26, 6144
    buffer_load_dword v123, v3, s[16:19], s26 offen
    s_add_u32 s26, s26, 6144
    buffer_load_dword v124, v3, s[16:19], s26 offen
    s_add_u32 s26, s26, 6144
    buffer_load_dword v125, v3, s[16:19], s26 offen
    s_add_u32 s26, s26, 6144
    buffer_load_dword v126, v3, s[16:19], s26 offen
    s_add_u32 s26, s26, 6144
    buffer_load_dword v127, v3, s[16:19], s26 offen
    s_add_u32 s26, s26, 6144
    buffer_load_dword v128, v3, s[16:19], s26 offen
    s_add_u32 s26, s26, 6144
    buffer_load_dword v129, v3, s[16:19], s26 offen
    s_add_u32 s26, s26, 6144
    buffer_load_dword v130, v3, s[16:19], s26 offen
    s_add_u32 s26, s26, 6144
    buffer_load_dword v131, v3, s[16:19], s26 offen
    s_add_u32 s26, s26, 6144
    buffer_load_dword v132, v3, s[16:19], s26 offen
    s_add_u32 s26, s26, 6144
    buffer_load_dword v133, v3, s[16:19], s26 offen
    s_add_u32 s26, s26, 6144
    buffer_load_dword v134, v3, s[16:19], s26 offen
    s_add_u32 s26, s26, 6144
    buffer_load_dword v135, v3, s[16:19], s26 offen
    s_add_u32 s26, s26, 6144
    buffer_load_dword v136, v3, s[16:19], s26 offen
    s_add_u32 s26, s26, 6144
    buffer_load_dword v137, v3, s[16:19], s26 offen
    s_add_u32 s26, s26, 6144
    buffer_load_dword v138, v3, s[16:19], s26 offen
    s_add_u32 s26, s26, 6144
    buffer_load_dword v139, v3, s[16:19], s26 offen
    s_add_u32 s26, s26, 6144
    buffer_load_dword v140, v3, s[16:19], s26 offen
    s_add_u32 s26, s26, 6144
    buffer_load_dword v141, v3, s[16:19], s26 offen
    s_add_u32 s26, s26, 6144
    buffer_load_dword v142, v3, s[16:19], s26 offen
    s_add_u32 s26, s26, 6144
    buffer_load_dword v143, v3, s[16:19], s26 offen
    s_add_u32 s26, s26, 6144
    v_readlane_b32 s32, v4, 0
    v_readlane_b32 s33, v4, 1
    v_readlane_b32 s34, v4, 2
    v_readlane_b32 s35, v4, 3
    v_readlane_b32 s36, v4, 4
    v_readlane_b32 s37, v4, 5
    v_readlane_b32 s38, v4, 6
    v_readlane_b32 s39, v4, 7
    v_readlane_b32 s40, v4, 8
    v_readlane_b32 s41, v4, 9
    v_readlane_b32 s42, v4, 10
    v_readlane_b32 s43, v4, 11
    v_readlane_b32 s44, v4, 12
    v_readlane_b32 s45, v4, 13
    v_readlane_b32 s46, v4, 14
    v_readlane_b32 s47, v4, 15
    s_waitcnt vmcnt(63)
    v_lshlrev_b32 v12, 16, v16
    v_and_b32 v13, 0xffff0000, v16
    v_fmac_f32 v10, s32, v12
    v_fmac_f32 v11, s32, v13
    v_lshlrev_b32 v12, 16, v17
    v_and_b32 v13, 0xffff0000, v17
    v_fmac_f32 v10, s33, v12
    v_fmac_f32 v11, s33, v13
    v_lshlrev_b32 v12, 16, v18
    v_and_b32 v13, 0xffff0000, v18
    v_fmac_f32 v10, s34, v12
    v_fmac_f32 v11, s34, v13
    v_lshlrev_b32 v12, 16, v19
    v_and_b32 v13, 0xffff0000, v19
    v_fmac_f32 v10, s35, v12
    v_fmac_f32 v11, s35, v13
    v_lshlrev_b32 v12, 16, v20
    v_and_b32 v13, 0xffff0000, v20
    v_fmac_f32 v10, s36, v12
    v_fmac_f32 v11, s36, v13
    v_lshlrev_b32 v12, 16, v21
    v_and_b32 v13, 0xffff0000, v21
    v_fmac_f32 v10, s37, v12
    v_fmac_f32 v11, s37, v13
    v_lshlrev_b32 v12, 16, v22
    v_and_b32 v13, 0xffff0000, v22
    v_fmac_f32 v10, s38, v12
    v_fmac_f32 v11, s38, v13
    v_lshlrev_b32 v12, 16, v23
    v_and_b32 v13, 0xffff0000, v23
    v_fmac_f32 v10, s39, v12
    v_fmac_f32 v11, s39, v13
    v_lshlrev_b32 v12, 16, v24
    v_and_b32 v13, 0xffff0000, v24
    v_fmac_f32 v10, s40, v12
    v_fmac_f32 v11, s40, v13
    v_lshlrev_b32 v12, 16, v25
    v_and_b32 v13, 0xffff0000, v25
    v_fmac_f32 v10, s41, v12
    v_fmac_f32 v11, s41, v13
    v_lshlrev_b32 v12, 16, v26
    v_and_b32 v13, 0xffff0000, v26
    v_fmac_f32 v10, s42, v12
    v_fmac_f32 v11, s42, v13
    v_lshlrev_b32 v12, 16, v27
    v_and_b32 v13, 0xffff0000, v27
    v_fmac_f32 v10, s43, v12
    v_fmac_f32 v11, s43, v13
    v_lshlrev_b32 v12, 16, v28
    v_and_b32 v13, 0xffff0000, v28
    v_fmac_f32 v10, s44, v12
    v_fmac_f32 v11, s44, v13
    v_lshlrev_b32 v12, 16, v29
    v_and_b32 v13, 0xffff0000, v29
    v_fmac_f32 v10, s45, v12
    v_fmac_f32 v11, s45, v13
    v_lshlrev_b32 v12, 16, v30
    v_and_b32 v13, 0xffff0000, v30
    v_fmac_f32 v10, s46, v12
    v_fmac_f32 v11, s46, v13
    v_lshlrev_b32 v12, 16, v31
    v_and_b32 v13, 0xffff0000, v31
    v_fmac_f32 v10, s47, v12
    v_fmac_f32 v11, s47, v13
    v_readlane_b32 s32, v4, 16
    v_readlane_b32 s33, v4, 17
    v_readlane_b32 s34, v4, 18
    v_readlane_b32 s35, v4, 19
    v_readlane_b32 s36, v4, 20
    v_readlane_b32 s37, v4, 21
    v_readlane_b32 s38, v4, 22
    v_readlane_b32 s39, v4, 23
    v_readlane_b32 s40, v4, 24
    v_readlane_b32 s41, v4, 25
    v_readlane_b32 s42, v4, 26
    v_readlane_b32 s43, v4, 27
    v_readlane_b32 s44, v4, 28
    v_readlane_b32 s45, v4, 29
    v_readlane_b32 s46, v4, 30
    v_readlane_b32 s47, v4, 31
    s_waitcnt vmcnt(63)
    v_lshlrev_b32 v12, 16, v32
    v_and_b32 v13, 0xffff0000, v32
    v_fmac_f32 v10, s32, v12
    v_fmac_f32 v11, s32, v13
    v_lshlrev_b32 v12, 16, v33
    v_and_b32 v13, 0xffff0000, v33
    v_fmac_f32 v10, s33, v12
    v_fmac_f32 v11, s33, v13
    v_lshlrev_b32 v12, 16, v34
    v_and_b32 v13, 0xffff0000, v34
    v_fmac_f32 v10, s34, v12
    v_fmac_f32 v11, s34, v13
    v_lshlrev_b32 v12, 16, v35
    v_and_b32 v13, 0xffff0000, v35
    v_fmac_f32 v10, s35, v12
    v_fmac_f32 v11, s35, v13
    v_lshlrev_b32 v12, 16, v36
    v_and_b32 v13, 0xffff0000, v36
    v_fmac_f32 v10, s36, v12
    v_fmac_f32 v11, s36, v13
    v_lshlrev_b32 v12, 16, v37
    v_and_b32 v13, 0xffff0000, v37
    v_fmac_f32 v10, s37, v12
    v_fmac_f32 v11, s37, v13
    v_lshlrev_b32 v12, 16, v38
    v_and_b32 v13, 0xffff0000, v38
    v_fmac_f32 v10, s38, v12
    v_fmac_f32 v11, s38, v13
    v_lshlrev_b32 v12, 16, v39
    v_and_b32 v13, 0xffff0000, v39
    v_fmac_f32 v10, s39, v12
    v_fmac_f32 v11, s39, v13
    v_lshlrev_b32 v12, 16, v40
    v_and_b32 v13, 0xffff0000, v40
    v_fmac_f32 v10, s40, v12
    v_fmac_f32 v11, s40, v13
    v_lshlrev_b32 v12, 16, v41
    v_and_b32 v13, 0xffff0000, v41
    v_fmac_f32 v10, s41, v12
    v_fmac_f32 v11, s41, v13
    v_lshlrev_b32 v12, 16, v42
    v_and_b32 v13, 0xffff0000, v42
    v_fmac_f32 v10, s42, v12
    v_fmac_f32 v11, s42, v13
    v_lshlrev_b32 v12, 16, v43
    v_and_b32 v13, 0xffff0000, v43
    v_fmac_f32 v10, s43, v12
    v_fmac_f32 v11, s43, v13
    v_lshlrev_b32 v12, 16, v44
    v_and_b32 v13, 0xffff0000, v44
    v_fmac_f32 v10, s44, v12
    v_fmac_f32 v11, s44, v13
    v_lshlrev_b32 v12, 16, v45
    v_and_b32 v13, 0xffff0000, v45
    v_fmac_f32 v10, s45, v12
    v_fmac_f32 v11, s45, v13
    v_lshlrev_b32 v12, 16, v46
    v_and_b32 v13, 0xffff0000, v46
    v_fmac_f32 v10, s46, v12
    v_fmac_f32 v11, s46, v13
    v_lshlrev_b32 v12, 16, v47
    v_and_b32 v13, 0xffff0000, v47
    v_fmac_f32 v10, s47, v12
    v_fmac_f32 v11, s47, v13
    v_readlane_b32 s32, v4, 32
    v_readlane_b32 s33, v4, 33
    v_readlane_b32 s34, v4, 34
    v_readlane_b32 s35, v4, 35
    v_readlane_b32 s36, v4, 36
    v_readlane_b32 s37, v4, 37
    v_readlane_b32 s38, v4, 38
    v_readlane_b32 s39, v4, 39
    v_readlane_b32 s40, v4, 40
    v_readlane_b32 s41, v4, 41
    v_readlane_b32 s42, v4, 42
    v_readlane_b32 s43, v4, 43
    v_readlane_b32 s44, v4, 44
    v_readlane_b32 s45, v4, 45
    v_readlane_b32 s46, v4, 46
    v_readlane_b32 s47, v4, 47
    s_waitcnt vmcnt(63)
    v_lshlrev_b32 v12, 16, v48
    v_and_b32 v13, 0xffff0000, v48
    v_fmac_f32 v10, s32, v12
    v_fmac_f32 v11, s32, v13
    v_lshlrev_b32 v12, 16, v49
    v_and_b32 v13, 0xffff0000, v49
    v_fmac_f32 v10, s33, v12
    v_fmac_f32 v11, s33, v13
    v_lshlrev_b32 v12, 16, v50
    v_and_b32 v13, 0xffff0000, v50
    v_fmac_f32 v10, s34, v12
    v_fmac_f32 v11, s34, v13
    v_lshlrev_b32 v12, 16, v51
    v_and_b32 v13, 0xffff0000, v51
    v_fmac_f32 v10, s35, v12
    v_fmac_f32 v11, s35, v13
    v_lshlrev_b32 v12, 16, v52
    v_and_b32 v13, 0xffff0000, v52
    v_fmac_f32 v10, s36, v12
    v_fmac_f32 v11, s36, v13
    v_lshlrev_b32 v12, 16, v53
    v_and_b32 v13, 0xffff0000, v53
    v_fmac_f32 v10, s37, v12
    v_fmac_f32 v11, s37, v13
    v_lshlrev_b32 v12, 16, v54
    v_and_b32 v13, 0xffff0000, v54
    v_fmac_f32 v10, s38, v12
    v_fmac_f32 v11, s38, v13
    v_lshlrev_b32 v12, 16, v55
    v_and_b32 v13, 0xffff0000, v55
    v_fmac_f32 v10, s39, v12
    v_fmac_f32 v11, s39, v13
    v_lshlrev_b32 v12, 16, v56
    v_and_b32 v13, 0xffff0000, v56
    v_fmac_f32 v10, s40, v12
    v_fmac_f32 v11, s40, v13
    v_lshlrev_b32 v12, 16, v57
    v_and_b32 v13, 0xffff0000, v57
    v_fmac_f32 v10, s41, v12
    v_fmac_f32 v11, s41, v13
    v_lshlrev_b32 v12, 16, v58
    v_and_b32 v13, 0xffff0000, v58
    v_fmac_f32 v10, s42, v12
    v_fmac_f32 v11, s42, v13
    v_lshlrev_b32 v12, 16, v59
    v_and_b32 v13, 0xffff0000, v59
    v_fmac_f32 v10, s43, v12
    v_fmac_f32 v11, s43, v13
    v_lshlrev_b32 v12, 16, v60
    v_and_b32 v13, 0xffff0000, v60
    v_fmac_f32 v10, s44, v12
    v_fmac_f32 v11, s44, v13
    v_lshlrev_b32 v12, 16, v61
    v_and_b32 v13, 0xffff0000, v61
    v_fmac_f32 v10, s45, v12
    v_fmac_f32 v11, s45, v13
    v_lshlrev_b32 v12, 16, v62
    v_and_b32 v13, 0xffff0000, v62
    v_fmac_f32 v10, s46, v12
    v_fmac_f32 v11, s46, v13
    v_lshlrev_b32 v12, 16, v63
    v_and_b32 v13, 0xffff0000, v63
    v_fmac_f32 v10, s47, v12
    v_fmac_f32 v11, s47, v13
    v_readlane_b32 s32, v4, 48
    v_readlane_b32 s33, v4, 49
    v_readlane_b32 s34, v4, 50
    v_readlane_b32 s35, v4, 51
    v_readlane_b32 s36, v4, 52
    v_readlane_b32 s37, v4, 53
    v_readlane_b32 s38, v4, 54
    v_readlane_b32 s39, v4, 55
    v_readlane_b32 s40, v4, 56
    v_readlane_b32 s41, v4, 57
    v_readlane_b32 s42, v4, 58
    v_readlane_b32 s43, v4, 59
    v_readlane_b32 s44, v4, 60
    v_readlane_b32 s45, v4, 61
    v_readlane_b32 s46, v4, 62
    v_readlane_b32 s47, v4, 63
    s_waitcnt vmcnt(63)
    v_lshlrev_b32 v12, 16, v64
    v_and_b32 v13, 0xffff0000, v64
    v_fmac_f32 v10, s32, v12
    v_fmac_f32 v11, s32, v13
    v_lshlrev_b32 v12, 16, v65
    v_and_b32 v13, 0xffff0000, v65
    v_fmac_f32 v10, s33, v12
    v_fmac_f32 v11, s33, v13
    v_lshlrev_b32 v12, 16, v66
    v_and_b32 v13, 0xffff0000, v66
    v_fmac_f32 v10, s34, v12
    v_fmac_f32 v11, s34, v13
    v_lshlrev_b32 v12, 16, v67
    v_and_b32 v13, 0xffff0000, v67
    v_fmac_f32 v10, s35, v12
    v_fmac_f32 v11, s35, v13
    v_lshlrev_b32 v12, 16, v68
    v_and_b32 v13, 0xffff0000, v68
    v_fmac_f32 v10, s36, v12
    v_fmac_f32 v11, s36, v13
    v_lshlrev_b32 v12, 16, v69
    v_and_b32 v13, 0xffff0000, v69
    v_fmac_f32 v10, s37, v12
    v_fmac_f32 v11, s37, v13
    v_lshlrev_b32 v12, 16, v70
    v_and_b32 v13, 0xffff0000, v70
    v_fmac_f32 v10, s38, v12
    v_fmac_f32 v11, s38, v13
    v_lshlrev_b32 v12, 16, v71
    v_and_b32 v13, 0xffff0000, v71
    v_fmac_f32 v10, s39, v12
    v_fmac_f32 v11, s39, v13
    v_lshlrev_b32 v12, 16, v72
    v_and_b32 v13, 0xffff0000, v72
    v_fmac_f32 v10, s40, v12
    v_fmac_f32 v11, s40, v13
    v_lshlrev_b32 v12, 16, v73
    v_and_b32 v13, 0xffff0000, v73
    v_fmac_f32 v10, s41, v12
    v_fmac_f32 v11, s41, v13
    v_lshlrev_b32 v12, 16, v74
    v_and_b32 v13, 0xffff0000, v74
    v_fmac_f32 v10, s42, v12
    v_fmac_f32 v11, s42, v13
    v_lshlrev_b32 v12, 16, v75
    v_and_b32 v13, 0xffff0000, v75
    v_fmac_f32 v10, s43, v12
    v_fmac_f32 v11, s43, v13
    v_lshlrev_b32 v12, 16, v76
    v_and_b32 v13, 0xffff0000, v76
    v_fmac_f32 v10, s44, v12
    v_fmac_f32 v11, s44, v13
    v_lshlrev_b32 v12, 16, v77
    v_and_b32 v13, 0xffff0000, v77
    v_fmac_f32 v10, s45, v12
    v_fmac_f32 v11, s45, v13
    v_lshlrev_b32 v12, 16, v78
    v_and_b32 v13, 0xffff0000, v78
    v_fmac_f32 v10, s46, v12
    v_fmac_f32 v11, s46, v13
    v_lshlrev_b32 v12, 16, v79
    v_and_b32 v13, 0xffff0000, v79
    v_fmac_f32 v10, s47, v12
    v_fmac_f32 v11, s47, v13
    v_readlane_b32 s32, v5, 0
    v_readlane_b32 s33, v5, 1
    v_readlane_b32 s34, v5, 2
    v_readlane_b32 s35, v5, 3
    v_readlane_b32 s36, v5, 4
    v_readlane_b32 s37, v5, 5
    v_readlane_b32 s38, v5, 6
    v_readlane_b32 s39, v5, 7
    v_readlane_b32 s40, v5, 8
    v_readlane_b32 s41, v5, 9
    v_readlane_b32 s42, v5, 10
    v_readlane_b32 s43, v5, 11
    v_readlane_b32 s44, v5, 12
    v_readlane_b32 s45, v5, 13
    v_readlane_b32 s46, v5, 14
    v_readlane_b32 s47, v5, 15
    s_waitcnt vmcnt(48)
    v_lshlrev_b32 v12, 16, v80
    v_and_b32 v13, 0xffff0000, v80
    v_fmac_f32 v10, s32, v12
    v_fmac_f32 v11, s32, v13
    v_lshlrev_b32 v12, 16, v81
    v_and_b32 v13, 0xffff0000, v81
    v_fmac_f32 v10, s33, v12
    v_fmac_f32 v11, s33, v13
    v_lshlrev_b32 v12, 16, v82
    v_and_b32 v13, 0xffff0000, v82
    v_fmac_f32 v10, s34, v12
    v_fmac_f32 v11, s34, v13
    v_lshlrev_b32 v12, 16, v83
    v_and_b32 v13, 0xffff0000, v83
    v_fmac_f32 v10, s35, v12
    v_fmac_f32 v11, s35, v13
    v_lshlrev_b32 v12, 16, v84
    v_and_b32 v13, 0xffff0000, v84
    v_fmac_f32 v10, s36, v12
    v_fmac_f32 v11, s36, v13
    v_lshlrev_b32 v12, 16, v85
    v_and_b32 v13, 0xffff0000, v85
    v_fmac_f32 v10, s37, v12
    v_fmac_f32 v11, s37, v13
    v_lshlrev_b32 v12, 16, v86
    v_and_b32 v13, 0xffff0000, v86
    v_fmac_f32 v10, s38, v12
    v_fmac_f32 v11, s38, v13
    v_lshlrev_b32 v12, 16, v87
    v_and_b32 v13, 0xffff0000, v87
    v_fmac_f32 v10, s39, v12
    v_fmac_f32 v11, s39, v13
    v_lshlrev_b32 v12, 16, v88
    v_and_b32 v13, 0xffff0000, v88
    v_fmac_f32 v10, s40, v12
    v_fmac_f32 v11, s40, v13
    v_lshlrev_b32 v12, 16, v89
    v_and_b32 v13, 0xffff0000, v89
    v_fmac_f32 v10, s41, v12
    v_fmac_f32 v11, s41, v13
    v_lshlrev_b32 v12, 16, v90
    v_and_b32 v13, 0xffff0000, v90
    v_fmac_f32 v10, s42, v12
    v_fmac_f32 v11, s42, v13
    v_lshlrev_b32 v12, 16, v91
    v_and_b32 v13, 0xffff0000, v91
    v_fmac_f32 v10, s43, v12
    v_fmac_f32 v11, s43, v13
    v_lshlrev_b32 v12, 16, v92
    v_and_b32 v13, 0xffff0000, v92
    v_fmac_f32 v10, s44, v12
    v_fmac_f32 v11, s44, v13
    v_lshlrev_b32 v12, 16, v93
    v_and_b32 v13, 0xffff0000, v93
    v_fmac_f32 v10, s45, v12
    v_fmac_f32 v11, s45, v13
    v_lshlrev_b32 v12, 16, v94
    v_and_b32 v13, 0xffff0000, v94
    v_fmac_f32 v10, s46, v12
    v_fmac_f32 v11, s46, v13
    v_lshlrev_b32 v12, 16, v95
    v_and_b32 v13, 0xffff0000, v95
    v_fmac_f32 v10, s47, v12
    v_fmac_f32 v11, s47, v13
    v_readlane_b32 s32, v5, 16
    v_readlane_b32 s33, v5, 17
    v_readlane_b32 s34, v5, 18
    v_readlane_b32 s35, v5, 19
    v_readlane_b32 s36, v5, 20
    v_readlane_b32 s37, v5, 21
    v_readlane_b32 s38, v5, 22
    v_readlane_b32 s39, v5, 23
    v_readlane_b32 s40, v5, 24
    v_readlane_b32 s41, v5, 25
    v_readlane_b32 s42, v5, 26
    v_readlane_b32 s43, v5, 27
    v_readlane_b32 s44, v5, 28
    v_readlane_b32 s45, v5, 29
    v_readlane_b32 s46, v5, 30
    v_readlane_b32 s47, v5, 31
    s_waitcnt vmcnt(32)
    v_lshlrev_b32 v12, 16, v96
    v_and_b32 v13, 0xffff0000, v96
    v_fmac_f32 v10, s32, v12
    v_fmac_f32 v11, s32, v13
    v_lshlrev_b32 v12, 16, v97
    v_and_b32 v13, 0xffff0000, v97
    v_fmac_f32 v10, s33, v12
    v_fmac_f32 v11, s33, v13
    v_lshlrev_b32 v12, 16, v98
    v_and_b32 v13, 0xffff0000, v98
    v_fmac_f32 v10, s34, v12
    v_fmac_f32 v11, s34, v13
    v_lshlrev_b32 v12, 16, v99
    v_and_b32 v13, 0xffff0000, v99
    v_fmac_f32 v10, s35, v12
    v_fmac_f32 v11, s35, v13
    v_lshlrev_b32 v12, 16, v100
    v_and_b32 v13, 0xffff0000, v100
    v_fmac_f32 v10, s36, v12
    v_fmac_f32 v11, s36, v13
    v_lshlrev_b32 v12, 16, v101
    v_and_b32 v13, 0xffff0000, v101
    v_fmac_f32 v10, s37, v12
    v_fmac_f32 v11, s37, v13
    v_lshlrev_b32 v12, 16, v102
    v_and_b32 v13, 0xffff0000, v102
    v_fmac_f32 v10, s38, v12
    v_fmac_f32 v11, s38, v13
    v_lshlrev_b32 v12, 16, v103
    v_and_b32 v13, 0xffff0000, v103
    v_fmac_f32 v10, s39, v12
    v_fmac_f32 v11, s39, v13
    v_lshlrev_b32 v12, 16, v104
    v_and_b32 v13, 0xffff0000, v104
    v_fmac_f32 v10, s40, v12
    v_fmac_f32 v11, s40, v13
    v_lshlrev_b32 v12, 16, v105
    v_and_b32 v13, 0xffff0000, v105
    v_fmac_f32 v10, s41, v12
    v_fmac_f32 v11, s41, v13
    v_lshlrev_b32 v12, 16, v106
    v_and_b32 v13, 0xffff0000, v106
    v_fmac_f32 v10, s42, v12
    v_fmac_f32 v11, s42, v13
    v_lshlrev_b32 v12, 16, v107
    v_and_b32 v13, 0xffff0000, v107
    v_fmac_f32 v10, s43, v12
    v_fmac_f32 v11, s43, v13
    v_lshlrev_b32 v12, 16, v108
    v_and_b32 v13, 0xffff0000, v108
    v_fmac_f32 v10, s44, v12
    v_fmac_f32 v11, s44, v13
    v_lshlrev_b32 v12, 16, v109
    v_and_b32 v13, 0xffff0000, v109
    v_fmac_f32 v10, s45, v12
    v_fmac_f32 v11, s45, v13
    v_lshlrev_b32 v12, 16, v110
    v_and_b32 v13, 0xffff0000, v110
    v_fmac_f32 v10, s46, v12
    v_fmac_f32 v11, s46, v13
    v_lshlrev_b32 v12, 16, v111
    v_and_b32 v13, 0xffff0000, v111
    v_fmac_f32 v10, s47, v12
    v_fmac_f32 v11, s47, v13
    v_readlane_b32 s32, v5, 32
    v_readlane_b32 s33, v5, 33
    v_readlane_b32 s34, v5, 34
    v_readlane_b32 s35, v5, 35
    v_readlane_b32 s36, v5, 36
    v_readlane_b32 s37, v5, 37
    v_readlane_b32 s38, v5, 38
    v_readlane_b32 s39, v5, 39
    v_readlane_b32 s40, v5, 40
    v_readlane_b32 s41, v5, 41
    v_readlane_b32 s42, v5, 42
    v_readlane_b32 s43, v5, 43
    v_readlane_b32 s44, v5, 44
    v_readlane_b32 s45, v5, 45
    v_readlane_b32 s46, v5, 46
    v_readlane_b32 s47, v5, 47
    s_waitcnt vmcnt(16)
    v_lshlrev_b32 v12, 16, v112
    v_and_b32 v13, 0xffff0000, v112
    v_fmac_f32 v10, s32, v12
    v_fmac_f32 v11, s32, v13
    v_lshlrev_b32 v12, 16, v113
    v_and_b32 v13, 0xffff0000, v113
    v_fmac_f32 v10, s33, v12
    v_fmac_f32 v11, s33, v13
    v_lshlrev_b32 v12, 16, v114
    v_and_b32 v13, 0xffff0000, v114
    v_fmac_f32 v10, s34, v12
    v_fmac_f32 v11, s34, v13
    v_lshlrev_b32 v12, 16, v115
    v_and_b32 v13, 0xffff0000, v115
    v_fmac_f32 v10, s35, v12
    v_fmac_f32 v11, s35, v13
    v_lshlrev_b32 v12, 16, v116
    v_and_b32 v13, 0xffff0000, v116
    v_fmac_f32 v10, s36, v12
    v_fmac_f32 v11, s36, v13
    v_lshlrev_b32 v12, 16, v117
    v_and_b32 v13, 0xffff0000, v117
    v_fmac_f32 v10, s37, v12
    v_fmac_f32 v11, s37, v13
    v_lshlrev_b32 v12, 16, v118
    v_and_b32 v13, 0xffff0000, v118
    v_fmac_f32 v10, s38, v12
    v_fmac_f32 v11, s38, v13
    v_lshlrev_b32 v12, 16, v119
    v_and_b32 v13, 0xffff0000, v119
    v_fmac_f32 v10, s39, v12
    v_fmac_f32 v11, s39, v13
    v_lshlrev_b32 v12, 16, v120
    v_and_b32 v13, 0xffff0000, v120
    v_fmac_f32 v10, s40, v12
    v_fmac_f32 v11, s40, v13
    v_lshlrev_b32 v12, 16, v121
    v_and_b32 v13, 0xffff0000, v121
    v_fmac_f32 v10, s41, v12
    v_fmac_f32 v11, s41, v13
    v_lshlrev_b32 v12, 16, v122
    v_and_b32 v13, 0xffff0000, v122
    v_fmac_f32 v10, s42, v12
    v_fmac_f32 v11, s42, v13
    v_lshlrev_b32 v12, 16, v123
    v_and_b32 v13, 0xffff0000, v123
    v_fmac_f32 v10, s43, v12
    v_fmac_f32 v11, s43, v13
    v_lshlrev_b32 v12, 16, v124
    v_and_b32 v13, 0xffff0000, v124
    v_fmac_f32 v10, s44, v12
    v_fmac_f32 v11, s44, v13
    v_lshlrev_b32 v12, 16, v125
    v_and_b32 v13, 0xffff0000, v125
    v_fmac_f32 v10, s45, v12
    v_fmac_f32 v11, s45, v13
    v_lshlrev_b32 v12, 16, v126
    v_and_b32 v13, 0xffff0000, v126
    v_fmac_f32 v10, s46, v12
    v_fmac_f32 v11, s46, v13
    v_lshlrev_b32 v12, 16, v127
    v_and_b32 v13, 0xffff0000, v127
    v_fmac_f32 v10, s47, v12
    v_fmac_f32 v11, s47, v13
    v_readlane_b32 s32, v5, 48
    v_readlane_b32 s33, v5, 49
    v_readlane_b32 s34, v5, 50
    v_readlane_b32 s35, v5, 51
    v_readlane_b32 s36, v5, 52
    v_readlane_b32 s37, v5, 53
    v_readlane_b32 s38, v5, 54
    v_readlane_b32 s39, v5, 55
    v_readlane_b32 s40, v5, 56
    v_readlane_b32 s41, v5, 57
    v_readlane_b32 s42, v5, 58
    v_readlane_b32 s43, v5, 59
    v_readlane_b32 s44, v5, 60
    v_readlane_b32 s45, v5, 61
    v_readlane_b32 s46, v5, 62
    v_readlane_b32 s47, v5, 63
    s_waitcnt vmcnt(0)
    v_lshlrev_b32 v12, 16, v128
    v_and_b32 v13, 0xffff0000, v128
    v_fmac_f32 v10, s32, v12
    v_fmac_f32 v11, s32, v13
    v_lshlrev_b32 v12, 16, v129
    v_and_b32 v13, 0xffff0000, v129
    v_fmac_f32 v10, s33, v12
    v_fmac_f32 v11, s33, v13
    v_lshlrev_b32 v12, 16, v130
    v_and_b32 v13, 0xffff0000, v130
    v_fmac_f32 v10, s34, v12
    v_fmac_f32 v11, s34, v13
    v_lshlrev_b32 v12, 16, v131
    v_and_b32 v13, 0xffff0000, v131
    v_fmac_f32 v10, s35, v12
    v_fmac_f32 v11, s35, v13
    v_lshlrev_b32 v12, 16, v132
    v_and_b32 v13, 0xffff0000, v132
    v_fmac_f32 v10, s36, v12
    v_fmac_f32 v11, s36, v13
    v_lshlrev_b32 v12, 16, v133
    v_and_b32 v13, 0xffff0000, v133
    v_fmac_f32 v10, s37, v12
    v_fmac_f32 v11, s37, v13
    v_lshlrev_b32 v12, 16, v134
    v_and_b32 v13, 0xffff0000, v134
    v_fmac_f32 v10, s38, v12
    v_fmac_f32 v11, s38, v13
    v_lshlrev_b32 v12, 16, v135
    v_and_b32 v13, 0xffff0000, v135
    v_fmac_f32 v10, s39, v12
    v_fmac_f32 v11, s39, v13
    v_lshlrev_b32 v12, 16, v136
    v_and_b32 v13, 0xffff0000, v136
    v_fmac_f32 v10, s40, v12
    v_fmac_f32 v11, s40, v13
    v_lshlrev_b32 v12, 16, v137
    v_and_b32 v13, 0xffff0000, v137
    v_fmac_f32 v10, s41, v12
    v_fmac_f32 v11, s41, v13
    v_lshlrev_b32 v12, 16, v138
    v_and_b32 v13, 0xffff0000, v138
    v_fmac_f32 v10, s42, v12
    v_fmac_f32 v11, s42, v13
    v_lshlrev_b32 v12, 16, v139
    v_and_b32 v13, 0xffff0000, v139
    v_fmac_f32 v10, s43, v12
    v_fmac_f32 v11, s43, v13
    v_lshlrev_b32 v12, 16, v140
    v_and_b32 v13, 0xffff0000, v140
    v_fmac_f32 v10, s44, v12
    v_fmac_f32 v11, s44, v13
    v_lshlrev_b32 v12, 16, v141
    v_and_b32 v13, 0xffff0000, v141
    v_fmac_f32 v10, s45, v12
    v_fmac_f32 v11, s45, v13
    v_lshlrev_b32 v12, 16, v142
    v_and_b32 v13, 0xffff0000, v142
    v_fmac_f32 v10, s46, v12
    v_fmac_f32 v11, s46, v13
    v_lshlrev_b32 v12, 16, v143
    v_and_b32 v13, 0xffff0000, v143
    v_fmac_f32 v10, s47, v12
    v_fmac_f32 v11, s47, v13
    v_lshlrev_b32 v12, 3, v0
    ds_write_b64 v12, v[10:11]
    s_waitcnt lgkmcnt(0)
    s_barrier
    s_cmp_lg_u32 s3, 0
    s_cbranch_scc1 prep_end
    ds_read_b64 v[16:17], v12 offset:512
    ds_read_b64 v[18:19], v12 offset:1024
    ds_read_b64 v[20:21], v12 offset:1536
    s_waitcnt lgkmcnt(0)
    v_add_f32 v10, v10, v16
    v_add_f32 v11, v11, v17
    v_add_f32 v10, v10, v18
    v_add_f32 v11, v11, v19
    v_add_f32 v10, v10, v20
    v_add_f32 v11, v11, v21
    v_cvt_pk_bf16_f32 v12, v10, v11
    v_lshlrev_b32 v10, 16, v12
    v_and_b32 v11, 0xffff0000, v12
    v_lshlrev_b32 v3, 1, v3
    buffer_store_dwordx2 v[10:11], v3, s[20:23], 0 offen
    s_branch prep_end
prep_not_mod:
    s_cmp_ge_u32 s2, 56
    s_cbranch_scc1 prep_repack
    s_load_dwordx2 s[6:7], s[0:1], 8
    s_waitcnt lgkmcnt(0)
    s_add_u32 s12, s4, 125829120
    s_addc_u32 s13, s5, 0
    s_and_b32 s13, s13, 0xffff
    s_mov_b32 s14, 532480
    s_mov_b32 s15, 0x00020000
    s_add_u32 s16, s4, 126877696
    s_addc_u32 s17, s5, 0
    s_and_b32 s17, s17, 0xffff
    s_mov_b32 s18, 1048576
    s_mov_b32 s19, 0x00020000
    s_mov_b32 s20, s6
    s_mov_b32 s21, s7
    s_and_b32 s21, s21, 0xffff
    s_mov_b32 s22, 8192
    s_mov_b32 s23, 0x00020000
    s_sub_u32 s24, s2, 24
    v_mov_b32 v4, -1
    v_mov_b32 v5, -1
    v_mov_b32 v6, -1
    v_mov_b32 v7, -1
    s_lshl_b32 s25, s24, 14
    s_add_u32 s25, s25, 8192
    v_lshlrev_b32 v3, 4, v0
    buffer_store_dwordx4 v[4:7], v3, s[12:15], s25 offen
    s_add_u32 s25, s25, 4096
    buffer_store_dwordx4 v[4:7], v3, s[12:15], s25 offen
    s_add_u32 s25, s25, 4096
    buffer_store_dwordx4 v[4:7], v3, s[12:15], s25 offen
    s_add_u32 s25, s25, 4096
    buffer_store_dwordx4 v[4:7], v3, s[12:15], s25 offen
    s_add_u32 s25, s25, 4096
    s_mul_i32 s25, s24, 32768
    buffer_store_dwordx4 v[4:7], v3, s[16:19], s25 offen
    s_add_u32 s25, s25, 4096
    buffer_store_dwordx4 v[4:7], v3, s[16:19], s25 offen
    s_add_u32 s25, s25, 4096
    buffer_store_dwordx4 v[4:7], v3, s[16:19], s25 offen
    s_add_u32 s25, s25, 4096
    buffer_store_dwordx4 v[4:7], v3, s[16:19], s25 offen
    s_add_u32 s25, s25, 4096
    buffer_store_dwordx4 v[4:7], v3, s[16:19], s25 offen
    s_add_u32 s25, s25, 4096
    buffer_store_dwordx4 v[4:7], v3, s[16:19], s25 offen
    s_add_u32 s25, s25, 4096
    buffer_store_dwordx4 v[4:7], v3, s[16:19], s25 offen
    s_add_u32 s25, s25, 4096
    buffer_store_dwordx4 v[4:7], v3, s[16:19], s25 offen
    s_add_u32 s25, s25, 4096
    s_cmp_lg_u32 s24, 2
    s_cbranch_scc1 prep_nosync
    s_add_u32 s28, s4, 126615552
    s_addc_u32 s29, s5, 0
    s_and_b32 s29, s29, 0xffff
    s_mov_b32 s30, 1024
    s_mov_b32 s31, 0x00020000
    v_mov_b32 v8, 0
    v_lshlrev_b32 v9, 2, v0
    buffer_store_dword v8, v9, s[28:31], 0 offen
prep_nosync:
    s_cmp_ge_u32 s24, 2
    s_cbranch_scc1 prep_end
    s_lshl_b32 s25, s24, 12
    buffer_load_dwordx4 v[8:11], v3, s[20:23], s25 offen
    s_lshl_b32 s26, s24, 8
    v_add_u32 v12, s26, v0
    v_lshrrev_b32 v13, 6, v12
    v_bfe_u32 v14, v12, 1, 5
    v_and_b32 v15, 1, v12
    v_lshlrev_b32 v14, 8, v14
    v_lshl_add_u32 v14, v13, 5, v14
    v_lshl_add_u32 v14, v15, 4, v14
    s_waitcnt vmcnt(0)
    buffer_store_dwordx4 v[8:11], v14, s[12:15], 0 offen
    s_branch prep_end
prep_repack:
    s_sub_u32 s24, s2, 56
    s_cmp_ge_u32 s24, 256
    s_cbranch_scc1 prep_rp_1
    s_load_dwordx2 s[6:7], s[0:1], 16
    s_sub_u32 s25, s24, 0
    s_lshl_b32 s25, s25, 2
    s_add_u32 s25, s25, s3
    s_lshr_b32 s26, s25, 6
    s_and_b32 s27, s25, 63
    s_waitcnt lgkmcnt(0)
    s_mov_b32 s12, s6
    s_mov_b32 s13, s7
    s_and_b32 s13, s13, 0xffff
    s_mov_b32 s14, 4194304
    s_mov_b32 s15, 0x00020000
    s_mul_i32 s28, s26, 262144
    s_lshl_b32 s29, s27, 7
    s_add_u32 s28, s28, s29
    s_mov_b32 s30, 65536
    s_mov_b32 s31, 8192
    s_mul_i32 s32, s27, 65536
    s_mul_i32 s33, s26, 1024
    s_add_u32 s32, s32, s33
    s_add_u32 s32, s32, 4194304
    s_mov_b32 s33, 16384
    s_mov_b32 s34, 0
    s_branch prep_rp_go
prep_rp_1:
    s_cmp_ge_u32 s24, 512
    s_cbranch_scc1 prep_rp_2
    s_load_dwordx2 s[6:7], s[0:1], 24
    s_sub_u32 s25, s24, 256
    s_lshl_b32 s25, s25, 2
    s_add_u32 s25, s25, s3
    s_lshr_b32 s26, s25, 6
    s_and_b32 s27, s25, 63
    s_waitcnt lgkmcnt(0)
    s_mov_b32 s12, s6
    s_mov_b32 s13, s7
    s_and_b32 s13, s13, 0xffff
    s_mov_b32 s14, 4194304
    s_mov_b32 s15, 0x00020000
    s_mul_i32 s28, s26, 262144
    s_lshl_b32 s29, s27, 7
    s_add_u32 s28, s28, s29
    s_mov_b32 s30, 65536
    s_mov_b32 s31, 8192
    s_mul_i32 s32, s27, 65536
    s_mul_i32 s33, s26, 1024
    s_add_u32 s32, s32, s33
    s_add_u32 s32, s32, 8388608
    s_mov_b32 s33, 16384
    s_mov_b32 s34, 0
    s_branch prep_rp_go
prep_rp_2:
    s_cmp_ge_u32 s24, 768
    s_cbranch_scc1 prep_rp_3
    s_load_dwordx2 s[6:7], s[0:1], 32
    s_sub_u32 s25, s24, 512
    s_lshl_b32 s25, s25, 2
    s_add_u32 s25, s25, s3
    s_lshr_b32 s26, s25, 6
    s_and_b32 s27, s25, 63
    s_waitcnt lgkmcnt(0)
    s_mov_b32 s12, s6
    s_mov_b32 s13, s7
    s_and_b32 s13, s13, 0xffff
    s_mov_b32 s14, 4194304
    s_mov_b32 s15, 0x00020000
    s_mul_i32 s28, s26, 262144
    s_lshl_b32 s29, s27, 7
    s_add_u32 s28, s28, s29
    s_mov_b32 s30, 65536
    s_mov_b32 s31, 8192
    s_mul_i32 s32, s27, 65536
    s_mul_i32 s33, s26, 1024
    s_add_u32 s32, s32, s33
    s_add_u32 s32, s32, 12582912
    s_mov_b32 s33, 16384
    s_mov_b32 s34, 0
    s_branch prep_rp_go
prep_rp_3:
    s_cmp_ge_u32 s24, 1024
    s_cbranch_scc1 prep_rp_4
    s_load_dwordx2 s[6:7], s[0:1], 40
    s_sub_u32 s25, s24, 768
    s_lshl_b32 s25, s25, 2
    s_add_u32 s25, s25, s3
    s_lshr_b32 s26, s25, 3
    s_and_b32 s27, s25, 7
    s_waitcnt lgkmcnt(0)
    s_mov_b32 s12, s6
    s_mov_b32 s13, s7
    s_and_b32 s13, s13, 0xffff
    s_mov_b32 s14, 4194304
    s_mov_b32 s15, 0x00020000
    s_mul_i32 s28, s26, 32768
    s_lshl_b32 s29, s27, 7
    s_add_u32 s28, s28, s29
    s_mov_b32 s30, 8192
    s_mov_b32 s31, 1024
    s_mul_i32 s32, s27, 4096
    s_mul_i32 s33, s26, 32768
    s_add_u32 s32, s32, s33
    s_add_u32 s32, s32, 16777216
    s_mov_b32 s33, 1024
    s_mov_b32 s34, 1
    s_branch prep_rp_go
prep_rp_4:
    s_cmp_ge_u32 s24, 1136
    s_cbranch_scc1 prep_rp_5
    s_load_dwordx2 s[6:7], s[0:1], 64
    s_sub_u32 s25, s24, 1024
    s_lshl_b32 s25, s25, 2
    s_add_u32 s25, s25, s3
    s_mul_hi_u32 s26, s25, 153391690
    s_mul_i32 s27, s26, 28
    s_sub_u32 s27, s25, s27
    s_waitcnt lgkmcnt(0)
    s_mov_b32 s12, s6
    s_mov_b32 s13, s7
    s_and_b32 s13, s13, 0xffff
    s_mov_b32 s14, 1835008
    s_mov_b32 s15, 0x00020000
    s_mul_i32 s28, s26, 114688
    s_lshl_b32 s29, s27, 7
    s_add_u32 s28, s28, s29
    s_mov_b32 s30, 28672
    s_mov_b32 s31, 3584
    s_mul_i32 s32, s27, 65536
    s_mul_i32 s33, s26, 1024
    s_add_u32 s32, s32, s33
    s_add_u32 s32, s32, 20971520
    s_mov_b32 s33, 16384
    s_mov_b32 s34, 0
    s_branch prep_rp_go
prep_rp_5:
    s_cmp_ge_u32 s24, 1248
    s_cbranch_scc1 prep_rp_6
    s_load_dwordx2 s[6:7], s[0:1], 80
    s_sub_u32 s25, s24, 1136
    s_lshl_b32 s25, s25, 2
    s_add_u32 s25, s25, s3
    s_lshr_b32 s26, s25, 3
    s_and_b32 s27, s25, 7
    s_waitcnt lgkmcnt(0)
    s_mov_b32 s12, s6
    s_mov_b32 s13, s7
    s_and_b32 s13, s13, 0xffff
    s_mov_b32 s14, 1835008
    s_mov_b32 s15, 0x00020000
    s_mul_i32 s28, s26, 32768
    s_lshl_b32 s29, s27, 7
    s_add_u32 s28, s28, s29
    s_mov_b32 s30, 8192
    s_mov_b32 s31, 1024
    s_mul_i32 s32, s27, 4096
    s_mul_i32 s33, s26, 32768
    s_add_u32 s32, s32, s33
    s_add_u32 s32, s32, 23068672
    s_mov_b32 s33, 1024
    s_mov_b32 s34, 1
    s_branch prep_rp_go
prep_rp_6:
    s_branch prep_end
prep_rp_go:
    s_mov_b32 s16, s4
    s_mov_b32 s17, s5
    s_and_b32 s17, s17, 0xffff
    s_mov_b32 s18, 268435455
    s_mov_b32 s19, 0x00020000
    v_lshrrev_b32 v3, 3, v2
    v_mul_lo_u32 v3, v3, s31
    v_and_b32 v4, 7, v2
    v_lshl_add_u32 v3, v4, 4, v3
    buffer_load_dwordx4 v[8:11], v3, s[12:15], s28 offen
    s_add_u32 s28, s28, s30
    buffer_load_dwordx4 v[12:15], v3, s[12:15], s28 offen
    s_add_u32 s28, s28, s30
    buffer_load_dwordx4 v[16:19], v3, s[12:15], s28 offen
    s_add_u32 s28, s28, s30
    buffer_load_dwordx4 v[20:23], v3, s[12:15], s28 offen
    s_add_u32 s28, s28, s30
    s_lshl_b32 s35, s3, 12
    v_lshrrev_b32 v3, 3, v2
    v_lshlrev_b32 v3, 7, v3
    v_lshl_add_u32 v3, v4, 4, v3
    v_add_u32 v3, s35, v3
    s_waitcnt vmcnt(0)
    ds_write_b128 v3, v[8:11] offset:0
    ds_write_b128 v3, v[12:15] offset:1024
    ds_write_b128 v3, v[16:19] offset:2048
    ds_write_b128 v3, v[20:23] offset:3072
    v_lshrrev_b32 v5, 4, v2
    v_bfe_u32 v6, v2, 2, 2
    v_and_b32 v7, 3, v2
    s_cmp_eq_u32 s34, 0
    s_cselect_b32 s36, 3, 2
    s_cselect_b32 s37, 4, 16
    s_lshl_b32 s37, s37, 7
    v_lshlrev_b32 v5, s36, v5
    v_add_u32 v5, v5, v6
    v_lshlrev_b32 v5, 7, v5
    v_lshl_add_u32 v5, v7, 3, v5
    v_add_u32 v5, s35, v5
    v_add_u32 v6, s37, v5
    s_waitcnt lgkmcnt(0)
    ds_read_b64_tr_b16 v[24:25], v5 offset:0
    ds_read_b64_tr_b16 v[26:27], v6 offset:0
    ds_read_b64_tr_b16 v[28:29], v5 offset:32
    ds_read_b64_tr_b16 v[30:31], v6 offset:32
    ds_read_b64_tr_b16 v[32:33], v5 offset:64
    ds_read_b64_tr_b16 v[34:35], v6 offset:64
    ds_read_b64_tr_b16 v[36:37], v5 offset:96
    ds_read_b64_tr_b16 v[38:39], v6 offset:96
    v_lshlrev_b32 v3, 4, v2
    s_waitcnt lgkmcnt(0)
    buffer_store_dwordx4 v[24:27], v3, s[16:19], s32 offen
    s_add_u32 s32, s32, s33
    buffer_store_dwordx4 v[28:31], v3, s[16:19], s32 offen
    s_add_u32 s32, s32, s33
    buffer_store_dwordx4 v[32:35], v3, s[16:19], s32 offen
    s_add_u32 s32, s32, s33
    buffer_store_dwordx4 v[36:39], v3, s[16:19], s32 offen
    s_add_u32 s32, s32, s33
prep_end:
    s_endpgm
.globl ln1_kernel
.p2align 8
.type ln1_kernel,@function
ln1_kernel:
    s_cmp_ge_u32 s2, 128
    s_cbranch_scc1 ln1_end
    s_load_dwordx2 s[4:5], s[0:1], 128
    s_load_dwordx2 s[6:7], s[0:1], 0
    v_lshrrev_b32 v1, 6, v0
    v_and_b32 v2, 63, v0
    s_nop 0
    v_readfirstlane_b32 s3, v1
    s_waitcnt lgkmcnt(0)
    s_mov_b32 s12, s6
    s_mov_b32 s13, s7
    s_and_b32 s13, s13, 0xffff
    s_mov_b32 s14, 2097152
    s_mov_b32 s15, 0x00020000
    s_mov_b32 s16, s4
    s_mov_b32 s17, s5
    s_and_b32 s17, s17, 0xffff
    s_mov_b32 s18, 12288
    s_mov_b32 s19, 0x00020000
    s_add_u32 s20, s4, 1048576
    s_addc_u32 s21, s5, 0
    s_and_b32 s21, s21, 0xffff
    s_mov_b32 s22, 2097152
    s_mov_b32 s23, 0x00020000
    v_lshlrev_b32 v3, 5, v2
    buffer_load_dwordx4 v[40:43], v3, s[16:19], 0 offen
    buffer_load_dwordx4 v[44:47], v3, s[16:19], 0 offen offset:16
    buffer_load_dwordx4 v[48:51], v3, s[16:19], 0 offen offset:2048
    buffer_load_dwordx4 v[52:55], v3, s[16:19], 0 offen offset:2064
    s_lshl_b32 s24, s2, 2
    s_add_u32 s24, s24, s3
    s_lshl_b32 s24, s24, 12
    v_lshlrev_b32 v3, 4, v2
    buffer_load_dwordx4 v[60:63], v3, s[12:15], s24 offen offset:0
    buffer_load_dwordx4 v[64:67], v3, s[12:15], s24 offen offset:1024
    buffer_load_dwordx4 v[68:71], v3, s[12:15], s24 offen offset:2048
    buffer_load_dwordx4 v[72:75], v3, s[12:15], s24 offen offset:3072
    s_waitcnt vmcnt(4)
    v_add_f32 v48, 1.0, v48
    v_add_f32 v49, 1.0, v49
    v_cvt_pk_bf16_f32 v4, v48, v49
    v_lshlrev_b32 v48, 16, v4
    v_and_b32 v49, 0xffff0000, v4
    v_add_f32 v50, 1.0, v50
    v_add_f32 v51, 1.0, v51
    v_cvt_pk_bf16_f32 v4, v50, v51
    v_lshlrev_b32 v50, 16, v4
    v_and_b32 v51, 0xffff0000, v4
    v_add_f32 v52, 1.0, v52
    v_add_f32 v53, 1.0, v53
    v_cvt_pk_bf16_f32 v4, v52, v53
    v_lshlrev_b32 v52, 16, v4
    v_and_b32 v53, 0xffff0000, v4
    v_add_f32 v54, 1.0, v54
    v_add_f32 v55, 1.0, v55
    v_cvt_pk_bf16_f32 v4, v54, v55
    v_lshlrev_b32 v54, 16, v4
    v_and_b32 v55, 0xffff0000, v4
    s_waitcnt vmcnt(3)
    v_lshlrev_b32 v8, 16, v60
    v_and_b32 v9, 0xffff0000, v60
    v_lshlrev_b32 v10, 16, v61
    v_and_b32 v11, 0xffff0000, v61
    v_lshlrev_b32 v12, 16, v62
    v_and_b32 v13, 0xffff0000, v62
    v_lshlrev_b32 v14, 16, v63
    v_and_b32 v15, 0xffff0000, v63
    v_add_f32 v20, v8, v9
    v_add_f32 v20, v20, v10
    v_add_f32 v20, v20, v11
    v_add_f32 v20, v20, v12
    v_add_f32 v20, v20, v13
    v_add_f32 v20, v20, v14
    v_add_f32 v20, v20, v15
    s_nop 1
    v_add_f32_dpp v20, v20, v20 quad_perm:[1,0,3,2] row_mask:0xf bank_mask:0xf
    s_nop 1
    v_add_f32_dpp v20, v20, v20 quad_perm:[2,3,0,1] row_mask:0xf bank_mask:0xf
    s_nop 1
    v_add_f32_dpp v20, v20, v20 row_half_mirror row_mask:0xf bank_mask:0xf
    s_nop 1
    v_add_f32_dpp v20, v20, v20 row_mirror row_mask:0xf bank_mask:0xf
    v_mov_b32 v21, v20
    v_mov_b32 v22, v20
    s_nop 1
    v_permlane16_swap_b32 v21, v22
    s_nop 1
    v_add_f32 v20, v21, v22
    v_mov_b32 v21, v20
    v_mov_b32 v22, v20
    s_nop 1
    v_permlane32_swap_b32 v21, v22
    s_nop 1
    v_add_f32 v20, v21, v22
    v_mul_f32 v23, 0x3b000000, v20
    v_sub_f32 v21, v8, v23
    v_mul_f32 v20, v21, v21
    v_sub_f32 v21, v9, v23
    v_fmac_f32 v20, v21, v21
    v_sub_f32 v21, v10, v23
    v_fmac_f32 v20, v21, v21
    v_sub_f32 v21, v11, v23
    v_fmac_f32 v20, v21, v21
    v_sub_f32 v21, v12, v23
    v_fmac_f32 v20, v21, v21
    v_sub_f32 v21, v13, v23
    v_fmac_f32 v20, v21, v21
    v_sub_f32 v21, v14, v23
    v_fmac_f32 v20, v21, v21
    v_sub_f32 v21, v15, v23
    v_fmac_f32 v20, v21, v21
    s_nop 1
    v_add_f32_dpp v20, v20, v20 quad_perm:[1,0,3,2] row_mask:0xf bank_mask:0xf
    s_nop 1
    v_add_f32_dpp v20, v20, v20 quad_perm:[2,3,0,1] row_mask:0xf bank_mask:0xf
    s_nop 1
    v_add_f32_dpp v20, v20, v20 row_half_mirror row_mask:0xf bank_mask:0xf
    s_nop 1
    v_add_f32_dpp v20, v20, v20 row_mirror row_mask:0xf bank_mask:0xf
    v_mov_b32 v21, v20
    v_mov_b32 v22, v20
    s_nop 1
    v_permlane16_swap_b32 v21, v22
    s_nop 1
    v_add_f32 v20, v21, v22
    v_mov_b32 v21, v20
    v_mov_b32 v22, v20
    s_nop 1
    v_permlane32_swap_b32 v21, v22
    s_nop 1
    v_add_f32 v20, v21, v22
    v_mul_f32 v24, 0x3b000000, v20
    v_cvt_pk_bf16_f32 v21, v23, v24
    v_lshlrev_b32 v23, 16, v21
    v_and_b32 v24, 0xffff0000, v21
    v_add_f32 v25, 0x3727c5ac, v24
    v_cvt_pk_bf16_f32 v21, v25, v25
    v_lshlrev_b32 v25, 16, v21
    v_sqrt_f32 v25, v25
    s_nop 0
    v_cvt_pk_bf16_f32 v21, v25, v25
    v_lshlrev_b32 v25, 16, v21
    v_rcp_f32 v25, v25
    v_sub_f32 v8, v8, v23
    v_sub_f32 v9, v9, v23
    v_cvt_pk_bf16_f32 v21, v8, v9
    v_lshlrev_b32 v8, 16, v21
    v_and_b32 v9, 0xffff0000, v21
    v_mul_f32 v8, v8, v25
    v_mul_f32 v9, v9, v25
    v_cvt_pk_bf16_f32 v21, v8, v9
    v_lshlrev_b32 v8, 16, v21
    v_and_b32 v9, 0xffff0000, v21
    v_sub_f32 v10, v10, v23
    v_sub_f32 v11, v11, v23
    v_cvt_pk_bf16_f32 v21, v10, v11
    v_lshlrev_b32 v10, 16, v21
    v_and_b32 v11, 0xffff0000, v21
    v_mul_f32 v10, v10, v25
    v_mul_f32 v11, v11, v25
    v_cvt_pk_bf16_f32 v21, v10, v11
    v_lshlrev_b32 v10, 16, v21
    v_and_b32 v11, 0xffff0000, v21
    v_sub_f32 v12, v12, v23
    v_sub_f32 v13, v13, v23
    v_cvt_pk_bf16_f32 v21, v12, v13
    v_lshlrev_b32 v12, 16, v21
    v_and_b32 v13, 0xffff0000, v21
    v_mul_f32 v12, v12, v25
    v_mul_f32 v13, v13, v25
    v_cvt_pk_bf16_f32 v21, v12, v13
    v_lshlrev_b32 v12, 16, v21
    v_and_b32 v13, 0xffff0000, v21
    v_sub_f32 v14, v14, v23
    v_sub_f32 v15, v15, v23
    v_cvt_pk_bf16_f32 v21, v14, v15
    v_lshlrev_b32 v14, 16, v21
    v_and_b32 v15, 0xffff0000, v21
    v_mul_f32 v14, v14, v25
    v_mul_f32 v15, v15, v25
    v_cvt_pk_bf16_f32 v21, v14, v15
    v_lshlrev_b32 v14, 16, v21
    v_and_b32 v15, 0xffff0000, v21
    v_mul_f32 v8, v8, v48
    v_mul_f32 v9, v9, v49
    v_cvt_pk_bf16_f32 v4, v8, v9
    v_lshlrev_b32 v8, 16, v4
    v_and_b32 v9, 0xffff0000, v4
    v_add_f32 v8, v8, v40
    v_add_f32 v9, v9, v41
    v_mul_f32 v10, v10, v50
    v_mul_f32 v11, v11, v51
    v_cvt_pk_bf16_f32 v4, v10, v11
    v_lshlrev_b32 v10, 16, v4
    v_and_b32 v11, 0xffff0000, v4
    v_add_f32 v10, v10, v42
    v_add_f32 v11, v11, v43
    v_mul_f32 v12, v12, v52
    v_mul_f32 v13, v13, v53
    v_cvt_pk_bf16_f32 v4, v12, v13
    v_lshlrev_b32 v12, 16, v4
    v_and_b32 v13, 0xffff0000, v4
    v_add_f32 v12, v12, v44
    v_add_f32 v13, v13, v45
    v_mul_f32 v14, v14, v54
    v_mul_f32 v15, v15, v55
    v_cvt_pk_bf16_f32 v4, v14, v15
    v_lshlrev_b32 v14, 16, v4
    v_and_b32 v15, 0xffff0000, v4
    v_add_f32 v14, v14, v46
    v_add_f32 v15, v15, v47
    v_cvt_pk_bf16_f32 v80, v8, v9
    v_cvt_pk_bf16_f32 v81, v10, v11
    v_cvt_pk_bf16_f32 v82, v12, v13
    v_cvt_pk_bf16_f32 v83, v14, v15
    v_lshrrev_b32 v5, 2, v2
    v_lshlrev_b32 v5, 10, v5
    v_and_b32 v6, 3, v2
    v_lshl_add_u32 v5, v6, 8, v5
    s_lshl_b32 s26, s3, 6
    v_add_u32 v5, s26, v5
    ds_write_b128 v5, v[80:83] offset:0
    s_waitcnt vmcnt(2)
    v_lshlrev_b32 v8, 16, v64
    v_and_b32 v9, 0xffff0000, v64
    v_lshlrev_b32 v10, 16, v65
    v_and_b32 v11, 0xffff0000, v65
    v_lshlrev_b32 v12, 16, v66
    v_and_b32 v13, 0xffff0000, v66
    v_lshlrev_b32 v14, 16, v67
    v_and_b32 v15, 0xffff0000, v67
    v_add_f32 v20, v8, v9
    v_add_f32 v20, v20, v10
    v_add_f32 v20, v20, v11
    v_add_f32 v20, v20, v12
    v_add_f32 v20, v20, v13
    v_add_f32 v20, v20, v14
    v_add_f32 v20, v20, v15
    s_nop 1
    v_add_f32_dpp v20, v20, v20 quad_perm:[1,0,3,2] row_mask:0xf bank_mask:0xf
    s_nop 1
    v_add_f32_dpp v20, v20, v20 quad_perm:[2,3,0,1] row_mask:0xf bank_mask:0xf
    s_nop 1
    v_add_f32_dpp v20, v20, v20 row_half_mirror row_mask:0xf bank_mask:0xf
    s_nop 1
    v_add_f32_dpp v20, v20, v20 row_mirror row_mask:0xf bank_mask:0xf
    v_mov_b32 v21, v20
    v_mov_b32 v22, v20
    s_nop 1
    v_permlane16_swap_b32 v21, v22
    s_nop 1
    v_add_f32 v20, v21, v22
    v_mov_b32 v21, v20
    v_mov_b32 v22, v20
    s_nop 1
    v_permlane32_swap_b32 v21, v22
    s_nop 1
    v_add_f32 v20, v21, v22
    v_mul_f32 v23, 0x3b000000, v20
    v_sub_f32 v21, v8, v23
    v_mul_f32 v20, v21, v21
    v_sub_f32 v21, v9, v23
    v_fmac_f32 v20, v21, v21
    v_sub_f32 v21, v10, v23
    v_fmac_f32 v20, v21, v21
    v_sub_f32 v21, v11, v23
    v_fmac_f32 v20, v21, v21
    v_sub_f32 v21, v12, v23
    v_fmac_f32 v20, v21, v21
    v_sub_f32 v21, v13, v23
    v_fmac_f32 v20, v21, v21
    v_sub_f32 v21, v14, v23
    v_fmac_f32 v20, v21, v21
    v_sub_f32 v21, v15, v23
    v_fmac_f32 v20, v21, v21
    s_nop 1
    v_add_f32_dpp v20, v20, v20 quad_perm:[1,0,3,2] row_mask:0xf bank_mask:0xf
    s_nop 1
    v_add_f32_dpp v20, v20, v20 quad_perm:[2,3,0,1] row_mask:0xf bank_mask:0xf
    s_nop 1
    v_add_f32_dpp v20, v20, v20 row_half_mirror row_mask:0xf bank_mask:0xf
    s_nop 1
    v_add_f32_dpp v20, v20, v20 row_mirror row_mask:0xf bank_mask:0xf
    v_mov_b32 v21, v20
    v_mov_b32 v22, v20
    s_nop 1
    v_permlane16_swap_b32 v21, v22
    s_nop 1
    v_add_f32 v20, v21, v22
    v_mov_b32 v21, v20
    v_mov_b32 v22, v20
    s_nop 1
    v_permlane32_swap_b32 v21, v22
    s_nop 1
    v_add_f32 v20, v21, v22
    v_mul_f32 v24, 0x3b000000, v20
    v_cvt_pk_bf16_f32 v21, v23, v24
    v_lshlrev_b32 v23, 16, v21
    v_and_b32 v24, 0xffff0000, v21
    v_add_f32 v25, 0x3727c5ac, v24
    v_cvt_pk_bf16_f32 v21, v25, v25
    v_lshlrev_b32 v25, 16, v21
    v_sqrt_f32 v25, v25
    s_nop 0
    v_cvt_pk_bf16_f32 v21, v25, v25
    v_lshlrev_b32 v25, 16, v21
    v_rcp_f32 v25, v25
    v_sub_f32 v8, v8, v23
    v_sub_f32 v9, v9, v23
    v_cvt_pk_bf16_f32 v21, v8, v9
    v_lshlrev_b32 v8, 16, v21
    v_and_b32 v9, 0xffff0000, v21
    v_mul_f32 v8, v8, v25
    v_mul_f32 v9, v9, v25
    v_cvt_pk_bf16_f32 v21, v8, v9
    v_lshlrev_b32 v8, 16, v21
    v_and_b32 v9, 0xffff0000, v21
    v_sub_f32 v10, v10, v23
    v_sub_f32 v11, v11, v23
    v_cvt_pk_bf16_f32 v21, v10, v11
    v_lshlrev_b32 v10, 16, v21
    v_and_b32 v11, 0xffff0000, v21
    v_mul_f32 v10, v10, v25
    v_mul_f32 v11, v11, v25
    v_cvt_pk_bf16_f32 v21, v10, v11
    v_lshlrev_b32 v10, 16, v21
    v_and_b32 v11, 0xffff0000, v21
    v_sub_f32 v12, v12, v23
    v_sub_f32 v13, v13, v23
    v_cvt_pk_bf16_f32 v21, v12, v13
    v_lshlrev_b32 v12, 16, v21
    v_and_b32 v13, 0xffff0000, v21
    v_mul_f32 v12, v12, v25
    v_mul_f32 v13, v13, v25
    v_cvt_pk_bf16_f32 v21, v12, v13
    v_lshlrev_b32 v12, 16, v21
    v_and_b32 v13, 0xffff0000, v21
    v_sub_f32 v14, v14, v23
    v_sub_f32 v15, v15, v23
    v_cvt_pk_bf16_f32 v21, v14, v15
    v_lshlrev_b32 v14, 16, v21
    v_and_b32 v15, 0xffff0000, v21
    v_mul_f32 v14, v14, v25
    v_mul_f32 v15, v15, v25
    v_cvt_pk_bf16_f32 v21, v14, v15
    v_lshlrev_b32 v14, 16, v21
    v_and_b32 v15, 0xffff0000, v21
    v_mul_f32 v8, v8, v48
    v_mul_f32 v9, v9, v49
    v_cvt_pk_bf16_f32 v4, v8, v9
    v_lshlrev_b32 v8, 16, v4
    v_and_b32 v9, 0xffff0000, v4
    v_add_f32 v8, v8, v40
    v_add_f32 v9, v9, v41
    v_mul_f32 v10, v10, v50
    v_mul_f32 v11, v11, v51
    v_cvt_pk_bf16_f32 v4, v10, v11
    v_lshlrev_b32 v10, 16, v4
    v_and_b32 v11, 0xffff0000, v4
    v_add_f32 v10, v10, v42
    v_add_f32 v11, v11, v43
    v_mul_f32 v12, v12, v52
    v_mul_f32 v13, v13, v53
    v_cvt_pk_bf16_f32 v4, v12, v13
    v_lshlrev_b32 v12, 16, v4
    v_and_b32 v13, 0xffff0000, v4
    v_add_f32 v12, v12, v44
    v_add_f32 v13, v13, v45
    v_mul_f32 v14, v14, v54
    v_mul_f32 v15, v15, v55
    v_cvt_pk_bf16_f32 v4, v14, v15
    v_lshlrev_b32 v14, 16, v4
    v_and_b32 v15, 0xffff0000, v4
    v_add_f32 v14, v14, v46
    v_add_f32 v15, v15, v47
    v_cvt_pk_bf16_f32 v84, v8, v9
    v_cvt_pk_bf16_f32 v85, v10, v11
    v_cvt_pk_bf16_f32 v86, v12, v13
    v_cvt_pk_bf16_f32 v87, v14, v15
    ds_write_b128 v5, v[84:87] offset:16
    s_waitcnt vmcnt(1)
    v_lshlrev_b32 v8, 16, v68
    v_and_b32 v9, 0xffff0000, v68
    v_lshlrev_b32 v10, 16, v69
    v_and_b32 v11, 0xffff0000, v69
    v_lshlrev_b32 v12, 16, v70
    v_and_b32 v13, 0xffff0000, v70
    v_lshlrev_b32 v14, 16, v71
    v_and_b32 v15, 0xffff0000, v71
    v_add_f32 v20, v8, v9
    v_add_f32 v20, v20, v10
    v_add_f32 v20, v20, v11
    v_add_f32 v20, v20, v12
    v_add_f32 v20, v20, v13
    v_add_f32 v20, v20, v14
    v_add_f32 v20, v20, v15
    s_nop 1
    v_add_f32_dpp v20, v20, v20 quad_perm:[1,0,3,2] row_mask:0xf bank_mask:0xf
    s_nop 1
    v_add_f32_dpp v20, v20, v20 quad_perm:[2,3,0,1] row_mask:0xf bank_mask:0xf
    s_nop 1
    v_add_f32_dpp v20, v20, v20 row_half_mirror row_mask:0xf bank_mask:0xf
    s_nop 1
    v_add_f32_dpp v20, v20, v20 row_mirror row_mask:0xf bank_mask:0xf
    v_mov_b32 v21, v20
    v_mov_b32 v22, v20
    s_nop 1
    v_permlane16_swap_b32 v21, v22
    s_nop 1
    v_add_f32 v20, v21, v22
    v_mov_b32 v21, v20
    v_mov_b32 v22, v20
    s_nop 1
    v_permlane32_swap_b32 v21, v22
    s_nop 1
    v_add_f32 v20, v21, v22
    v_mul_f32 v23, 0x3b000000, v20
    v_sub_f32 v21, v8, v23
    v_mul_f32 v20, v21, v21
    v_sub_f32 v21, v9, v23
    v_fmac_f32 v20, v21, v21
    v_sub_f32 v21, v10, v23
    v_fmac_f32 v20, v21, v21
    v_sub_f32 v21, v11, v23
    v_fmac_f32 v20, v21, v21
    v_sub_f32 v21, v12, v23
    v_fmac_f32 v20, v21, v21
    v_sub_f32 v21, v13, v23
    v_fmac_f32 v20, v21, v21
    v_sub_f32 v21, v14, v23
    v_fmac_f32 v20, v21, v21
    v_sub_f32 v21, v15, v23
    v_fmac_f32 v20, v21, v21
    s_nop 1
    v_add_f32_dpp v20, v20, v20 quad_perm:[1,0,3,2] row_mask:0xf bank_mask:0xf
    s_nop 1
    v_add_f32_dpp v20, v20, v20 quad_perm:[2,3,0,1] row_mask:0xf bank_mask:0xf
    s_nop 1
    v_add_f32_dpp v20, v20, v20 row_half_mirror row_mask:0xf bank_mask:0xf
    s_nop 1
    v_add_f32_dpp v20, v20, v20 row_mirror row_mask:0xf bank_mask:0xf
    v_mov_b32 v21, v20
    v_mov_b32 v22, v20
    s_nop 1
    v_permlane16_swap_b32 v21, v22
    s_nop 1
    v_add_f32 v20, v21, v22
    v_mov_b32 v21, v20
    v_mov_b32 v22, v20
    s_nop 1
    v_permlane32_swap_b32 v21, v22
    s_nop 1
    v_add_f32 v20, v21, v22
    v_mul_f32 v24, 0x3b000000, v20
    v_cvt_pk_bf16_f32 v21, v23, v24
    v_lshlrev_b32 v23, 16, v21
    v_and_b32 v24, 0xffff0000, v21
    v_add_f32 v25, 0x3727c5ac, v24
    v_cvt_pk_bf16_f32 v21, v25, v25
    v_lshlrev_b32 v25, 16, v21
    v_sqrt_f32 v25, v25
    s_nop 0
    v_cvt_pk_bf16_f32 v21, v25, v25
    v_lshlrev_b32 v25, 16, v21
    v_rcp_f32 v25, v25
    v_sub_f32 v8, v8, v23
    v_sub_f32 v9, v9, v23
    v_cvt_pk_bf16_f32 v21, v8, v9
    v_lshlrev_b32 v8, 16, v21
    v_and_b32 v9, 0xffff0000, v21
    v_mul_f32 v8, v8, v25
    v_mul_f32 v9, v9, v25
    v_cvt_pk_bf16_f32 v21, v8, v9
    v_lshlrev_b32 v8, 16, v21
    v_and_b32 v9, 0xffff0000, v21
    v_sub_f32 v10, v10, v23
    v_sub_f32 v11, v11, v23
    v_cvt_pk_bf16_f32 v21, v10, v11
    v_lshlrev_b32 v10, 16, v21
    v_and_b32 v11, 0xffff0000, v21
    v_mul_f32 v10, v10, v25
    v_mul_f32 v11, v11, v25
    v_cvt_pk_bf16_f32 v21, v10, v11
    v_lshlrev_b32 v10, 16, v21
    v_and_b32 v11, 0xffff0000, v21
    v_sub_f32 v12, v12, v23
    v_sub_f32 v13, v13, v23
    v_cvt_pk_bf16_f32 v21, v12, v13
    v_lshlrev_b32 v12, 16, v21
    v_and_b32 v13, 0xffff0000, v21
    v_mul_f32 v12, v12, v25
    v_mul_f32 v13, v13, v25
    v_cvt_pk_bf16_f32 v21, v12, v13
    v_lshlrev_b32 v12, 16, v21
    v_and_b32 v13, 0xffff0000, v21
    v_sub_f32 v14, v14, v23
    v_sub_f32 v15, v15, v23
    v_cvt_pk_bf16_f32 v21, v14, v15
    v_lshlrev_b32 v14, 16, v21
    v_and_b32 v15, 0xffff0000, v21
    v_mul_f32 v14, v14, v25
    v_mul_f32 v15, v15, v25
    v_cvt_pk_bf16_f32 v21, v14, v15
    v_lshlrev_b32 v14, 16, v21
    v_and_b32 v15, 0xffff0000, v21
    v_mul_f32 v8, v8, v48
    v_mul_f32 v9, v9, v49
    v_cvt_pk_bf16_f32 v4, v8, v9
    v_lshlrev_b32 v8, 16, v4
    v_and_b32 v9, 0xffff0000, v4
    v_add_f32 v8, v8, v40
    v_add_f32 v9, v9, v41
    v_mul_f32 v10, v10, v50
    v_mul_f32 v11, v11, v51
    v_cvt_pk_bf16_f32 v4, v10, v11
    v_lshlrev_b32 v10, 16, v4
    v_and_b32 v11, 0xffff0000, v4
    v_add_f32 v10, v10, v42
    v_add_f32 v11, v11, v43
    v_mul_f32 v12, v12, v52
    v_mul_f32 v13, v13, v53
    v_cvt_pk_bf16_f32 v4, v12, v13
    v_lshlrev_b32 v12, 16, v4
    v_and_b32 v13, 0xffff0000, v4
    v_add_f32 v12, v12, v44
    v_add_f32 v13, v13, v45
    v_mul_f32 v14, v14, v54
    v_mul_f32 v15, v15, v55
    v_cvt_pk_bf16_f32 v4, v14, v15
    v_lshlrev_b32 v14, 16, v4
    v_and_b32 v15, 0xffff0000, v4
    v_add_f32 v14, v14, v46
    v_add_f32 v15, v15, v47
    v_cvt_pk_bf16_f32 v88, v8, v9
    v_cvt_pk_bf16_f32 v89, v10, v11
    v_cvt_pk_bf16_f32 v90, v12, v13
    v_cvt_pk_bf16_f32 v91, v14, v15
    ds_write_b128 v5, v[88:91] offset:32
    s_waitcnt vmcnt(0)
    v_lshlrev_b32 v8, 16, v72
    v_and_b32 v9, 0xffff0000, v72
    v_lshlrev_b32 v10, 16, v73
    v_and_b32 v11, 0xffff0000, v73
    v_lshlrev_b32 v12, 16, v74
    v_and_b32 v13, 0xffff0000, v74
    v_lshlrev_b32 v14, 16, v75
    v_and_b32 v15, 0xffff0000, v75
    v_add_f32 v20, v8, v9
    v_add_f32 v20, v20, v10
    v_add_f32 v20, v20, v11
    v_add_f32 v20, v20, v12
    v_add_f32 v20, v20, v13
    v_add_f32 v20, v20, v14
    v_add_f32 v20, v20, v15
    s_nop 1
    v_add_f32_dpp v20, v20, v20 quad_perm:[1,0,3,2] row_mask:0xf bank_mask:0xf
    s_nop 1
    v_add_f32_dpp v20, v20, v20 quad_perm:[2,3,0,1] row_mask:0xf bank_mask:0xf
    s_nop 1
    v_add_f32_dpp v20, v20, v20 row_half_mirror row_mask:0xf bank_mask:0xf
    s_nop 1
    v_add_f32_dpp v20, v20, v20 row_mirror row_mask:0xf bank_mask:0xf
    v_mov_b32 v21, v20
    v_mov_b32 v22, v20
    s_nop 1
    v_permlane16_swap_b32 v21, v22
    s_nop 1
    v_add_f32 v20, v21, v22
    v_mov_b32 v21, v20
    v_mov_b32 v22, v20
    s_nop 1
    v_permlane32_swap_b32 v21, v22
    s_nop 1
    v_add_f32 v20, v21, v22
    v_mul_f32 v23, 0x3b000000, v20
    v_sub_f32 v21, v8, v23
    v_mul_f32 v20, v21, v21
    v_sub_f32 v21, v9, v23
    v_fmac_f32 v20, v21, v21
    v_sub_f32 v21, v10, v23
    v_fmac_f32 v20, v21, v21
    v_sub_f32 v21, v11, v23
    v_fmac_f32 v20, v21, v21
    v_sub_f32 v21, v12, v23
    v_fmac_f32 v20, v21, v21
    v_sub_f32 v21, v13, v23
    v_fmac_f32 v20, v21, v21
    v_sub_f32 v21, v14, v23
    v_fmac_f32 v20, v21, v21
    v_sub_f32 v21, v15, v23
    v_fmac_f32 v20, v21, v21
    s_nop 1
    v_add_f32_dpp v20, v20, v20 quad_perm:[1,0,3,2] row_mask:0xf bank_mask:0xf
    s_nop 1
    v_add_f32_dpp v20, v20, v20 quad_perm:[2,3,0,1] row_mask:0xf bank_mask:0xf
    s_nop 1
    v_add_f32_dpp v20, v20, v20 row_half_mirror row_mask:0xf bank_mask:0xf
    s_nop 1
    v_add_f32_dpp v20, v20, v20 row_mirror row_mask:0xf bank_mask:0xf
    v_mov_b32 v21, v20
    v_mov_b32 v22, v20
    s_nop 1
    v_permlane16_swap_b32 v21, v22
    s_nop 1
    v_add_f32 v20, v21, v22
    v_mov_b32 v21, v20
    v_mov_b32 v22, v20
    s_nop 1
    v_permlane32_swap_b32 v21, v22
    s_nop 1
    v_add_f32 v20, v21, v22
    v_mul_f32 v24, 0x3b000000, v20
    v_cvt_pk_bf16_f32 v21, v23, v24
    v_lshlrev_b32 v23, 16, v21
    v_and_b32 v24, 0xffff0000, v21
    v_add_f32 v25, 0x3727c5ac, v24
    v_cvt_pk_bf16_f32 v21, v25, v25
    v_lshlrev_b32 v25, 16, v21
    v_sqrt_f32 v25, v25
    s_nop 0
    v_cvt_pk_bf16_f32 v21, v25, v25
    v_lshlrev_b32 v25, 16, v21
    v_rcp_f32 v25, v25
    v_sub_f32 v8, v8, v23
    v_sub_f32 v9, v9, v23
    v_cvt_pk_bf16_f32 v21, v8, v9
    v_lshlrev_b32 v8, 16, v21
    v_and_b32 v9, 0xffff0000, v21
    v_mul_f32 v8, v8, v25
    v_mul_f32 v9, v9, v25
    v_cvt_pk_bf16_f32 v21, v8, v9
    v_lshlrev_b32 v8, 16, v21
    v_and_b32 v9, 0xffff0000, v21
    v_sub_f32 v10, v10, v23
    v_sub_f32 v11, v11, v23
    v_cvt_pk_bf16_f32 v21, v10, v11
    v_lshlrev_b32 v10, 16, v21
    v_and_b32 v11, 0xffff0000, v21
    v_mul_f32 v10, v10, v25
    v_mul_f32 v11, v11, v25
    v_cvt_pk_bf16_f32 v21, v10, v11
    v_lshlrev_b32 v10, 16, v21
    v_and_b32 v11, 0xffff0000, v21
    v_sub_f32 v12, v12, v23
    v_sub_f32 v13, v13, v23
    v_cvt_pk_bf16_f32 v21, v12, v13
    v_lshlrev_b32 v12, 16, v21
    v_and_b32 v13, 0xffff0000, v21
    v_mul_f32 v12, v12, v25
    v_mul_f32 v13, v13, v25
    v_cvt_pk_bf16_f32 v21, v12, v13
    v_lshlrev_b32 v12, 16, v21
    v_and_b32 v13, 0xffff0000, v21
    v_sub_f32 v14, v14, v23
    v_sub_f32 v15, v15, v23
    v_cvt_pk_bf16_f32 v21, v14, v15
    v_lshlrev_b32 v14, 16, v21
    v_and_b32 v15, 0xffff0000, v21
    v_mul_f32 v14, v14, v25
    v_mul_f32 v15, v15, v25
    v_cvt_pk_bf16_f32 v21, v14, v15
    v_lshlrev_b32 v14, 16, v21
    v_and_b32 v15, 0xffff0000, v21
    v_mul_f32 v8, v8, v48
    v_mul_f32 v9, v9, v49
    v_cvt_pk_bf16_f32 v4, v8, v9
    v_lshlrev_b32 v8, 16, v4
    v_and_b32 v9, 0xffff0000, v4
    v_add_f32 v8, v8, v40
    v_add_f32 v9, v9, v41
    v_mul_f32 v10, v10, v50
    v_mul_f32 v11, v11, v51
    v_cvt_pk_bf16_f32 v4, v10, v11
    v_lshlrev_b32 v10, 16, v4
    v_and_b32 v11, 0xffff0000, v4
    v_add_f32 v10, v10, v42
    v_add_f32 v11, v11, v43
    v_mul_f32 v12, v12, v52
    v_mul_f32 v13, v13, v53
    v_cvt_pk_bf16_f32 v4, v12, v13
    v_lshlrev_b32 v12, 16, v4
    v_and_b32 v13, 0xffff0000, v4
    v_add_f32 v12, v12, v44
    v_add_f32 v13, v13, v45
    v_mul_f32 v14, v14, v54
    v_mul_f32 v15, v15, v55
    v_cvt_pk_bf16_f32 v4, v14, v15
    v_lshlrev_b32 v14, 16, v4
    v_and_b32 v15, 0xffff0000, v4
    v_add_f32 v14, v14, v46
    v_add_f32 v15, v15, v47
    v_cvt_pk_bf16_f32 v92, v8, v9
    v_cvt_pk_bf16_f32 v93, v10, v11
    v_cvt_pk_bf16_f32 v94, v12, v13
    v_cvt_pk_bf16_f32 v95, v14, v15
    ds_write_b128 v5, v[92:95] offset:48
    s_waitcnt lgkmcnt(0)
    s_barrier
    s_lshl_b32 s26, s3, 12
    v_add_u32 v5, s26, v3
    ds_read_b128 v[60:63], v5 offset:0
    ds_read_b128 v[64:67], v5 offset:1024
    ds_read_b128 v[68:71], v5 offset:2048
    ds_read_b128 v[72:75], v5 offset:3072
    s_lshl_b32 s25, s2, 14
    s_add_u32 s25, s25, s26
    s_waitcnt lgkmcnt(0)
    buffer_store_dwordx4 v[60:63], v3, s[20:23], s25 offen offset:0
    buffer_store_dwordx4 v[64:67], v3, s[20:23], s25 offen offset:1024
    buffer_store_dwordx4 v[68:71], v3, s[20:23], s25 offen offset:2048
    buffer_store_dwordx4 v[72:75], v3, s[20:23], s25 offen offset:3072
ln1_end:
    s_endpgm
.globl main_kernel
.p2align 8
.type main_kernel,@function
main_kernel:
    s_cmp_ge_u32 s2, 256
    s_cbranch_scc1 main_end
    s_load_dwordx2 s[4:5], s[0:1], 128
    s_load_dwordx2 s[8:9], s[0:1], 120
    v_lshrrev_b32 v1, 6, v0
    v_and_b32 v2, 63, v0
    s_nop 0
    v_readfirstlane_b32 s3, v1
    s_getreg_b32 s10, hwreg(HW_REG_XCC_ID)
    s_and_b32 s10, s10, 15
    s_waitcnt lgkmcnt(0)
    s_mov_b32 s12, s4
    s_mov_b32 s13, s5
    s_and_b32 s13, s13, 0xffff
    s_mov_b32 s14, 268435455
    s_mov_b32 s15, 0x00020000
    s_mov_b32 s16, s8
    s_mov_b32 s17, s9
    s_and_b32 s17, s17, 0xffff
    s_mov_b32 s18, 256
    s_mov_b32 s19, 0x00020000
    s_cmp_lg_u32 s3, 0
    s_cbranch_scc1 m_role_wait
    v_cmp_eq_u32 vcc, 0, v2
    s_and_saveexec_b64 s[42:43], vcc
    v_mov_b32 v10, 1
    s_lshl_b32 s20, s10, 2
    v_mov_b32 v11, s20
    buffer_atomic_add v10, v11, s[16:19], 0 offen sc0 sc1
    s_waitcnt vmcnt(0)
    v_mov_b32 v12, 1
    v_mov_b32 v11, 64
    buffer_atomic_add v12, v11, s[16:19], 0 offen sc0 sc1
    s_waitcnt vmcnt(0)
    s_nop 0
    v_readfirstlane_b32 s21, v10
    v_readfirstlane_b32 s22, v12
    v_mov_b32 v11, 68
    s_cmp_lg_u32 s21, 31
    s_cbranch_scc1 m_role_a
    s_add_u32 s20, s10, 1
    v_mov_b32 v14, s20
    v_mov_b32 v15, 0
    buffer_atomic_cmpswap v[14:15], v11, s[16:19], 0 offen sc1
    s_waitcnt vmcnt(0)
m_role_a:
    s_cmp_lg_u32 s22, 255
    s_cbranch_scc1 m_role_b
    v_mov_b32 v14, 100
    v_mov_b32 v15, 0
    buffer_atomic_cmpswap v[14:15], v11, s[16:19], 0 offen sc1
    s_waitcnt vmcnt(0)
m_role_b:
    s_mov_b32 s30, 0
m_role_poll:
    buffer_load_dword v14, v11, s[16:19], 0 offen sc1
    s_waitcnt vmcnt(0)
    s_nop 0
    v_readfirstlane_b32 s23, v14
    s_cmp_lg_u32 s23, 0
    s_cbranch_scc1 m_role_c
    s_add_u32 s30, s30, 1
    s_cmp_lt_u32 s30, 200000
    s_cbranch_scc1 m_role_poll
m_role_c:
    s_mov_b32 s24, 999
    s_add_u32 s20, s10, 1
    s_cmp_eq_u32 s23, s20
    s_cselect_b32 s24, s21, s24
    s_cmp_eq_u32 s23, 100
    s_cselect_b32 s24, s22, s24
    s_cselect_b32 s25, 1, 0
    s_mov_b32 s26, 0
    s_cmp_lt_u32 s24, 32
    s_cbranch_scc1 m_role_d
    s_mov_b32 s24, 999
    v_mov_b32 v12, 1
    v_mov_b32 v11, 72
    buffer_atomic_add v12, v11, s[16:19], 0 offen sc0 sc1
    s_waitcnt vmcnt(0)
    s_nop 0
    v_readfirstlane_b32 s26, v12
m_role_d:
    s_lshl_b32 s20, s25, 10
    s_or_b32 s20, s20, s24
    s_lshl_b32 s26, s26, 12
    s_or_b32 s20, s20, s26
    v_mov_b32 v14, s20
    v_mov_b32 v15, 0
    ds_write_b32 v15, v14
    s_mov_b64 exec, s[42:43]
    s_waitcnt lgkmcnt(0)
m_role_wait:
    s_barrier
    v_mov_b32 v15, 0
    ds_read_b32 v14, v15
    s_waitcnt lgkmcnt(0)
    s_nop 0
    v_readfirstlane_b32 s20, v14
    s_and_b32 s6, s20, 0x3ff
    s_bfe_u32 s11, s20, 0x1000a
    s_lshr_b32 s9, s20, 12
    s_barrier
    s_cmp_ge_u32 s6, 32
    s_cbranch_scc1 main_helper
    v_and_b32 v3, 15, v2
    v_lshrrev_b32 v4, 4, v2
    v_and_b32 v5, 7, v2
    v_lshlrev_b32 v5, 5, v5
    v_and_b32 v1, 1, v4
    v_lshl_add_u32 v5, v1, 4, v5
    v_lshrrev_b32 v1, 1, v4
    v_lshl_add_u32 v5, v1, 8, v5
    v_add_u32 v5, 147456, v5
    v_lshlrev_b32 v6, 4, v2
    v_lshlrev_b32 v7, 13, v3
    v_lshl_add_u32 v7, v4, 4, v7
    v_lshlrev_b32 v8, 6, v3
    v_lshl_add_u32 v8, v4, 4, v8
    v_bfe_u32 v9, v3, 1, 2
    v_lshlrev_b32 v9, 12, v9
    v_and_b32 v1, 1, v3
    v_lshl_add_u32 v9, v1, 6, v9
    v_lshl_add_u32 v9, v4, 4, v9
    v_lshrrev_b32 v1, 3, v3
    v_lshl_add_u32 v9, v1, 14, v9
    v_mov_b32 v1, 0x40000000
    s_mov_b32 s38, 0xfffffffc
    v_lshlrev_b32 v10, 3, v2
    v_cmp_gt_u32 vcc, 8, v2
    s_nop 1
    v_cndmask_b32 v10, v1, v10, vcc
    s_mov_b32 s40, 0
    s_mov_b32 s41, 0x00ff00ff
    s_mov_b32 s34, 0x3db504f3
    s_mov_b32 s35, 0x3db504f3
    s_mov_b32 s36, 0x3fb8aa3b
    s_mov_b32 s37, 0x3fb8aa3b
    s_lshl_b32 s20, s6, 3
    s_lshl_b32 s21, s3, 1
    s_add_u32 s20, s20, s21
    s_add_u32 s20, s20, 0
    s_lshl_b32 s20, s20, 14
    s_add_u32 s20, s20, 4194304
    buffer_load_dwordx4 a[0:3], v6, s[12:15], s20 offen offset:0
    buffer_load_dwordx4 a[4:7], v6, s[12:15], s20 offen offset:1024
    buffer_load_dwordx4 a[8:11], v6, s[12:15], s20 offen offset:2048
    buffer_load_dwordx4 a[12:15], v6, s[12:15], s20 offen offset:3072
    s_add_u32 s20, s20, 4096
    buffer_load_dwordx4 a[16:19], v6, s[12:15], s20 offen offset:0
    buffer_load_dwordx4 a[20:23], v6, s[12:15], s20 offen offset:1024
    buffer_load_dwordx4 a[24:27], v6, s[12:15], s20 offen offset:2048
    buffer_load_dwordx4 a[28:31], v6, s[12:15], s20 offen offset:3072
    s_add_u32 s20, s20, 4096
    buffer_load_dwordx4 a[32:35], v6, s[12:15], s20 offen offset:0
    buffer_load_dwordx4 a[36:39], v6, s[12:15], s20 offen offset:1024
    buffer_load_dwordx4 a[40:43], v6, s[12:15], s20 offen offset:2048
    buffer_load_dwordx4 a[44:47], v6, s[12:15], s20 offen offset:3072
    s_add_u32 s20, s20, 4096
    buffer_load_dwordx4 a[48:51], v6, s[12:15], s20 offen offset:0
    buffer_load_dwordx4 a[52:55], v6, s[12:15], s20 offen offset:1024
    buffer_load_dwordx4 a[56:59], v6, s[12:15], s20 offen offset:2048
    buffer_load_dwordx4 a[60:63], v6, s[12:15], s20 offen offset:3072
    s_add_u32 s20, s20, 4096
    s_lshl_b32 s20, s6, 3
    s_lshl_b32 s21, s3, 1
    s_add_u32 s20, s20, s21
    s_add_u32 s20, s20, 1
    s_lshl_b32 s20, s20, 14
    s_add_u32 s20, s20, 4194304
    buffer_load_dwordx4 a[64:67], v6, s[12:15], s20 offen offset:0
    buffer_load_dwordx4 a[68:71], v6, s[12:15], s20 offen offset:1024
    buffer_load_dwordx4 a[72:75], v6, s[12:15], s20 offen offset:2048
    buffer_load_dwordx4 a[76:79], v6, s[12:15], s20 offen offset:3072
    s_add_u32 s20, s20, 4096
    buffer_load_dwordx4 a[80:83], v6, s[12:15], s20 offen offset:0
    buffer_load_dwordx4 a[84:87], v6, s[12:15], s20 offen offset:1024
    buffer_load_dwordx4 a[88:91], v6, s[12:15], s20 offen offset:2048
    buffer_load_dwordx4 a[92:95], v6, s[12:15], s20 offen offset:3072
    s_add_u32 s20, s20, 4096
    buffer_load_dwordx4 a[96:99], v6, s[12:15], s20 offen offset:0
    buffer_load_dwordx4 a[100:103], v6, s[12:15], s20 offen offset:1024
    buffer_load_dwordx4 a[104:107], v6, s[12:15], s20 offen offset:2048
    buffer_load_dwordx4 a[108:111], v6, s[12:15], s20 offen offset:3072
    s_add_u32 s20, s20, 4096
    buffer_load_dwordx4 a[112:115], v6, s[12:15], s20 offen offset:0
    buffer_load_dwordx4 a[116:119], v6, s[12:15], s20 offen offset:1024
    buffer_load_dwordx4 a[120:123], v6, s[12:15], s20 offen offset:2048
    buffer_load_dwordx4 a[124:127], v6, s[12:15], s20 offen offset:3072
    s_add_u32 s20, s20, 4096
    s_lshl_b32 s20, s6, 3
    s_lshl_b32 s21, s3, 1
    s_add_u32 s20, s20, s21
    s_add_u32 s20, s20, 256
    s_lshl_b32 s20, s20, 14
    s_add_u32 s20, s20, 4194304
    buffer_load_dwordx4 a[128:131], v6, s[12:15], s20 offen offset:0
    buffer_load_dwordx4 a[132:135], v6, s[12:15], s20 offen offset:1024
    buffer_load_dwordx4 a[136:139], v6, s[12:15], s20 offen offset:2048
    buffer_load_dwordx4 a[140:143], v6, s[12:15], s20 offen offset:3072
    s_add_u32 s20, s20, 4096
    buffer_load_dwordx4 a[144:147], v6, s[12:15], s20 offen offset:0
    buffer_load_dwordx4 a[148:151], v6, s[12:15], s20 offen offset:1024
    buffer_load_dwordx4 a[152:155], v6, s[12:15], s20 offen offset:2048
    buffer_load_dwordx4 a[156:159], v6, s[12:15], s20 offen offset:3072
    s_add_u32 s20, s20, 4096
    buffer_load_dwordx4 a[160:163], v6, s[12:15], s20 offen offset:0
    buffer_load_dwordx4 a[164:167], v6, s[12:15], s20 offen offset:1024
    buffer_load_dwordx4 a[168:171], v6, s[12:15], s20 offen offset:2048
    buffer_load_dwordx4 a[172:175], v6, s[12:15], s20 offen offset:3072
    s_add_u32 s20, s20, 4096
    buffer_load_dwordx4 a[176:179], v6, s[12:15], s20 offen offset:0
    buffer_load_dwordx4 a[180:183], v6, s[12:15], s20 offen offset:1024
    buffer_load_dwordx4 a[184:187], v6, s[12:15], s20 offen offset:2048
    buffer_load_dwordx4 a[188:191], v6, s[12:15], s20 offen offset:3072
    s_add_u32 s20, s20, 4096
    s_lshl_b32 s20, s6, 3
    s_lshl_b32 s21, s3, 1
    s_add_u32 s20, s20, s21
    s_add_u32 s20, s20, 257
    s_lshl_b32 s20, s20, 14
    s_add_u32 s20, s20, 4194304
    buffer_load_dwordx4 a[192:195], v6, s[12:15], s20 offen offset:0
    buffer_load_dwordx4 a[196:199], v6, s[12:15], s20 offen offset:1024
    buffer_load_dwordx4 a[200:203], v6, s[12:15], s20 offen offset:2048
    buffer_load_dwordx4 a[204:207], v6, s[12:15], s20 offen offset:3072
    s_add_u32 s20, s20, 4096
    buffer_load_dwordx4 a[208:211], v6, s[12:15], s20 offen offset:0
    buffer_load_dwordx4 a[212:215], v6, s[12:15], s20 offen offset:1024
    buffer_load_dwordx4 a[216:219], v6, s[12:15], s20 offen offset:2048
    buffer_load_dwordx4 a[220:223], v6, s[12:15], s20 offen offset:3072
    s_add_u32 s20, s20, 4096
    buffer_load_dwordx4 a[224:227], v6, s[12:15], s20 offen offset:0
    buffer_load_dwordx4 a[228:231], v6, s[12:15], s20 offen offset:1024
    buffer_load_dwordx4 a[232:235], v6, s[12:15], s20 offen offset:2048
    buffer_load_dwordx4 a[236:239], v6, s[12:15], s20 offen offset:3072
    s_add_u32 s20, s20, 4096
    buffer_load_dwordx4 a[240:243], v6, s[12:15], s20 offen offset:0
    buffer_load_dwordx4 a[244:247], v6, s[12:15], s20 offen offset:1024
    buffer_load_dwordx4 a[248:251], v6, s[12:15], s20 offen offset:2048
    buffer_load_dwordx4 a[252:255], v6, s[12:15], s20 offen offset:3072
    s_add_u32 s20, s20, 4096
    s_lshl_b32 s20, s6, 3
    s_lshl_b32 s21, s3, 1
    s_add_u32 s20, s20, s21
    s_add_u32 s20, s20, 512
    s_lshl_b32 s20, s20, 14
    s_add_u32 s20, s20, 4194304
    buffer_load_dwordx4 v[128:131], v6, s[12:15], s20 offen offset:0
    buffer_load_dwordx4 v[132:135], v6, s[12:15], s20 offen offset:1024
    buffer_load_dwordx4 v[136:139], v6, s[12:15], s20 offen offset:2048
    buffer_load_dwordx4 v[140:143], v6, s[12:15], s20 offen offset:3072
    s_add_u32 s20, s20, 4096
    buffer_load_dwordx4 v[144:147], v6, s[12:15], s20 offen offset:0
    buffer_load_dwordx4 v[148:151], v6, s[12:15], s20 offen offset:1024
    buffer_load_dwordx4 v[152:155], v6, s[12:15], s20 offen offset:2048
    buffer_load_dwordx4 v[156:159], v6, s[12:15], s20 offen offset:3072
    s_add_u32 s20, s20, 4096
    buffer_load_dwordx4 v[160:163], v6, s[12:15], s20 offen offset:0
    buffer_load_dwordx4 v[164:167], v6, s[12:15], s20 offen offset:1024
    buffer_load_dwordx4 v[168:171], v6, s[12:15], s20 offen offset:2048
    buffer_load_dwordx4 v[172:175], v6, s[12:15], s20 offen offset:3072
    s_add_u32 s20, s20, 4096
    buffer_load_dwordx4 v[176:179], v6, s[12:15], s20 offen offset:0
    buffer_load_dwordx4 v[180:183], v6, s[12:15], s20 offen offset:1024
    buffer_load_dwordx4 v[184:187], v6, s[12:15], s20 offen offset:2048
    buffer_load_dwordx4 v[188:191], v6, s[12:15], s20 offen offset:3072
    s_add_u32 s20, s20, 4096
    s_lshl_b32 s20, s6, 3
    s_lshl_b32 s21, s3, 1
    s_add_u32 s20, s20, s21
    s_add_u32 s20, s20, 513
    s_lshl_b32 s20, s20, 14
    s_add_u32 s20, s20, 4194304
    buffer_load_dwordx4 v[192:195], v6, s[12:15], s20 offen offset:0
    buffer_load_dwordx4 v[196:199], v6, s[12:15], s20 offen offset:1024
    buffer_load_dwordx4 v[200:203], v6, s[12:15], s20 offen offset:2048
    buffer_load_dwordx4 v[204:207], v6, s[12:15], s20 offen offset:3072
    s_add_u32 s20, s20, 4096
    buffer_load_dwordx4 v[208:211], v6, s[12:15], s20 offen offset:0
    buffer_load_dwordx4 v[212:215], v6, s[12:15], s20 offen offset:1024
    buffer_load_dwordx4 v[216:219], v6, s[12:15], s20 offen offset:2048
    buffer_load_dwordx4 v[220:223], v6, s[12:15], s20 offen offset:3072
    s_add_u32 s20, s20, 4096
    buffer_load_dwordx4 v[224:227], v6, s[12:15], s20 offen offset:0
    buffer_load_dwordx4 v[228:231], v6, s[12:15], s20 offen offset:1024
    buffer_load_dwordx4 v[232:235], v6, s[12:15], s20 offen offset:2048
    buffer_load_dwordx4 v[236:239], v6, s[12:15], s20 offen offset:3072
    s_add_u32 s20, s20, 4096
    buffer_load_dwordx4 v[240:243], v6, s[12:15], s20 offen offset:0
    buffer_load_dwordx4 v[244:247], v6, s[12:15], s20 offen offset:1024
    buffer_load_dwordx4 v[248:251], v6, s[12:15], s20 offen offset:2048
    buffer_load_dwordx4 v[252:255], v6, s[12:15], s20 offen offset:3072
    s_add_u32 s20, s20, 4096
    s_lshl_b32 s20, s6, 17
    s_lshl_b32 s21, s3, 15
    s_add_u32 s20, s20, s21
    s_add_u32 s20, s20, 16777216
    v_add_u32 v11, s21, v6
    buffer_load_dwordx4 v[64:67], v6, s[12:15], s20 offen offset:0
    buffer_load_dwordx4 v[68:71], v6, s[12:15], s20 offen offset:1024
    buffer_load_dwordx4 v[72:75], v6, s[12:15], s20 offen offset:2048
    buffer_load_dwordx4 v[76:79], v6, s[12:15], s20 offen offset:3072
    s_add_u32 s20, s20, 4096
    buffer_load_dwordx4 v[80:83], v6, s[12:15], s20 offen offset:0
    buffer_load_dwordx4 v[84:87], v6, s[12:15], s20 offen offset:1024
    buffer_load_dwordx4 v[88:91], v6, s[12:15], s20 offen offset:2048
    buffer_load_dwordx4 v[92:95], v6, s[12:15], s20 offen offset:3072
    s_add_u32 s20, s20, 4096
    buffer_load_dwordx4 v[96:99], v6, s[12:15], s20 offen offset:0
    buffer_load_dwordx4 v[100:103], v6, s[12:15], s20 offen offset:1024
    buffer_load_dwordx4 v[104:107], v6, s[12:15], s20 offen offset:2048
    buffer_load_dwordx4 v[108:111], v6, s[12:15], s20 offen offset:3072
    s_add_u32 s20, s20, 4096
    buffer_load_dwordx4 v[112:115], v6, s[12:15], s20 offen offset:0
    buffer_load_dwordx4 v[116:119], v6, s[12:15], s20 offen offset:1024
    buffer_load_dwordx4 v[120:123], v6, s[12:15], s20 offen offset:2048
    buffer_load_dwordx4 v[124:127], v6, s[12:15], s20 offen offset:3072
    s_add_u32 s20, s20, 4096
    s_waitcnt vmcnt(15)
    ds_write_b128 v11, v[64:67] offset:0
    s_waitcnt vmcnt(14)
    ds_write_b128 v11, v[68:71] offset:1024
    s_waitcnt vmcnt(13)
    ds_write_b128 v11, v[72:75] offset:2048
    s_waitcnt vmcnt(12)
    ds_write_b128 v11, v[76:79] offset:3072
    s_waitcnt vmcnt(11)
    ds_write_b128 v11, v[80:83] offset:4096
    s_waitcnt vmcnt(10)
    ds_write_b128 v11, v[84:87] offset:5120
    s_waitcnt vmcnt(9)
    ds_write_b128 v11, v[88:91] offset:6144
    s_waitcnt vmcnt(8)
    ds_write_b128 v11, v[92:95] offset:7168
    s_waitcnt vmcnt(7)
    ds_write_b128 v11, v[96:99] offset:8192
    s_waitcnt vmcnt(6)
    ds_write_b128 v11, v[100:103] offset:9216
    s_waitcnt vmcnt(5)
    ds_write_b128 v11, v[104:107] offset:10240
    s_waitcnt vmcnt(4)
    ds_write_b128 v11, v[108:111] offset:11264
    s_waitcnt vmcnt(3)
    ds_write_b128 v11, v[112:115] offset:12288
    s_waitcnt vmcnt(2)
    ds_write_b128 v11, v[116:119] offset:13312
    s_waitcnt vmcnt(1)
    ds_write_b128 v11, v[120:123] offset:14336
    s_waitcnt vmcnt(0)
    ds_write_b128 v11, v[124:127] offset:15360
    buffer_load_dwordx4 v[64:67], v6, s[12:15], s20 offen offset:0
    buffer_load_dwordx4 v[68:71], v6, s[12:15], s20 offen offset:1024
    buffer_load_dwordx4 v[72:75], v6, s[12:15], s20 offen offset:2048
    buffer_load_dwordx4 v[76:79], v6, s[12:15], s20 offen offset:3072
    s_add_u32 s20, s20, 4096
    buffer_load_dwordx4 v[80:83], v6, s[12:15], s20 offen offset:0
    buffer_load_dwordx4 v[84:87], v6, s[12:15], s20 offen offset:1024
    buffer_load_dwordx4 v[88:91], v6, s[12:15], s20 offen offset:2048
    buffer_load_dwordx4 v[92:95], v6, s[12:15], s20 offen offset:3072
    s_add_u32 s20, s20, 4096
    buffer_load_dwordx4 v[96:99], v6, s[12:15], s20 offen offset:0
    buffer_load_dwordx4 v[100:103], v6, s[12:15], s20 offen offset:1024
    buffer_load_dwordx4 v[104:107], v6, s[12:15], s20 offen offset:2048
    buffer_load_dwordx4 v[108:111], v6, s[12:15], s20 offen offset:3072
    s_add_u32 s20, s20, 4096
    buffer_load_dwordx4 v[112:115], v6, s[12:15], s20 offen offset:0
    buffer_load_dwordx4 v[116:119], v6, s[12:15], s20 offen offset:1024
    buffer_load_dwordx4 v[120:123], v6, s[12:15], s20 offen offset:2048
    buffer_load_dwordx4 v[124:127], v6, s[12:15], s20 offen offset:3072
    s_add_u32 s20, s20, 4096
    s_waitcnt vmcnt(15)
    ds_write_b128 v11, v[64:67] offset:16384
    s_waitcnt vmcnt(14)
    ds_write_b128 v11, v[68:71] offset:17408
    s_waitcnt vmcnt(13)
    ds_write_b128 v11, v[72:75] offset:18432
    s_waitcnt vmcnt(12)
    ds_write_b128 v11, v[76:79] offset:19456
    s_waitcnt vmcnt(11)
    ds_write_b128 v11, v[80:83] offset:20480
    s_waitcnt vmcnt(10)
    ds_write_b128 v11, v[84:87] offset:21504
    s_waitcnt vmcnt(9)
    ds_write_b128 v11, v[88:91] offset:22528
    s_waitcnt vmcnt(8)
    ds_write_b128 v11, v[92:95] offset:23552
    s_waitcnt vmcnt(7)
    ds_write_b128 v11, v[96:99] offset:24576
    s_waitcnt vmcnt(6)
    ds_write_b128 v11, v[100:103] offset:25600
    s_waitcnt vmcnt(5)
    ds_write_b128 v11, v[104:107] offset:26624
    s_waitcnt vmcnt(4)
    ds_write_b128 v11, v[108:111] offset:27648
    s_waitcnt vmcnt(3)
    ds_write_b128 v11, v[112:115] offset:28672
    s_waitcnt vmcnt(2)
    ds_write_b128 v11, v[116:119] offset:29696
    s_waitcnt vmcnt(1)
    ds_write_b128 v11, v[120:123] offset:30720
    s_waitcnt vmcnt(0)
    ds_write_b128 v11, v[124:127] offset:31744
    s_mov_b32 s7, 0
    s_mov_b32 s46, 0
    s_mov_b32 s22, 125829120
    s_lshl_b32 s23, s6, 12
    s_lshl_b32 s20, s3, 10
    s_add_u32 s23, s23, s20
    s_add_u32 s23, s23, 50331648
    s_lshl_b32 s24, s6, 13
    s_lshl_b32 s20, s3, 11
    s_add_u32 s24, s24, s20
    s_add_u32 s24, s24, 67108864
    s_lshl_b32 s25, s6, 12
    s_lshl_b32 s20, s3, 10
    s_add_u32 s25, s25, s20
    s_add_u32 s25, s25, 100663296
    s_lshl_b32 s26, s6, 12
    s_lshl_b32 s20, s3, 10
    s_add_u32 s26, s26, s20
    s_add_u32 s26, s26, 109051904
    s_lshl_b32 s27, s3, 17
    s_lshl_b32 s20, s6, 7
    s_add_u32 s27, s27, s20
    s_add_u32 s27, s27, 126877696
    s_lshl_b32 s28, s6, 14
    s_lshl_b32 s20, s3, 12
    s_add_u32 s28, s28, s20
    s_add_u32 s28, s28, 126877696
    s_lshl_b32 s29, s6, 8
    s_lshl_b32 s20, s3, 6
    s_add_u32 s29, s29, s20
    s_add_u32 s29, s29, 8192
    s_lshl_b32 s31, s3, 11
    s_lshl_b32 s32, s6, 4
    s_lshl_b32 s20, s3, 2
    s_add_u32 s32, s32, s20
    s_add_u32 s32, s32, 126615552
    v_bfe_u32 v12, v2, 3, 1
    v_lshlrev_b32 v12, 17, v12
    v_and_b32 v13, 7, v2
    v_lshl_add_u32 v12, v13, 7, v12
    v_add_u32 v12, s23, v12
    v_lshlrev_b32 v13, 7, v3
    v_add_u32 v13, s24, v13
    v_cmp_gt_u32 vcc, 32, v2
    s_lshl_b32 s21, s3, 13
    v_add_u32 v11, s21, v6
    v_add_u32 v0, 0x10000, v11
    v_lshrrev_b32 v14, 3, v3
    v_cndmask_b32 v3, v13, v12, vcc
    v_add_u32 v1, 131072, v6
    s_mul_i32 s20, s3, 3072
    v_add_u32 v2, s20, v1
    v_mul_u32_u24 v13, 1920, v14
    v_add_u32 v4, 1024, v1
    v_mul_u32_u24 v12, 120, v14
    v_sub_u32 v4, v4, v12
    v_add_u32 v1, v1, v13
    v_add_u32 v62, s31, v6
    v_add_u32 v62, 147456, v62
    s_lshl_b32 s20, s3, 10
    v_add_u32 v60, s20, v6
    v_add_u32 v60, 143360, v60
    v_add_u32 v61, 143360, v6
    s_lshl_b32 s20, s3, 8
    s_add_u32 s20, s20, 155648
    s_mov_b32 m0, s20
    s_mov_b32 s30, 0
    s_mov_b32 s33, 126616064
w_kv0:
    buffer_load_dword v52, off, s[12:15], s33 sc1
    s_waitcnt vmcnt(0)
    v_cmp_ne_u32 vcc, 32, v52
    s_cbranch_vccz w_kv0_ok
    s_sleep 8
    s_add_u32 s30, s30, 1
    s_cmp_lt_u32 s30, 200000
    s_cbranch_scc1 w_kv0
w_kv0_ok:
    s_waitcnt lgkmcnt(0)
    s_barrier
rec_step:
    s_mov_b32 s30, 0
    s_add_u32 s21, s22, s31
    s_cmp_lg_u32 s46, 0
    s_cbranch_scc1 rec_poll
    s_add_u32 s33, s7, 1
    s_and_b32 s20, s33, 3
    s_cmp_lg_u32 s20, 0
    s_cbranch_scc1 rec_poll
    s_lshr_b32 s33, s33, 2
    s_min_u32 s33, s33, 15
    s_mov_b32 s47, 126616064
    v_lshrrev_b32 v52, 2, v6
    v_and_b32 v52, 60, v52
rec_kvchk:
    buffer_load_dword v53, v52, s[12:15], s47 offen sc1
    s_waitcnt vmcnt(0)
    v_cmp_ne_u32 vcc, 32, v53
    s_cmp_eq_u64 vcc, 0
    s_cselect_b32 s46, 1, 0
    s_lshr_b32 s20, vcc_lo, s33
    s_and_b32 s20, s20, 1
    s_cmp_eq_u32 s20, 0
    s_cbranch_scc1 rec_poll
    s_sleep 4
    s_add_u32 s30, s30, 1
    s_cmp_lt_u32 s30, 200000
    s_cbranch_scc1 rec_kvchk
rec_poll:
    buffer_load_dwordx4 v[64:67], v6, s[12:15], s21 offen sc1
    buffer_load_dwordx4 v[68:71], v6, s[12:15], s21 offen offset:1024 sc1
    s_waitcnt vmcnt(0)
    v_max3_u32 v52, v64, v65, v66
    v_max3_u32 v52, v52, v67, v68
    v_max3_u32 v52, v52, v69, v70
    v_max_u32 v52, v52, v71
    v_cmp_eq_u32 vcc, -1, v52
    s_cbranch_vccz rec_poll_ok
    s_add_u32 s30, s30, 1
    s_cmp_lt_u32 s30, 200000
    s_cbranch_scc1 rec_poll
rec_poll_ok:
    ds_write_b128 v62, v[64:67]
    ds_write_b128 v62, v[68:71] offset:1024
    s_waitcnt lgkmcnt(0)
    s_barrier
    ds_read_b128 v[64:67], v5 offset:0
    ds_read_b128 v[68:71], v5 offset:512
    ds_read_b128 v[72:75], v5 offset:1024
    ds_read_b128 v[76:79], v5 offset:1536
    ds_read_b128 v[80:83], v5 offset:2048
    ds_read_b128 v[84:87], v5 offset:2560
    ds_read_b128 v[88:91], v5 offset:3072
    ds_read_b128 v[92:95], v5 offset:3584
    ds_read_b128 v[96:99], v5 offset:4096
    ds_read_b128 v[100:103], v5 offset:4608
    ds_read_b128 v[104:107], v5 offset:5120
    ds_read_b128 v[108:111], v5 offset:5632
    ds_read_b128 v[112:115], v5 offset:6144
    ds_read_b128 v[116:119], v5 offset:6656
    ds_read_b128 v[120:123], v5 offset:7168
    ds_read_b128 v[124:127], v5 offset:7680
    s_sub_u32 s47, s26, 0x20000
    s_cmp_eq_u32 s7, 0
    s_cselect_b32 s47, s26, s47
    s_sub_u32 s20, s7, 1
    s_max_i32 s20, s20, 0
    v_mov_b32 v52, s20
    s_bfe_u32 s20, s7, 0x10001
    s_lshl_b32 s39, 1, s20
    v_mov_b32 v63, s39
    s_xor_b32 s39, s39, 3
    s_add_u32 s33, s7, 1
    s_min_u32 s33, s33, 63
    s_lshl_b32 s33, s33, 18
    s_add_u32 s20, s23, 0x20000
    s_waitcnt lgkmcnt(15)
    v_mfma_f32_16x16x32_bf16 v[12:15], a[0:3], v[64:67], 0
    v_mfma_f32_16x16x32_bf16 v[16:19], a[64:67], v[64:67], 0
    v_mfma_f32_16x16x32_bf16 v[20:23], a[128:131], v[64:67], 0
    v_mfma_f32_16x16x32_bf16 v[24:27], a[192:195], v[64:67], 0
    buffer_load_dwordx4 v[36:39], v6, s[12:15], s23 offen
    s_waitcnt lgkmcnt(14)
    v_mfma_f32_16x16x32_bf16 v[12:15], a[4:7], v[68:71], v[12:15]
    v_mfma_f32_16x16x32_bf16 v[16:19], a[68:71], v[68:71], v[16:19]
    v_mfma_f32_16x16x32_bf16 v[20:23], a[132:135], v[68:71], v[20:23]
    v_mfma_f32_16x16x32_bf16 v[24:27], a[196:199], v[68:71], v[24:27]
    buffer_load_dwordx4 v[40:43], v6, s[12:15], s20 offen
    s_waitcnt lgkmcnt(13)
    v_mfma_f32_16x16x32_bf16 v[12:15], a[8:11], v[72:75], v[12:15]
    v_mfma_f32_16x16x32_bf16 v[16:19], a[72:75], v[72:75], v[16:19]
    v_mfma_f32_16x16x32_bf16 v[20:23], a[136:139], v[72:75], v[20:23]
    v_mfma_f32_16x16x32_bf16 v[24:27], a[200:203], v[72:75], v[24:27]
    buffer_load_dwordx4 v[44:47], v6, s[12:15], s24 offen
    s_waitcnt lgkmcnt(12)
    v_mfma_f32_16x16x32_bf16 v[12:15], a[12:15], v[76:79], v[12:15]
    v_mfma_f32_16x16x32_bf16 v[16:19], a[76:79], v[76:79], v[16:19]
    v_mfma_f32_16x16x32_bf16 v[20:23], a[140:143], v[76:79], v[20:23]
    v_mfma_f32_16x16x32_bf16 v[24:27], a[204:207], v[76:79], v[24:27]
    buffer_load_dwordx4 v[48:51], v6, s[12:15], s24 offen offset:1024
    s_waitcnt lgkmcnt(11)
    v_mfma_f32_16x16x32_bf16 v[12:15], a[16:19], v[80:83], v[12:15]
    v_mfma_f32_16x16x32_bf16 v[16:19], a[80:83], v[80:83], v[16:19]
    v_mfma_f32_16x16x32_bf16 v[20:23], a[144:147], v[80:83], v[20:23]
    v_mfma_f32_16x16x32_bf16 v[24:27], a[208:211], v[80:83], v[24:27]
    buffer_load_dword v3, s[12:15], s33 offen lds
    s_waitcnt lgkmcnt(10)
    v_mfma_f32_16x16x32_bf16 v[12:15], a[20:23], v[84:87], v[12:15]
    v_mfma_f32_16x16x32_bf16 v[16:19], a[84:87], v[84:87], v[16:19]
    v_mfma_f32_16x16x32_bf16 v[20:23], a[148:151], v[84:87], v[20:23]
    v_mfma_f32_16x16x32_bf16 v[24:27], a[212:215], v[84:87], v[24:27]
    buffer_store_dwordx4 v[28:31], v6, s[12:15], s47 offen sc1
    s_waitcnt lgkmcnt(9)
    v_mfma_f32_16x16x32_bf16 v[12:15], a[24:27], v[88:91], v[12:15]
    v_mfma_f32_16x16x32_bf16 v[16:19], a[88:91], v[88:91], v[16:19]
    v_mfma_f32_16x16x32_bf16 v[20:23], a[152:155], v[88:91], v[20:23]
    v_mfma_f32_16x16x32_bf16 v[24:27], a[216:219], v[88:91], v[24:27]
    buffer_store_dword v52, off, s[12:15], s32 sc1
    s_waitcnt lgkmcnt(8)
    v_mfma_f32_16x16x32_bf16 v[12:15], a[28:31], v[92:95], v[12:15]
    v_mfma_f32_16x16x32_bf16 v[16:19], a[92:95], v[92:95], v[16:19]
    v_mfma_f32_16x16x32_bf16 v[20:23], a[156:159], v[92:95], v[20:23]
    v_mfma_f32_16x16x32_bf16 v[24:27], a[220:223], v[92:95], v[24:27]
    s_waitcnt lgkmcnt(7)
    v_mfma_f32_16x16x32_bf16 v[12:15], a[32:35], v[96:99], v[12:15]
    v_mfma_f32_16x16x32_bf16 v[16:19], a[96:99], v[96:99], v[16:19]
    v_mfma_f32_16x16x32_bf16 v[20:23], a[160:163], v[96:99], v[20:23]
    v_mfma_f32_16x16x32_bf16 v[24:27], a[224:227], v[96:99], v[24:27]
    s_waitcnt lgkmcnt(6)
    v_mfma_f32_16x16x32_bf16 v[12:15], a[36:39], v[100:103], v[12:15]
    v_mfma_f32_16x16x32_bf16 v[16:19], a[100:103], v[100:103], v[16:19]
    v_mfma_f32_16x16x32_bf16 v[20:23], a[164:167], v[100:103], v[20:23]
    v_mfma_f32_16x16x32_bf16 v[24:27], a[228:231], v[100:103], v[24:27]
    s_waitcnt lgkmcnt(5)
    v_mfma_f32_16x16x32_bf16 v[12:15], a[40:43], v[104:107], v[12:15]
    v_mfma_f32_16x16x32_bf16 v[16:19], a[104:107], v[104:107], v[16:19]
    v_mfma_f32_16x16x32_bf16 v[20:23], a[168:171], v[104:107], v[20:23]
    v_mfma_f32_16x16x32_bf16 v[24:27], a[232:235], v[104:107], v[24:27]
    s_waitcnt lgkmcnt(4)
    v_mfma_f32_16x16x32_bf16 v[12:15], a[44:47], v[108:111], v[12:15]
    v_mfma_f32_16x16x32_bf16 v[16:19], a[108:111], v[108:111], v[16:19]
    v_mfma_f32_16x16x32_bf16 v[20:23], a[172:175], v[108:111], v[20:23]
    v_mfma_f32_16x16x32_bf16 v[24:27], a[236:239], v[108:111], v[24:27]
    s_waitcnt lgkmcnt(3)
    v_mfma_f32_16x16x32_bf16 v[12:15], a[48:51], v[112:115], v[12:15]
    v_mfma_f32_16x16x32_bf16 v[16:19], a[112:115], v[112:115], v[16:19]
    v_mfma_f32_16x16x32_bf16 v[20:23], a[176:179], v[112:115], v[20:23]
    v_mfma_f32_16x16x32_bf16 v[24:27], a[240:243], v[112:115], v[24:27]
    s_waitcnt lgkmcnt(2)
    v_mfma_f32_16x16x32_bf16 v[12:15], a[52:55], v[116:119], v[12:15]
    v_mfma_f32_16x16x32_bf16 v[16:19], a[116:119], v[116:119], v[16:19]
    v_mfma_f32_16x16x32_bf16 v[20:23], a[180:183], v[116:119], v[20:23]
    v_mfma_f32_16x16x32_bf16 v[24:27], a[244:247], v[116:119], v[24:27]
    s_waitcnt lgkmcnt(1)
    v_mfma_f32_16x16x32_bf16 v[12:15], a[56:59], v[120:123], v[12:15]
    v_mfma_f32_16x16x32_bf16 v[16:19], a[120:123], v[120:123], v[16:19]
    v_mfma_f32_16x16x32_bf16 v[20:23], a[184:187], v[120:123], v[20:23]
    v_mfma_f32_16x16x32_bf16 v[24:27], a[248:251], v[120:123], v[24:27]
    s_waitcnt lgkmcnt(0)
    v_mfma_f32_16x16x32_bf16 v[12:15], a[60:63], v[124:127], v[12:15]
    v_mfma_f32_16x16x32_bf16 v[16:19], a[124:127], v[124:127], v[16:19]
    v_mfma_f32_16x16x32_bf16 v[20:23], a[188:191], v[124:127], v[20:23]
    v_mfma_f32_16x16x32_bf16 v[24:27], a[252:255], v[124:127], v[24:27]
    v_mfma_f32_16x16x32_bf16 v[28:31], v[64:67], v[128:131], 0
    v_mfma_f32_16x16x32_bf16 v[32:35], v[64:67], v[192:195], 0
    s_nop 5
    v_cvt_pk_bf16_f32 v52, v12, v13
    v_cvt_pk_bf16_f32 v53, v14, v15
    v_cvt_pk_bf16_f32 v54, v16, v17
    v_cvt_pk_bf16_f32 v55, v18, v19
    v_cvt_pk_bf16_f32 v56, v20, v21
    v_cvt_pk_bf16_f32 v57, v22, v23
    v_cvt_pk_bf16_f32 v58, v24, v25
    v_cvt_pk_bf16_f32 v59, v26, v27
    s_waitcnt vmcnt(5)
    buffer_store_dwordx4 v[56:59], v6, s[12:15], s25 offen sc1
    v_mfma_f32_16x16x32_bf16 v[12:15], v[56:59], v[52:55], 0
    v_mfma_f32_16x16x32_bf16 v[16:19], v[36:39], v[52:55], 0
    v_mfma_f32_16x16x32_bf16 v[20:23], v[40:43], v[52:55], 0
    v_mfma_f32_16x16x32_bf16 v[28:31], v[68:71], v[132:135], v[28:31]
    v_mfma_f32_16x16x32_bf16 v[32:35], v[68:71], v[196:199], v[32:35]
    s_nop 5
    ds_write_b128 v2, v[12:15] offset:0
    ds_write_b128 v2, v[16:19] offset:1024
    ds_write_b128 v2, v[20:23] offset:2048
    s_waitcnt lgkmcnt(0)
    s_barrier
    ds_read_b128 v[12:15], v1 offset:0
    ds_read_b64 v[16:17], v4 offset:0
    ds_read_b128 v[18:21], v1 offset:3072
    ds_read_b64 v[22:23], v4 offset:3072
    ds_read_b128 v[36:39], v1 offset:6144
    ds_read_b64 v[40:41], v4 offset:6144
    ds_read_b128 v[52:55], v1 offset:9216
    ds_read_b64 v[56:57], v4 offset:9216
    v_mfma_f32_16x16x32_bf16 v[28:31], v[72:75], v[136:139], v[28:31]
    v_mfma_f32_16x16x32_bf16 v[32:35], v[72:75], v[200:203], v[32:35]
    v_mfma_f32_16x16x32_bf16 v[28:31], v[76:79], v[140:143], v[28:31]
    v_mfma_f32_16x16x32_bf16 v[32:35], v[76:79], v[204:207], v[32:35]
    s_waitcnt lgkmcnt(4)
    v_pk_add_f32 v[12:13], v[12:13], v[18:19]
    v_pk_add_f32 v[14:15], v[14:15], v[20:21]
    v_pk_add_f32 v[16:17], v[16:17], v[22:23]
    s_waitcnt lgkmcnt(2)
    v_pk_add_f32 v[12:13], v[12:13], v[36:37]
    v_pk_add_f32 v[14:15], v[14:15], v[38:39]
    v_pk_add_f32 v[16:17], v[16:17], v[40:41]
    s_waitcnt lgkmcnt(0)
    v_pk_add_f32 v[12:13], v[12:13], v[52:53]
    v_pk_add_f32 v[14:15], v[14:15], v[54:55]
    v_pk_add_f32 v[16:17], v[16:17], v[56:57]
    v_cvt_pk_bf16_f32 v24, v12, v13
    v_lshlrev_b32 v12, 16, v24
    v_and_b32 v13, 0xffff0000, v24
    v_mfma_f32_16x16x32_bf16 v[28:31], v[80:83], v[144:147], v[28:31]
    v_cvt_pk_bf16_f32 v24, v14, v15
    v_lshlrev_b32 v14, 16, v24
    v_and_b32 v15, 0xffff0000, v24
    v_mfma_f32_16x16x32_bf16 v[32:35], v[80:83], v[208:211], v[32:35]
    v_cvt_pk_bf16_f32 v24, v16, v17
    v_lshlrev_b32 v16, 16, v24
    v_and_b32 v17, 0xffff0000, v24
    v_mfma_f32_16x16x32_bf16 v[28:31], v[84:87], v[148:151], v[28:31]
    v_pk_mul_f32 v[12:13], v[12:13], s[34:35]
    v_pk_mul_f32 v[14:15], v[14:15], s[34:35]
    v_pk_mul_f32 v[16:17], v[16:17], s[34:35]
    v_mfma_f32_16x16x32_bf16 v[32:35], v[84:87], v[212:215], v[32:35]
    v_cvt_pk_bf16_f32 v24, v12, v13
    v_lshlrev_b32 v12, 16, v24
    v_and_b32 v13, 0xffff0000, v24
    v_mfma_f32_16x16x32_bf16 v[28:31], v[88:91], v[152:155], v[28:31]
    v_cvt_pk_bf16_f32 v24, v14, v15
    v_lshlrev_b32 v14, 16, v24
    v_and_b32 v15, 0xffff0000, v24
    v_mfma_f32_16x16x32_bf16 v[32:35], v[88:91], v[216:219], v[32:35]
    v_cvt_pk_bf16_f32 v24, v16, v17
    v_lshlrev_b32 v16, 16, v24
    v_and_b32 v17, 0xffff0000, v24
    v_mfma_f32_16x16x32_bf16 v[28:31], v[92:95], v[156:159], v[28:31]
    v_mov_b32 v24, 0xff800000
    v_cndmask_b32 v12, v12, v24, s[40:41]
    v_cndmask_b32 v13, v13, v24, s[40:41]
    v_mfma_f32_16x16x32_bf16 v[32:35], v[92:95], v[220:223], v[32:35]
    v_cndmask_b32 v14, v14, v24, s[40:41]
    v_cndmask_b32 v15, v15, v24, s[40:41]
    v_max3_f32 v24, v12, v13, v14
    v_mfma_f32_16x16x32_bf16 v[28:31], v[96:99], v[160:163], v[28:31]
    v_max3_f32 v24, v24, v15, v16
    v_max_f32 v24, v24, v17
    s_nop 1
    v_mfma_f32_16x16x32_bf16 v[32:35], v[96:99], v[224:227], v[32:35]
    v_max_f32_dpp v24, v24, v24 row_ror:8 row_mask:0xf bank_mask:0xf
    v_mov_b32 v25, v24
    v_mov_b32 v26, v24
    v_mfma_f32_16x16x32_bf16 v[28:31], v[100:103], v[164:167], v[28:31]
    s_nop 1
    v_permlane16_swap_b32 v25, v26
    s_nop 1
    v_mfma_f32_16x16x32_bf16 v[32:35], v[100:103], v[228:231], v[32:35]
    v_max_f32 v24, v25, v26
    v_mov_b32 v25, v24
    v_mov_b32 v26, v24
    v_mfma_f32_16x16x32_bf16 v[28:31], v[104:107], v[168:171], v[28:31]
    s_nop 1
    v_permlane32_swap_b32 v25, v26
    s_nop 1
    v_mfma_f32_16x16x32_bf16 v[32:35], v[104:107], v[232:235], v[32:35]
    v_max_f32 v24, v25, v26
    v_sub_f32 v12, v12, v24
    v_sub_f32 v13, v13, v24
    v_mfma_f32_16x16x32_bf16 v[28:31], v[108:111], v[172:175], v[28:31]
    v_sub_f32 v14, v14, v24
    v_sub_f32 v15, v15, v24
    v_sub_f32 v16, v16, v24
    v_mfma_f32_16x16x32_bf16 v[32:35], v[108:111], v[236:239], v[32:35]
    v_sub_f32 v17, v17, v24
    v_pk_mul_f32 v[12:13], v[12:13], s[36:37]
    v_pk_mul_f32 v[14:15], v[14:15], s[36:37]
    v_mfma_f32_16x16x32_bf16 v[28:31], v[112:115], v[176:179], v[28:31]
    v_pk_mul_f32 v[16:17], v[16:17], s[36:37]
    v_exp_f32 v12, v12
    v_exp_f32 v13, v13
    v_mfma_f32_16x16x32_bf16 v[32:35], v[112:115], v[240:243], v[32:35]
    v_exp_f32 v14, v14
    v_exp_f32 v15, v15
    v_exp_f32 v16, v16
    v_mfma_f32_16x16x32_bf16 v[28:31], v[116:119], v[180:183], v[28:31]
    v_exp_f32 v17, v17
    s_nop 0
    v_add_f32 v24, v12, v13
    v_mfma_f32_16x16x32_bf16 v[32:35], v[116:119], v[244:247], v[32:35]
    v_add_f32 v24, v24, v14
    v_add_f32 v24, v24, v15
    v_add_f32 v24, v24, v16
    v_mfma_f32_16x16x32_bf16 v[28:31], v[120:123], v[184:187], v[28:31]
    v_add_f32 v24, v24, v17
    s_nop 1
    v_add_f32_dpp v24, v24, v24 row_ror:8 row_mask:0xf bank_mask:0xf
    v_mfma_f32_16x16x32_bf16 v[32:35], v[120:123], v[248:251], v[32:35]
    v_mov_b32 v25, v24
    v_mov_b32 v26, v24
    s_nop 1
    v_mfma_f32_16x16x32_bf16 v[28:31], v[124:127], v[188:191], v[28:31]
    v_permlane16_swap_b32 v25, v26
    s_nop 1
    v_add_f32 v24, v25, v26
    v_mfma_f32_16x16x32_bf16 v[32:35], v[124:127], v[252:255], v[32:35]
    v_mov_b32 v25, v24
    v_mov_b32 v26, v24
    s_nop 1
    v_permlane32_swap_b32 v25, v26
    s_nop 1
    v_add_f32 v24, v25, v26
    v_rcp_f32 v24, v24
    s_nop 0
    v_mul_f32 v12, v12, v24
    v_mul_f32 v13, v13, v24
    v_mul_f32 v14, v14, v24
    v_mul_f32 v15, v15, v24
    v_mul_f32 v16, v16, v24
    v_mul_f32 v17, v17, v24
    v_cvt_pk_bf16_f32 v40, v12, v13
    v_cvt_pk_bf16_f32 v41, v14, v15
    v_cvt_pk_bf16_f32 v36, v16, v17
    v_mov_b32 v42, 0
    v_mov_b32 v43, 0
    v_mov_b32_dpp v37, v36 row_ror:8 row_mask:0xf bank_mask:0xf
    v_mov_b32_dpp v38, v40 row_ror:8 row_mask:0xf bank_mask:0xf
    v_mov_b32_dpp v39, v41 row_ror:8 row_mask:0xf bank_mask:0xf
    v_cvt_pk_bf16_f32 v52, v28, v29
    v_cvt_pk_bf16_f32 v53, v30, v31
    v_mov_b32 v54, 0
    v_mov_b32 v55, 0
    v_cvt_pk_bf16_f32 v56, v32, v33
    v_cvt_pk_bf16_f32 v57, v34, v35
    v_mov_b32 v58, 0
    v_mov_b32 v59, 0
    s_waitcnt vmcnt(4)
    v_mfma_f32_16x16x32_bf16 v[12:15], v[44:47], v[36:39], 0
    v_mfma_f32_16x16x32_bf16 v[16:19], v[48:51], v[36:39], 0
    v_mfma_f32_16x16x32_bf16 v[12:15], v[52:55], v[40:43], v[12:15]
    v_mfma_f32_16x16x32_bf16 v[16:19], v[56:59], v[40:43], v[16:19]
    v_mov_b32 v28, v52
    v_mov_b32 v29, v53
    v_mov_b32 v30, v56
    v_mov_b32 v31, v57
    s_cmp_eq_u32 s7, 63
    s_cbranch_scc1 rec_last
    ds_read_b128 v[64:67], v11 offset:0
    ds_read_b128 v[68:71], v11 offset:32768
    ds_read_b128 v[72:75], v0 offset:0
    ds_read_b128 v[76:79], v0 offset:32768
    ds_read_b128 v[80:83], v11 offset:1024
    ds_read_b128 v[84:87], v11 offset:33792
    ds_read_b128 v[88:91], v0 offset:1024
    ds_read_b128 v[92:95], v0 offset:33792
    s_add_u32 s23, s23, 0x40000
    s_add_u32 s24, s24, 0x40000
    s_add_u32 s25, s25, 0x20000
    s_add_u32 s26, s26, 0x20000
    v_cvt_pk_bf16_f32 v20, v12, v13
    v_cvt_pk_bf16_f32 v21, v14, v15
    v_cvt_pk_bf16_f32 v22, v16, v17
    v_cvt_pk_bf16_f32 v23, v18, v19
    ds_write_b128 v60, v[20:23]
    s_waitcnt lgkmcnt(0)
    s_barrier
    ds_read_b128 v[12:15], v61 offset:0
    ds_read_b128 v[16:19], v61 offset:1024
    ds_read_b128 v[20:23], v61 offset:2048
    ds_read_b128 v[24:27], v61 offset:3072
    s_mov_b32 s20, s27
    s_waitcnt lgkmcnt(0)
    s_cmp_lg_u32 s11, 0
    s_cbranch_scc1 rec_op_g
    v_mfma_f32_16x16x32_bf16 v[96:99], v[64:67], v[12:15], 0
    v_mfma_f32_16x16x32_bf16 v[96:99], v[68:71], v[16:19], v[96:99]
    v_mfma_f32_16x16x32_bf16 v[96:99], v[72:75], v[20:23], v[96:99]
    v_mfma_f32_16x16x32_bf16 v[96:99], v[76:79], v[24:27], v[96:99]
    ds_read_b128 v[64:67], v11 offset:2048
    ds_read_b128 v[68:71], v11 offset:34816
    ds_read_b128 v[72:75], v0 offset:2048
    ds_read_b128 v[76:79], v0 offset:34816
    v_mfma_f32_16x16x32_bf16 v[100:103], v[80:83], v[12:15], 0
    v_mfma_f32_16x16x32_bf16 v[100:103], v[84:87], v[16:19], v[100:103]
    v_mfma_f32_16x16x32_bf16 v[100:103], v[88:91], v[20:23], v[100:103]
    v_mfma_f32_16x16x32_bf16 v[100:103], v[92:95], v[24:27], v[100:103]
    ds_read_b128 v[80:83], v11 offset:3072
    ds_read_b128 v[84:87], v11 offset:35840
    ds_read_b128 v[88:91], v0 offset:3072
    ds_read_b128 v[92:95], v0 offset:35840
    s_waitcnt lgkmcnt(4)
    v_mfma_f32_16x16x32_bf16 v[104:107], v[64:67], v[12:15], 0
    v_mfma_f32_16x16x32_bf16 v[104:107], v[68:71], v[16:19], v[104:107]
    v_mfma_f32_16x16x32_bf16 v[104:107], v[72:75], v[20:23], v[104:107]
    v_mfma_f32_16x16x32_bf16 v[104:107], v[76:79], v[24:27], v[104:107]
    ds_read_b128 v[64:67], v11 offset:4096
    ds_read_b128 v[68:71], v11 offset:36864
    ds_read_b128 v[72:75], v0 offset:4096
    ds_read_b128 v[76:79], v0 offset:36864
    s_waitcnt lgkmcnt(4)
    v_mfma_f32_16x16x32_bf16 v[108:111], v[80:83], v[12:15], 0
    v_mfma_f32_16x16x32_bf16 v[108:111], v[84:87], v[16:19], v[108:111]
    v_mfma_f32_16x16x32_bf16 v[108:111], v[88:91], v[20:23], v[108:111]
    v_mfma_f32_16x16x32_bf16 v[108:111], v[92:95], v[24:27], v[108:111]
    ds_read_b128 v[80:83], v11 offset:5120
    ds_read_b128 v[84:87], v11 offset:37888
    ds_read_b128 v[88:91], v0 offset:5120
    ds_read_b128 v[92:95], v0 offset:37888
    v_mov_b32_dpp v96, v100 row_shr:8 row_mask:0xf bank_mask:0xc
    v_mov_b32_dpp v97, v101 row_shr:8 row_mask:0xf bank_mask:0xc
    v_mov_b32_dpp v98, v102 row_shr:8 row_mask:0xf bank_mask:0xc
    v_mov_b32_dpp v99, v103 row_shr:8 row_mask:0xf bank_mask:0xc
    v_and_or_b32 v96, v96, s38, v63
    v_and_or_b32 v97, v97, s38, v63
    v_and_or_b32 v98, v98, s38, v63
    v_and_or_b32 v99, v99, s38, v63
    buffer_store_dwordx4 v[96:99], v9, s[12:15], s20 offen
    s_add_u32 s20, s20, 32768
    s_waitcnt lgkmcnt(4)
    v_mfma_f32_16x16x32_bf16 v[112:115], v[64:67], v[12:15], 0
    v_mfma_f32_16x16x32_bf16 v[112:115], v[68:71], v[16:19], v[112:115]
    v_mfma_f32_16x16x32_bf16 v[112:115], v[72:75], v[20:23], v[112:115]
    v_mfma_f32_16x16x32_bf16 v[112:115], v[76:79], v[24:27], v[112:115]
    ds_read_b128 v[64:67], v11 offset:6144
    ds_read_b128 v[68:71], v11 offset:38912
    ds_read_b128 v[72:75], v0 offset:6144
    ds_read_b128 v[76:79], v0 offset:38912
    s_waitcnt lgkmcnt(4)
    v_mfma_f32_16x16x32_bf16 v[116:119], v[80:83], v[12:15], 0
    v_mfma_f32_16x16x32_bf16 v[116:119], v[84:87], v[16:19], v[116:119]
    v_mfma_f32_16x16x32_bf16 v[116:119], v[88:91], v[20:23], v[116:119]
    v_mfma_f32_16x16x32_bf16 v[116:119], v[92:95], v[24:27], v[116:119]
    ds_read_b128 v[80:83], v11 offset:7168
    ds_read_b128 v[84:87], v11 offset:39936
    ds_read_b128 v[88:91], v0 offset:7168
    ds_read_b128 v[92:95], v0 offset:39936
    v_mov_b32_dpp v104, v108 row_shr:8 row_mask:0xf bank_mask:0xc
    v_mov_b32_dpp v105, v109 row_shr:8 row_mask:0xf bank_mask:0xc
    v_mov_b32_dpp v106, v110 row_shr:8 row_mask:0xf bank_mask:0xc
    v_mov_b32_dpp v107, v111 row_shr:8 row_mask:0xf bank_mask:0xc
    v_and_or_b32 v104, v104, s38, v63
    v_and_or_b32 v105, v105, s38, v63
    v_and_or_b32 v106, v106, s38, v63
    v_and_or_b32 v107, v107, s38, v63
    buffer_store_dwordx4 v[104:107], v9, s[12:15], s20 offen
    s_add_u32 s20, s20, 32768
    s_waitcnt lgkmcnt(4)
    v_mfma_f32_16x16x32_bf16 v[120:123], v[64:67], v[12:15], 0
    v_mfma_f32_16x16x32_bf16 v[120:123], v[68:71], v[16:19], v[120:123]
    v_mfma_f32_16x16x32_bf16 v[120:123], v[72:75], v[20:23], v[120:123]
    v_mfma_f32_16x16x32_bf16 v[120:123], v[76:79], v[24:27], v[120:123]
    s_waitcnt lgkmcnt(0)
    v_mfma_f32_16x16x32_bf16 v[124:127], v[80:83], v[12:15], 0
    v_mfma_f32_16x16x32_bf16 v[124:127], v[84:87], v[16:19], v[124:127]
    v_mfma_f32_16x16x32_bf16 v[124:127], v[88:91], v[20:23], v[124:127]
    v_mfma_f32_16x16x32_bf16 v[124:127], v[92:95], v[24:27], v[124:127]
    v_mov_b32_dpp v112, v116 row_shr:8 row_mask:0xf bank_mask:0xc
    v_mov_b32_dpp v113, v117 row_shr:8 row_mask:0xf bank_mask:0xc
    v_mov_b32_dpp v114, v118 row_shr:8 row_mask:0xf bank_mask:0xc
    v_mov_b32_dpp v115, v119 row_shr:8 row_mask:0xf bank_mask:0xc
    v_and_or_b32 v112, v112, s38, v63
    v_and_or_b32 v113, v113, s38, v63
    v_and_or_b32 v114, v114, s38, v63
    v_and_or_b32 v115, v115, s38, v63
    buffer_store_dwordx4 v[112:115], v9, s[12:15], s20 offen
    s_add_u32 s20, s20, 32768
    s_nop 7
    v_mov_b32_dpp v120, v124 row_shr:8 row_mask:0xf bank_mask:0xc
    v_mov_b32_dpp v121, v125 row_shr:8 row_mask:0xf bank_mask:0xc
    v_mov_b32_dpp v122, v126 row_shr:8 row_mask:0xf bank_mask:0xc
    v_mov_b32_dpp v123, v127 row_shr:8 row_mask:0xf bank_mask:0xc
    v_and_or_b32 v120, v120, s38, v63
    v_and_or_b32 v121, v121, s38, v63
    v_and_or_b32 v122, v122, s38, v63
    v_and_or_b32 v123, v123, s38, v63
    buffer_store_dwordx4 v[120:123], v9, s[12:15], s20 offen
    s_add_u32 s20, s20, 32768
    s_branch rec_op_e
rec_op_g:
    v_mfma_f32_16x16x32_bf16 v[96:99], v[64:67], v[12:15], 0
    v_mfma_f32_16x16x32_bf16 v[96:99], v[68:71], v[16:19], v[96:99]
    v_mfma_f32_16x16x32_bf16 v[96:99], v[72:75], v[20:23], v[96:99]
    v_mfma_f32_16x16x32_bf16 v[96:99], v[76:79], v[24:27], v[96:99]
    ds_read_b128 v[64:67], v11 offset:2048
    ds_read_b128 v[68:71], v11 offset:34816
    ds_read_b128 v[72:75], v0 offset:2048
    ds_read_b128 v[76:79], v0 offset:34816
    v_mfma_f32_16x16x32_bf16 v[100:103], v[80:83], v[12:15], 0
    v_mfma_f32_16x16x32_bf16 v[100:103], v[84:87], v[16:19], v[100:103]
    v_mfma_f32_16x16x32_bf16 v[100:103], v[88:91], v[20:23], v[100:103]
    v_mfma_f32_16x16x32_bf16 v[100:103], v[92:95], v[24:27], v[100:103]
    ds_read_b128 v[80:83], v11 offset:3072
    ds_read_b128 v[84:87], v11 offset:35840
    ds_read_b128 v[88:91], v0 offset:3072
    ds_read_b128 v[92:95], v0 offset:35840
    s_waitcnt lgkmcnt(4)
    v_mfma_f32_16x16x32_bf16 v[104:107], v[64:67], v[12:15], 0
    v_mfma_f32_16x16x32_bf16 v[104:107], v[68:71], v[16:19], v[104:107]
    v_mfma_f32_16x16x32_bf16 v[104:107], v[72:75], v[20:23], v[104:107]
    v_mfma_f32_16x16x32_bf16 v[104:107], v[76:79], v[24:27], v[104:107]
    ds_read_b128 v[64:67], v11 offset:4096
    ds_read_b128 v[68:71], v11 offset:36864
    ds_read_b128 v[72:75], v0 offset:4096
    ds_read_b128 v[76:79], v0 offset:36864
    s_waitcnt lgkmcnt(4)
    v_mfma_f32_16x16x32_bf16 v[108:111], v[80:83], v[12:15], 0
    v_mfma_f32_16x16x32_bf16 v[108:111], v[84:87], v[16:19], v[108:111]
    v_mfma_f32_16x16x32_bf16 v[108:111], v[88:91], v[20:23], v[108:111]
    v_mfma_f32_16x16x32_bf16 v[108:111], v[92:95], v[24:27], v[108:111]
    ds_read_b128 v[80:83], v11 offset:5120
    ds_read_b128 v[84:87], v11 offset:37888
    ds_read_b128 v[88:91], v0 offset:5120
    ds_read_b128 v[92:95], v0 offset:37888
    v_mov_b32_dpp v96, v100 row_shr:8 row_mask:0xf bank_mask:0xc
    v_mov_b32_dpp v97, v101 row_shr:8 row_mask:0xf bank_mask:0xc
    v_mov_b32_dpp v98, v102 row_shr:8 row_mask:0xf bank_mask:0xc
    v_mov_b32_dpp v99, v103 row_shr:8 row_mask:0xf bank_mask:0xc
    v_and_or_b32 v96, v96, s38, v63
    v_and_or_b32 v97, v97, s38, v63
    v_and_or_b32 v98, v98, s38, v63
    v_and_or_b32 v99, v99, s38, v63
    buffer_store_dwordx4 v[96:99], v9, s[12:15], s20 offen sc1
    s_add_u32 s20, s20, 32768
    s_waitcnt lgkmcnt(4)
    v_mfma_f32_16x16x32_bf16 v[112:115], v[64:67], v[12:15], 0
    v_mfma_f32_16x16x32_bf16 v[112:115], v[68:71], v[16:19], v[112:115]
    v_mfma_f32_16x16x32_bf16 v[112:115], v[72:75], v[20:23], v[112:115]
    v_mfma_f32_16x16x32_bf16 v[112:115], v[76:79], v[24:27], v[112:115]
    ds_read_b128 v[64:67], v11 offset:6144
    ds_read_b128 v[68:71], v11 offset:38912
    ds_read_b128 v[72:75], v0 offset:6144
    ds_read_b128 v[76:79], v0 offset:38912
    s_waitcnt lgkmcnt(4)
    v_mfma_f32_16x16x32_bf16 v[116:119], v[80:83], v[12:15], 0
    v_mfma_f32_16x16x32_bf16 v[116:119], v[84:87], v[16:19], v[116:119]
    v_mfma_f32_16x16x32_bf16 v[116:119], v[88:91], v[20:23], v[116:119]
    v_mfma_f32_16x16x32_bf16 v[116:119], v[92:95], v[24:27], v[116:119]
    ds_read_b128 v[80:83], v11 offset:7168
    ds_read_b128 v[84:87], v11 offset:39936
    ds_read_b128 v[88:91], v0 offset:7168
    ds_read_b128 v[92:95], v0 offset:39936
    v_mov_b32_dpp v104, v108 row_shr:8 row_mask:0xf bank_mask:0xc
    v_mov_b32_dpp v105, v109 row_shr:8 row_mask:0xf bank_mask:0xc
    v_mov_b32_dpp v106, v110 row_shr:8 row_mask:0xf bank_mask:0xc
    v_mov_b32_dpp v107, v111 row_shr:8 row_mask:0xf bank_mask:0xc
    v_and_or_b32 v104, v104, s38, v63
    v_and_or_b32 v105, v105, s38, v63
    v_and_or_b32 v106, v106, s38, v63
    v_and_or_b32 v107, v107, s38, v63
    buffer_store_dwordx4 v[104:107], v9, s[12:15], s20 offen sc1
    s_add_u32 s20, s20, 32768
    s_waitcnt lgkmcnt(4)
    v_mfma_f32_16x16x32_bf16 v[120:123], v[64:67], v[12:15], 0
    v_mfma_f32_16x16x32_bf16 v[120:123], v[68:71], v[16:19], v[120:123]
    v_mfma_f32_16x16x32_bf16 v[120:123], v[72:75], v[20:23], v[120:123]
    v_mfma_f32_16x16x32_bf16 v[120:123], v[76:79], v[24:27], v[120:123]
    s_waitcnt lgkmcnt(0)
    v_mfma_f32_16x16x32_bf16 v[124:127], v[80:83], v[12:15], 0
    v_mfma_f32_16x16x32_bf16 v[124:127], v[84:87], v[16:19], v[124:127]
    v_mfma_f32_16x16x32_bf16 v[124:127], v[88:91], v[20:23], v[124:127]
    v_mfma_f32_16x16x32_bf16 v[124:127], v[92:95], v[24:27], v[124:127]
    v_mov_b32_dpp v112, v116 row_shr:8 row_mask:0xf bank_mask:0xc
    v_mov_b32_dpp v113, v117 row_shr:8 row_mask:0xf bank_mask:0xc
    v_mov_b32_dpp v114, v118 row_shr:8 row_mask:0xf bank_mask:0xc
    v_mov_b32_dpp v115, v119 row_shr:8 row_mask:0xf bank_mask:0xc
    v_and_or_b32 v112, v112, s38, v63
    v_and_or_b32 v113, v113, s38, v63
    v_and_or_b32 v114, v114, s38, v63
    v_and_or_b32 v115, v115, s38, v63
    buffer_store_dwordx4 v[112:115], v9, s[12:15], s20 offen sc1
    s_add_u32 s20, s20, 32768
    s_nop 7
    v_mov_b32_dpp v120, v124 row_shr:8 row_mask:0xf bank_mask:0xc
    v_mov_b32_dpp v121, v125 row_shr:8 row_mask:0xf bank_mask:0xc
    v_mov_b32_dpp v122, v126 row_shr:8 row_mask:0xf bank_mask:0xc
    v_mov_b32_dpp v123, v127 row_shr:8 row_mask:0xf bank_mask:0xc
    v_and_or_b32 v120, v120, s38, v63
    v_and_or_b32 v121, v121, s38, v63
    v_and_or_b32 v122, v122, s38, v63
    v_and_or_b32 v123, v123, s38, v63
    buffer_store_dwordx4 v[120:123], v9, s[12:15], s20 offen sc1
    s_add_u32 s20, s20, 32768
rec_op_e:
    s_mov_b32 s30, 0
rec_rpoll:
    buffer_load_dwordx4 v[64:67], v6, s[12:15], s28 offen offset:0 sc1
    buffer_load_dwordx4 v[68:71], v6, s[12:15], s28 offen offset:1024 sc1
    buffer_load_dwordx4 v[72:75], v6, s[12:15], s28 offen offset:2048 sc1
    buffer_load_dwordx4 v[76:79], v6, s[12:15], s28 offen offset:3072 sc1
    s_waitcnt vmcnt(0)
    v_or3_b32 v52, v64, v65, v66
    v_or3_b32 v52, v52, v67, v68
    v_or3_b32 v52, v52, v69, v70
    v_or3_b32 v52, v52, v71, v72
    v_or3_b32 v52, v52, v73, v74
    v_or3_b32 v52, v52, v75, v76
    v_or3_b32 v52, v52, v77, v78
    v_or_b32 v52, v52, v79
    v_and_b32 v52, s39, v52
    v_cmp_ne_u32 vcc, 0, v52
    s_cbranch_vccz rec_rpoll_ok
    s_add_u32 s30, s30, 1
    s_cmp_lt_u32 s30, 200000
    s_cbranch_scc1 rec_rpoll
rec_rpoll_ok:
    v_add_f32 v12, v64, v68
    v_add_f32 v13, v65, v69
    v_add_f32 v14, v66, v70
    v_add_f32 v15, v67, v71
    v_add_f32 v12, v12, v72
    v_add_f32 v13, v13, v73
    v_add_f32 v14, v14, v74
    v_add_f32 v15, v15, v75
    v_add_f32 v12, v12, v76
    v_add_f32 v13, v13, v77
    v_add_f32 v14, v14, v78
    v_add_f32 v15, v15, v79
    s_nop 0
    v_add_f32_dpp v12, v12, v12 row_ror:8 row_mask:0xf bank_mask:0xf
    v_add_f32_dpp v13, v13, v13 row_ror:8 row_mask:0xf bank_mask:0xf
    v_add_f32_dpp v14, v14, v14 row_ror:8 row_mask:0xf bank_mask:0xf
    v_add_f32_dpp v15, v15, v15 row_ror:8 row_mask:0xf bank_mask:0xf
    v_mov_b32 v16, v12
    v_mov_b32 v17, v13
    v_mov_b32 v18, v14
    v_mov_b32 v19, v15
    s_nop 0
    v_permlane16_swap_b32 v12, v16
    v_permlane16_swap_b32 v13, v17
    v_permlane16_swap_b32 v14, v18
    v_permlane16_swap_b32 v15, v19
    s_nop 0
    v_add_f32 v12, v12, v16
    v_add_f32 v13, v13, v17
    v_add_f32 v14, v14, v18
    v_add_f32 v15, v15, v19
    v_mov_b32 v16, v12
    v_mov_b32 v17, v13
    v_mov_b32 v18, v14
    v_mov_b32 v19, v15
    s_nop 0
    v_permlane32_swap_b32 v12, v16
    v_permlane32_swap_b32 v13, v17
    v_permlane32_swap_b32 v14, v18
    v_permlane32_swap_b32 v15, v19
    s_nop 0
    v_add_f32 v12, v12, v16
    v_add_f32 v13, v13, v17
    v_add_f32 v14, v14, v18
    v_add_f32 v15, v15, v19
    v_cvt_pk_bf16_f32 v16, v12, v13
    v_cvt_pk_bf16_f32 v17, v14, v15
    s_add_u32 s20, s22, s29
    s_cmp_lg_u32 s11, 0
    s_cbranch_scc1 rec_pub_g
    buffer_store_dwordx2 v[16:17], v10, s[12:15], s20 offen
    s_branch rec_pub_e
rec_pub_g:
    buffer_store_dwordx2 v[16:17], v10, s[12:15], s20 offen sc1
rec_pub_e:
    s_add_u32 s7, s7, 1
rec_next:
    s_add_u32 s22, s22, 8192
    s_xor_b32 s27, s27, 0x80000
    s_xor_b32 s28, s28, 0x80000
    s_branch rec_step
rec_last:
    buffer_store_dwordx4 v[28:31], v6, s[12:15], s26 offen sc1
    s_waitcnt vmcnt(0)
    v_mov_b32 v18, 64
    buffer_store_dword v18, off, s[12:15], s32 sc1
    s_branch main_end
main_helper:
    v_and_b32 v3, 15, v2
    v_lshrrev_b32 v4, 4, v2
    v_lshlrev_b32 v5, 10, v3
    v_lshl_add_u32 v5, v4, 4, v5
    v_lshlrev_b32 v6, 4, v2
    s_lshl_b32 s25, s3, 15
    v_add_u32 v7, s25, v6
    v_add_u32 v9, 0x10000, v6
    s_mov_b32 s8, s9
h_task:
    s_cmp_lt_u32 s8, 512
    s_cbranch_scc0 h_task_q
    s_lshr_b32 s6, s8, 5
    s_and_b32 s26, s8, 31
    s_lshl_b32 s26, s26, 2
    s_add_u32 s26, s26, 64
    s_mov_b32 s36, 126616064
    s_branch h_task_d
h_task_q:
    s_sub_u32 s26, s8, 512
    s_lshr_b32 s6, s26, 4
    s_and_b32 s26, s26, 15
    s_lshl_b32 s26, s26, 2
    s_mov_b32 s36, 126616128
h_task_d:
    s_lshl_b32 s20, s6, 2
    s_add_u32 s36, s36, s20
    s_add_u32 s26, s26, s3
    s_mov_b32 s27, 0
    s_lshl_b32 s28, s26, 16
    s_add_u32 s28, s28, 4194304
    s_add_u32 s29, s28, 16384
    s_add_u32 s30, s28, 32768
    s_add_u32 s31, s28, 49152
    s_lshl_b32 s24, s6, 17
    s_add_u32 s24, s24, s25
    s_add_u32 s24, s24, 1048576
    buffer_load_dwordx4 v[64:67], v6, s[12:15], s24 offen offset:0
    buffer_load_dwordx4 v[68:71], v6, s[12:15], s24 offen offset:1024
    buffer_load_dwordx4 v[72:75], v6, s[12:15], s24 offen offset:2048
    buffer_load_dwordx4 v[76:79], v6, s[12:15], s24 offen offset:3072
    s_add_u32 s24, s24, 4096
    buffer_load_dwordx4 v[80:83], v6, s[12:15], s24 offen offset:0
    buffer_load_dwordx4 v[84:87], v6, s[12:15], s24 offen offset:1024
    buffer_load_dwordx4 v[88:91], v6, s[12:15], s24 offen offset:2048
    buffer_load_dwordx4 v[92:95], v6, s[12:15], s24 offen offset:3072
    s_add_u32 s24, s24, 4096
    buffer_load_dwordx4 v[96:99], v6, s[12:15], s24 offen offset:0
    buffer_load_dwordx4 v[100:103], v6, s[12:15], s24 offen offset:1024
    buffer_load_dwordx4 v[104:107], v6, s[12:15], s24 offen offset:2048
    buffer_load_dwordx4 v[108:111], v6, s[12:15], s24 offen offset:3072
    s_add_u32 s24, s24, 4096
    buffer_load_dwordx4 v[112:115], v6, s[12:15], s24 offen offset:0
    buffer_load_dwordx4 v[116:119], v6, s[12:15], s24 offen offset:1024
    buffer_load_dwordx4 v[120:123], v6, s[12:15], s24 offen offset:2048
    buffer_load_dwordx4 v[124:127], v6, s[12:15], s24 offen offset:3072
    s_add_u32 s24, s24, 4096
    buffer_load_dwordx4 v[128:131], v6, s[12:15], s24 offen offset:0
    buffer_load_dwordx4 v[132:135], v6, s[12:15], s24 offen offset:1024
    buffer_load_dwordx4 v[136:139], v6, s[12:15], s24 offen offset:2048
    buffer_load_dwordx4 v[140:143], v6, s[12:15], s24 offen offset:3072
    s_add_u32 s24, s24, 4096
    buffer_load_dwordx4 v[144:147], v6, s[12:15], s24 offen offset:0
    buffer_load_dwordx4 v[148:151], v6, s[12:15], s24 offen offset:1024
    buffer_load_dwordx4 v[152:155], v6, s[12:15], s24 offen offset:2048
    buffer_load_dwordx4 v[156:159], v6, s[12:15], s24 offen offset:3072
    s_add_u32 s24, s24, 4096
    buffer_load_dwordx4 v[160:163], v6, s[12:15], s24 offen offset:0
    buffer_load_dwordx4 v[164:167], v6, s[12:15], s24 offen offset:1024
    buffer_load_dwordx4 v[168:171], v6, s[12:15], s24 offen offset:2048
    buffer_load_dwordx4 v[172:175], v6, s[12:15], s24 offen offset:3072
    s_add_u32 s24, s24, 4096
    buffer_load_dwordx4 v[176:179], v6, s[12:15], s24 offen offset:0
    buffer_load_dwordx4 v[180:183], v6, s[12:15], s24 offen offset:1024
    buffer_load_dwordx4 v[184:187], v6, s[12:15], s24 offen offset:2048
    buffer_load_dwordx4 v[188:191], v6, s[12:15], s24 offen offset:3072
    s_add_u32 s24, s24, 4096
    v_mov_b32 v8, v6
    buffer_load_dwordx4 a[0:3], v8, s[12:15], s28 offen
    buffer_load_dwordx4 a[4:7], v8, s[12:15], s29 offen
    buffer_load_dwordx4 a[8:11], v8, s[12:15], s30 offen
    buffer_load_dwordx4 a[12:15], v8, s[12:15], s31 offen
    v_add_u32 v8, 1024, v8
    buffer_load_dwordx4 a[16:19], v8, s[12:15], s28 offen
    buffer_load_dwordx4 a[20:23], v8, s[12:15], s29 offen
    buffer_load_dwordx4 a[24:27], v8, s[12:15], s30 offen
    buffer_load_dwordx4 a[28:31], v8, s[12:15], s31 offen
    v_add_u32 v8, 1024, v8
    buffer_load_dwordx4 a[32:35], v8, s[12:15], s28 offen
    buffer_load_dwordx4 a[36:39], v8, s[12:15], s29 offen
    buffer_load_dwordx4 a[40:43], v8, s[12:15], s30 offen
    buffer_load_dwordx4 a[44:47], v8, s[12:15], s31 offen
    v_add_u32 v8, 1024, v8
    buffer_load_dwordx4 a[48:51], v8, s[12:15], s28 offen
    buffer_load_dwordx4 a[52:55], v8, s[12:15], s29 offen
    buffer_load_dwordx4 a[56:59], v8, s[12:15], s30 offen
    buffer_load_dwordx4 a[60:63], v8, s[12:15], s31 offen
    v_add_u32 v8, 1024, v8
    buffer_load_dwordx4 a[64:67], v8, s[12:15], s28 offen
    buffer_load_dwordx4 a[68:71], v8, s[12:15], s29 offen
    buffer_load_dwordx4 a[72:75], v8, s[12:15], s30 offen
    buffer_load_dwordx4 a[76:79], v8, s[12:15], s31 offen
    v_add_u32 v8, 1024, v8
    buffer_load_dwordx4 a[80:83], v8, s[12:15], s28 offen
    buffer_load_dwordx4 a[84:87], v8, s[12:15], s29 offen
    buffer_load_dwordx4 a[88:91], v8, s[12:15], s30 offen
    buffer_load_dwordx4 a[92:95], v8, s[12:15], s31 offen
    v_add_u32 v8, 1024, v8
    buffer_load_dwordx4 a[96:99], v8, s[12:15], s28 offen
    buffer_load_dwordx4 a[100:103], v8, s[12:15], s29 offen
    buffer_load_dwordx4 a[104:107], v8, s[12:15], s30 offen
    buffer_load_dwordx4 a[108:111], v8, s[12:15], s31 offen
    v_add_u32 v8, 1024, v8
    s_waitcnt vmcnt(59)
    ds_write_b128 v7, v[64:67] offset:0
    s_waitcnt vmcnt(58)
    ds_write_b128 v7, v[68:71] offset:1024
    s_waitcnt vmcnt(57)
    ds_write_b128 v7, v[72:75] offset:2048
    s_waitcnt vmcnt(56)
    ds_write_b128 v7, v[76:79] offset:3072
    s_waitcnt vmcnt(55)
    ds_write_b128 v7, v[80:83] offset:4096
    s_waitcnt vmcnt(54)
    ds_write_b128 v7, v[84:87] offset:5120
    s_waitcnt vmcnt(53)
    ds_write_b128 v7, v[88:91] offset:6144
    s_waitcnt vmcnt(52)
    ds_write_b128 v7, v[92:95] offset:7168
    s_waitcnt vmcnt(51)
    ds_write_b128 v7, v[96:99] offset:8192
    s_waitcnt vmcnt(50)
    ds_write_b128 v7, v[100:103] offset:9216
    s_waitcnt vmcnt(49)
    ds_write_b128 v7, v[104:107] offset:10240
    s_waitcnt vmcnt(48)
    ds_write_b128 v7, v[108:111] offset:11264
    s_waitcnt vmcnt(47)
    ds_write_b128 v7, v[112:115] offset:12288
    s_waitcnt vmcnt(46)
    ds_write_b128 v7, v[116:119] offset:13312
    s_waitcnt vmcnt(45)
    ds_write_b128 v7, v[120:123] offset:14336
    s_waitcnt vmcnt(44)
    ds_write_b128 v7, v[124:127] offset:15360
    s_waitcnt vmcnt(43)
    ds_write_b128 v7, v[128:131] offset:16384
    s_waitcnt vmcnt(42)
    ds_write_b128 v7, v[132:135] offset:17408
    s_waitcnt vmcnt(41)
    ds_write_b128 v7, v[136:139] offset:18432
    s_waitcnt vmcnt(40)
    ds_write_b128 v7, v[140:143] offset:19456
    s_waitcnt vmcnt(39)
    ds_write_b128 v7, v[144:147] offset:20480
    s_waitcnt vmcnt(38)
    ds_write_b128 v7, v[148:151] offset:21504
    s_waitcnt vmcnt(37)
    ds_write_b128 v7, v[152:155] offset:22528
    s_waitcnt vmcnt(36)
    ds_write_b128 v7, v[156:159] offset:23552
    s_waitcnt vmcnt(35)
    ds_write_b128 v7, v[160:163] offset:24576
    s_waitcnt vmcnt(34)
    ds_write_b128 v7, v[164:167] offset:25600
    s_waitcnt vmcnt(33)
    ds_write_b128 v7, v[168:171] offset:26624
    s_waitcnt vmcnt(32)
    ds_write_b128 v7, v[172:175] offset:27648
    s_waitcnt vmcnt(31)
    ds_write_b128 v7, v[176:179] offset:28672
    s_waitcnt vmcnt(30)
    ds_write_b128 v7, v[180:183] offset:29696
    s_waitcnt vmcnt(29)
    ds_write_b128 v7, v[184:187] offset:30720
    s_waitcnt vmcnt(28)
    ds_write_b128 v7, v[188:191] offset:31744
    s_waitcnt lgkmcnt(0)
    s_barrier
qkv_group:
    ds_read_b128 v[64:67], v6 offset:0
    ds_read_b128 v[68:71], v6 offset:16384
    ds_read_b128 v[72:75], v6 offset:32768
    ds_read_b128 v[76:79], v6 offset:49152
    ds_read_b128 v[80:83], v9 offset:0
    ds_read_b128 v[84:87], v9 offset:16384
    ds_read_b128 v[88:91], v9 offset:32768
    ds_read_b128 v[92:95], v9 offset:49152
    s_cmp_ge_u32 s26, 128
    s_cbranch_scc1 qkv_vbody
    buffer_load_dwordx4 a[112:115], v8, s[12:15], s28 offen
    buffer_load_dwordx4 a[116:119], v8, s[12:15], s29 offen
    buffer_load_dwordx4 a[120:123], v8, s[12:15], s30 offen
    buffer_load_dwordx4 a[124:127], v8, s[12:15], s31 offen
    v_add_u32 v8, 1024, v8
    ds_read_b128 v[96:99], v6 offset:1024
    ds_read_b128 v[100:103], v6 offset:17408
    ds_read_b128 v[104:107], v6 offset:33792
    ds_read_b128 v[108:111], v6 offset:50176
    ds_read_b128 v[112:115], v9 offset:1024
    ds_read_b128 v[116:119], v9 offset:17408
    ds_read_b128 v[120:123], v9 offset:33792
    ds_read_b128 v[124:127], v9 offset:50176
    s_waitcnt vmcnt(28) lgkmcnt(8)
    v_mfma_f32_16x16x32_bf16 v[128:131], a[0:3], v[64:67], 0
    v_mfma_f32_16x16x32_bf16 v[132:135], a[4:7], v[64:67], 0
    v_mfma_f32_16x16x32_bf16 v[136:139], a[8:11], v[64:67], 0
    v_mfma_f32_16x16x32_bf16 v[140:143], a[12:15], v[64:67], 0
    v_mfma_f32_16x16x32_bf16 v[144:147], a[0:3], v[68:71], 0
    v_mfma_f32_16x16x32_bf16 v[148:151], a[4:7], v[68:71], 0
    v_mfma_f32_16x16x32_bf16 v[152:155], a[8:11], v[68:71], 0
    v_mfma_f32_16x16x32_bf16 v[156:159], a[12:15], v[68:71], 0
    v_mfma_f32_16x16x32_bf16 v[160:163], a[0:3], v[72:75], 0
    v_mfma_f32_16x16x32_bf16 v[164:167], a[4:7], v[72:75], 0
    v_mfma_f32_16x16x32_bf16 v[168:171], a[8:11], v[72:75], 0
    v_mfma_f32_16x16x32_bf16 v[172:175], a[12:15], v[72:75], 0
    v_mfma_f32_16x16x32_bf16 v[176:179], a[0:3], v[76:79], 0
    v_mfma_f32_16x16x32_bf16 v[180:183], a[4:7], v[76:79], 0
    v_mfma_f32_16x16x32_bf16 v[184:187], a[8:11], v[76:79], 0
    v_mfma_f32_16x16x32_bf16 v[188:191], a[12:15], v[76:79], 0
    v_mfma_f32_16x16x32_bf16 v[192:195], a[0:3], v[80:83], 0
    v_mfma_f32_16x16x32_bf16 v[196:199], a[4:7], v[80:83], 0
    v_mfma_f32_16x16x32_bf16 v[200:203], a[8:11], v[80:83], 0
    v_mfma_f32_16x16x32_bf16 v[204:207], a[12:15], v[80:83], 0
    v_mfma_f32_16x16x32_bf16 v[208:211], a[0:3], v[84:87], 0
    v_mfma_f32_16x16x32_bf16 v[212:215], a[4:7], v[84:87], 0
    v_mfma_f32_16x16x32_bf16 v[216:219], a[8:11], v[84:87], 0
    v_mfma_f32_16x16x32_bf16 v[220:223], a[12:15], v[84:87], 0
    v_mfma_f32_16x16x32_bf16 v[224:227], a[0:3], v[88:91], 0
    v_mfma_f32_16x16x32_bf16 v[228:231], a[4:7], v[88:91], 0
    v_mfma_f32_16x16x32_bf16 v[232:235], a[8:11], v[88:91], 0
    v_mfma_f32_16x16x32_bf16 v[236:239], a[12:15], v[88:91], 0
    v_mfma_f32_16x16x32_bf16 v[240:243], a[0:3], v[92:95], 0
    v_mfma_f32_16x16x32_bf16 v[244:247], a[4:7], v[92:95], 0
    v_mfma_f32_16x16x32_bf16 v[248:251], a[8:11], v[92:95], 0
    v_mfma_f32_16x16x32_bf16 v[252:255], a[12:15], v[92:95], 0
    buffer_load_dwordx4 a[0:3], v8, s[12:15], s28 offen
    buffer_load_dwordx4 a[4:7], v8, s[12:15], s29 offen
    buffer_load_dwordx4 a[8:11], v8, s[12:15], s30 offen
    buffer_load_dwordx4 a[12:15], v8, s[12:15], s31 offen
    v_add_u32 v8, 1024, v8
    ds_read_b128 v[64:67], v6 offset:2048
    ds_read_b128 v[68:71], v6 offset:18432
    ds_read_b128 v[72:75], v6 offset:34816
    ds_read_b128 v[76:79], v6 offset:51200
    ds_read_b128 v[80:83], v9 offset:2048
    ds_read_b128 v[84:87], v9 offset:18432
    ds_read_b128 v[88:91], v9 offset:34816
    ds_read_b128 v[92:95], v9 offset:51200
    s_waitcnt vmcnt(28) lgkmcnt(8)
    v_mfma_f32_16x16x32_bf16 v[128:131], a[16:19], v[96:99], v[128:131]
    v_mfma_f32_16x16x32_bf16 v[132:135], a[20:23], v[96:99], v[132:135]
    v_mfma_f32_16x16x32_bf16 v[136:139], a[24:27], v[96:99], v[136:139]
    v_mfma_f32_16x16x32_bf16 v[140:143], a[28:31], v[96:99], v[140:143]
    v_mfma_f32_16x16x32_bf16 v[144:147], a[16:19], v[100:103], v[144:147]
    v_mfma_f32_16x16x32_bf16 v[148:151], a[20:23], v[100:103], v[148:151]
    v_mfma_f32_16x16x32_bf16 v[152:155], a[24:27], v[100:103], v[152:155]
    v_mfma_f32_16x16x32_bf16 v[156:159], a[28:31], v[100:103], v[156:159]
    v_mfma_f32_16x16x32_bf16 v[160:163], a[16:19], v[104:107], v[160:163]
    v_mfma_f32_16x16x32_bf16 v[164:167], a[20:23], v[104:107], v[164:167]
    v_mfma_f32_16x16x32_bf16 v[168:171], a[24:27], v[104:107], v[168:171]
    v_mfma_f32_16x16x32_bf16 v[172:175], a[28:31], v[104:107], v[172:175]
    v_mfma_f32_16x16x32_bf16 v[176:179], a[16:19], v[108:111], v[176:179]
    v_mfma_f32_16x16x32_bf16 v[180:183], a[20:23], v[108:111], v[180:183]
    v_mfma_f32_16x16x32_bf16 v[184:187], a[24:27], v[108:111], v[184:187]
    v_mfma_f32_16x16x32_bf16 v[188:191], a[28:31], v[108:111], v[188:191]
    v_mfma_f32_16x16x32_bf16 v[192:195], a[16:19], v[112:115], v[192:195]
    v_mfma_f32_16x16x32_bf16 v[196:199], a[20:23], v[112:115], v[196:199]
    v_mfma_f32_16x16x32_bf16 v[200:203], a[24:27], v[112:115], v[200:203]
    v_mfma_f32_16x16x32_bf16 v[204:207], a[28:31], v[112:115], v[204:207]
    v_mfma_f32_16x16x32_bf16 v[208:211], a[16:19], v[116:119], v[208:211]
    v_mfma_f32_16x16x32_bf16 v[212:215], a[20:23], v[116:119], v[212:215]
    v_mfma_f32_16x16x32_bf16 v[216:219], a[24:27], v[116:119], v[216:219]
    v_mfma_f32_16x16x32_bf16 v[220:223], a[28:31], v[116:119], v[220:223]
    v_mfma_f32_16x16x32_bf16 v[224:227], a[16:19], v[120:123], v[224:227]
    v_mfma_f32_16x16x32_bf16 v[228:231], a[20:23], v[120:123], v[228:231]
    v_mfma_f32_16x16x32_bf16 v[232:235], a[24:27], v[120:123], v[232:235]
    v_mfma_f32_16x16x32_bf16 v[236:239], a[28:31], v[120:123], v[236:239]
    v_mfma_f32_16x16x32_bf16 v[240:243], a[16:19], v[124:127], v[240:243]
    v_mfma_f32_16x16x32_bf16 v[244:247], a[20:23], v[124:127], v[244:247]
    v_mfma_f32_16x16x32_bf16 v[248:251], a[24:27], v[124:127], v[248:251]
    v_mfma_f32_16x16x32_bf16 v[252:255], a[28:31], v[124:127], v[252:255]
    buffer_load_dwordx4 a[16:19], v8, s[12:15], s28 offen
    buffer_load_dwordx4 a[20:23], v8, s[12:15], s29 offen
    buffer_load_dwordx4 a[24:27], v8, s[12:15], s30 offen
    buffer_load_dwordx4 a[28:31], v8, s[12:15], s31 offen
    v_add_u32 v8, 1024, v8
    ds_read_b128 v[96:99], v6 offset:3072
    ds_read_b128 v[100:103], v6 offset:19456
    ds_read_b128 v[104:107], v6 offset:35840
    ds_read_b128 v[108:111], v6 offset:52224
    ds_read_b128 v[112:115], v9 offset:3072
    ds_read_b128 v[116:119], v9 offset:19456
    ds_read_b128 v[120:123], v9 offset:35840
    ds_read_b128 v[124:127], v9 offset:52224
    s_waitcnt vmcnt(28) lgkmcnt(8)
    v_mfma_f32_16x16x32_bf16 v[128:131], a[32:35], v[64:67], v[128:131]
    v_mfma_f32_16x16x32_bf16 v[132:135], a[36:39], v[64:67], v[132:135]
    v_mfma_f32_16x16x32_bf16 v[136:139], a[40:43], v[64:67], v[136:139]
    v_mfma_f32_16x16x32_bf16 v[140:143], a[44:47], v[64:67], v[140:143]
    v_mfma_f32_16x16x32_bf16 v[144:147], a[32:35], v[68:71], v[144:147]
    v_mfma_f32_16x16x32_bf16 v[148:151], a[36:39], v[68:71], v[148:151]
    v_mfma_f32_16x16x32_bf16 v[152:155], a[40:43], v[68:71], v[152:155]
    v_mfma_f32_16x16x32_bf16 v[156:159], a[44:47], v[68:71], v[156:159]
    v_mfma_f32_16x16x32_bf16 v[160:163], a[32:35], v[72:75], v[160:163]
    v_mfma_f32_16x16x32_bf16 v[164:167], a[36:39], v[72:75], v[164:167]
    v_mfma_f32_16x16x32_bf16 v[168:171], a[40:43], v[72:75], v[168:171]
    v_mfma_f32_16x16x32_bf16 v[172:175], a[44:47], v[72:75], v[172:175]
    v_mfma_f32_16x16x32_bf16 v[176:179], a[32:35], v[76:79], v[176:179]
    v_mfma_f32_16x16x32_bf16 v[180:183], a[36:39], v[76:79], v[180:183]
    v_mfma_f32_16x16x32_bf16 v[184:187], a[40:43], v[76:79], v[184:187]
    v_mfma_f32_16x16x32_bf16 v[188:191], a[44:47], v[76:79], v[188:191]
    v_mfma_f32_16x16x32_bf16 v[192:195], a[32:35], v[80:83], v[192:195]
    v_mfma_f32_16x16x32_bf16 v[196:199], a[36:39], v[80:83], v[196:199]
    v_mfma_f32_16x16x32_bf16 v[200:203], a[40:43], v[80:83], v[200:203]
    v_mfma_f32_16x16x32_bf16 v[204:207], a[44:47], v[80:83], v[204:207]
    v_mfma_f32_16x16x32_bf16 v[208:211], a[32:35], v[84:87], v[208:211]
    v_mfma_f32_16x16x32_bf16 v[212:215], a[36:39], v[84:87], v[212:215]
    v_mfma_f32_16x16x32_bf16 v[216:219], a[40:43], v[84:87], v[216:219]
    v_mfma_f32_16x16x32_bf16 v[220:223], a[44:47], v[84:87], v[220:223]
    v_mfma_f32_16x16x32_bf16 v[224:227], a[32:35], v[88:91], v[224:227]
    v_mfma_f32_16x16x32_bf16 v[228:231], a[36:39], v[88:91], v[228:231]
    v_mfma_f32_16x16x32_bf16 v[232:235], a[40:43], v[88:91], v[232:235]
    v_mfma_f32_16x16x32_bf16 v[236:239], a[44:47], v[88:91], v[236:239]
    v_mfma_f32_16x16x32_bf16 v[240:243], a[32:35], v[92:95], v[240:243]
    v_mfma_f32_16x16x32_bf16 v[244:247], a[36:39], v[92:95], v[244:247]
    v_mfma_f32_16x16x32_bf16 v[248:251], a[40:43], v[92:95], v[248:251]
    v_mfma_f32_16x16x32_bf16 v[252:255], a[44:47], v[92:95], v[252:255]
    buffer_load_dwordx4 a[32:35], v8, s[12:15], s28 offen
    buffer_load_dwordx4 a[36:39], v8, s[12:15], s29 offen
    buffer_load_dwordx4 a[40:43], v8, s[12:15], s30 offen
    buffer_load_dwordx4 a[44:47], v8, s[12:15], s31 offen
    v_add_u32 v8, 1024, v8
    ds_read_b128 v[64:67], v6 offset:4096
    ds_read_b128 v[68:71], v6 offset:20480
    ds_read_b128 v[72:75], v6 offset:36864
    ds_read_b128 v[76:79], v6 offset:53248
    ds_read_b128 v[80:83], v9 offset:4096
    ds_read_b128 v[84:87], v9 offset:20480
    ds_read_b128 v[88:91], v9 offset:36864
    ds_read_b128 v[92:95], v9 offset:53248
    s_waitcnt vmcnt(28) lgkmcnt(8)
    v_mfma_f32_16x16x32_bf16 v[128:131], a[48:51], v[96:99], v[128:131]
    v_mfma_f32_16x16x32_bf16 v[132:135], a[52:55], v[96:99], v[132:135]
    v_mfma_f32_16x16x32_bf16 v[136:139], a[56:59], v[96:99], v[136:139]
    v_mfma_f32_16x16x32_bf16 v[140:143], a[60:63], v[96:99], v[140:143]
    v_mfma_f32_16x16x32_bf16 v[144:147], a[48:51], v[100:103], v[144:147]
    v_mfma_f32_16x16x32_bf16 v[148:151], a[52:55], v[100:103], v[148:151]
    v_mfma_f32_16x16x32_bf16 v[152:155], a[56:59], v[100:103], v[152:155]
    v_mfma_f32_16x16x32_bf16 v[156:159], a[60:63], v[100:103], v[156:159]
    v_mfma_f32_16x16x32_bf16 v[160:163], a[48:51], v[104:107], v[160:163]
    v_mfma_f32_16x16x32_bf16 v[164:167], a[52:55], v[104:107], v[164:167]
    v_mfma_f32_16x16x32_bf16 v[168:171], a[56:59], v[104:107], v[168:171]
    v_mfma_f32_16x16x32_bf16 v[172:175], a[60:63], v[104:107], v[172:175]
    v_mfma_f32_16x16x32_bf16 v[176:179], a[48:51], v[108:111], v[176:179]
    v_mfma_f32_16x16x32_bf16 v[180:183], a[52:55], v[108:111], v[180:183]
    v_mfma_f32_16x16x32_bf16 v[184:187], a[56:59], v[108:111], v[184:187]
    v_mfma_f32_16x16x32_bf16 v[188:191], a[60:63], v[108:111], v[188:191]
    v_mfma_f32_16x16x32_bf16 v[192:195], a[48:51], v[112:115], v[192:195]
    v_mfma_f32_16x16x32_bf16 v[196:199], a[52:55], v[112:115], v[196:199]
    v_mfma_f32_16x16x32_bf16 v[200:203], a[56:59], v[112:115], v[200:203]
    v_mfma_f32_16x16x32_bf16 v[204:207], a[60:63], v[112:115], v[204:207]
    v_mfma_f32_16x16x32_bf16 v[208:211], a[48:51], v[116:119], v[208:211]
    v_mfma_f32_16x16x32_bf16 v[212:215], a[52:55], v[116:119], v[212:215]
    v_mfma_f32_16x16x32_bf16 v[216:219], a[56:59], v[116:119], v[216:219]
    v_mfma_f32_16x16x32_bf16 v[220:223], a[60:63], v[116:119], v[220:223]
    v_mfma_f32_16x16x32_bf16 v[224:227], a[48:51], v[120:123], v[224:227]
    v_mfma_f32_16x16x32_bf16 v[228:231], a[52:55], v[120:123], v[228:231]
    v_mfma_f32_16x16x32_bf16 v[232:235], a[56:59], v[120:123], v[232:235]
    v_mfma_f32_16x16x32_bf16 v[236:239], a[60:63], v[120:123], v[236:239]
    v_mfma_f32_16x16x32_bf16 v[240:243], a[48:51], v[124:127], v[240:243]
    v_mfma_f32_16x16x32_bf16 v[244:247], a[52:55], v[124:127], v[244:247]
    v_mfma_f32_16x16x32_bf16 v[248:251], a[56:59], v[124:127], v[248:251]
    v_mfma_f32_16x16x32_bf16 v[252:255], a[60:63], v[124:127], v[252:255]
    buffer_load_dwordx4 a[48:51], v8, s[12:15], s28 offen
    buffer_load_dwordx4 a[52:55], v8, s[12:15], s29 offen
    buffer_load_dwordx4 a[56:59], v8, s[12:15], s30 offen
    buffer_load_dwordx4 a[60:63], v8, s[12:15], s31 offen
    v_add_u32 v8, 1024, v8
    ds_read_b128 v[96:99], v6 offset:5120
    ds_read_b128 v[100:103], v6 offset:21504
    ds_read_b128 v[104:107], v6 offset:37888
    ds_read_b128 v[108:111], v6 offset:54272
    ds_read_b128 v[112:115], v9 offset:5120
    ds_read_b128 v[116:119], v9 offset:21504
    ds_read_b128 v[120:123], v9 offset:37888
    ds_read_b128 v[124:127], v9 offset:54272
    s_waitcnt vmcnt(28) lgkmcnt(8)
    v_mfma_f32_16x16x32_bf16 v[128:131], a[64:67], v[64:67], v[128:131]
    v_mfma_f32_16x16x32_bf16 v[132:135], a[68:71], v[64:67], v[132:135]
    v_mfma_f32_16x16x32_bf16 v[136:139], a[72:75], v[64:67], v[136:139]
    v_mfma_f32_16x16x32_bf16 v[140:143], a[76:79], v[64:67], v[140:143]
    v_mfma_f32_16x16x32_bf16 v[144:147], a[64:67], v[68:71], v[144:147]
    v_mfma_f32_16x16x32_bf16 v[148:151], a[68:71], v[68:71], v[148:151]
    v_mfma_f32_16x16x32_bf16 v[152:155], a[72:75], v[68:71], v[152:155]
    v_mfma_f32_16x16x32_bf16 v[156:159], a[76:79], v[68:71], v[156:159]
    v_mfma_f32_16x16x32_bf16 v[160:163], a[64:67], v[72:75], v[160:163]
    v_mfma_f32_16x16x32_bf16 v[164:167], a[68:71], v[72:75], v[164:167]
    v_mfma_f32_16x16x32_bf16 v[168:171], a[72:75], v[72:75], v[168:171]
    v_mfma_f32_16x16x32_bf16 v[172:175], a[76:79], v[72:75], v[172:175]
    v_mfma_f32_16x16x32_bf16 v[176:179], a[64:67], v[76:79], v[176:179]
    v_mfma_f32_16x16x32_bf16 v[180:183], a[68:71], v[76:79], v[180:183]
    v_mfma_f32_16x16x32_bf16 v[184:187], a[72:75], v[76:79], v[184:187]
    v_mfma_f32_16x16x32_bf16 v[188:191], a[76:79], v[76:79], v[188:191]
    v_mfma_f32_16x16x32_bf16 v[192:195], a[64:67], v[80:83], v[192:195]
    v_mfma_f32_16x16x32_bf16 v[196:199], a[68:71], v[80:83], v[196:199]
    v_mfma_f32_16x16x32_bf16 v[200:203], a[72:75], v[80:83], v[200:203]
    v_mfma_f32_16x16x32_bf16 v[204:207], a[76:79], v[80:83], v[204:207]
    v_mfma_f32_16x16x32_bf16 v[208:211], a[64:67], v[84:87], v[208:211]
    v_mfma_f32_16x16x32_bf16 v[212:215], a[68:71], v[84:87], v[212:215]
    v_mfma_f32_16x16x32_bf16 v[216:219], a[72:75], v[84:87], v[216:219]
    v_mfma_f32_16x16x32_bf16 v[220:223], a[76:79], v[84:87], v[220:223]
    v_mfma_f32_16x16x32_bf16 v[224:227], a[64:67], v[88:91], v[224:227]
    v_mfma_f32_16x16x32_bf16 v[228:231], a[68:71], v[88:91], v[228:231]
    v_mfma_f32_16x16x32_bf16 v[232:235], a[72:75], v[88:91], v[232:235]
    v_mfma_f32_16x16x32_bf16 v[236:239], a[76:79], v[88:91], v[236:239]
    v_mfma_f32_16x16x32_bf16 v[240:243], a[64:67], v[92:95], v[240:243]
    v_mfma_f32_16x16x32_bf16 v[244:247], a[68:71], v[92:95], v[244:247]
    v_mfma_f32_16x16x32_bf16 v[248:251], a[72:75], v[92:95], v[248:251]
    v_mfma_f32_16x16x32_bf16 v[252:255], a[76:79], v[92:95], v[252:255]
    buffer_load_dwordx4 a[64:67], v8, s[12:15], s28 offen
    buffer_load_dwordx4 a[68:71], v8, s[12:15], s29 offen
    buffer_load_dwordx4 a[72:75], v8, s[12:15], s30 offen
    buffer_load_dwordx4 a[76:79], v8, s[12:15], s31 offen
    v_add_u32 v8, 1024, v8
    ds_read_b128 v[64:67], v6 offset:6144
    ds_read_b128 v[68:71], v6 offset:22528
    ds_read_b128 v[72:75], v6 offset:38912
    ds_read_b128 v[76:79], v6 offset:55296
    ds_read_b128 v[80:83], v9 offset:6144
    ds_read_b128 v[84:87], v9 offset:22528
    ds_read_b128 v[88:91], v9 offset:38912
    ds_read_b128 v[92:95], v9 offset:55296
    s_waitcnt vmcnt(28) lgkmcnt(8)
    v_mfma_f32_16x16x32_bf16 v[128:131], a[80:83], v[96:99], v[128:131]
    v_mfma_f32_16x16x32_bf16 v[132:135], a[84:87], v[96:99], v[132:135]
    v_mfma_f32_16x16x32_bf16 v[136:139], a[88:91], v[96:99], v[136:139]
    v_mfma_f32_16x16x32_bf16 v[140:143], a[92:95], v[96:99], v[140:143]
    v_mfma_f32_16x16x32_bf16 v[144:147], a[80:83], v[100:103], v[144:147]
    v_mfma_f32_16x16x32_bf16 v[148:151], a[84:87], v[100:103], v[148:151]
    v_mfma_f32_16x16x32_bf16 v[152:155], a[88:91], v[100:103], v[152:155]
    v_mfma_f32_16x16x32_bf16 v[156:159], a[92:95], v[100:103], v[156:159]
    v_mfma_f32_16x16x32_bf16 v[160:163], a[80:83], v[104:107], v[160:163]
    v_mfma_f32_16x16x32_bf16 v[164:167], a[84:87], v[104:107], v[164:167]
    v_mfma_f32_16x16x32_bf16 v[168:171], a[88:91], v[104:107], v[168:171]
    v_mfma_f32_16x16x32_bf16 v[172:175], a[92:95], v[104:107], v[172:175]
    v_mfma_f32_16x16x32_bf16 v[176:179], a[80:83], v[108:111], v[176:179]
    v_mfma_f32_16x16x32_bf16 v[180:183], a[84:87], v[108:111], v[180:183]
    v_mfma_f32_16x16x32_bf16 v[184:187], a[88:91], v[108:111], v[184:187]
    v_mfma_f32_16x16x32_bf16 v[188:191], a[92:95], v[108:111], v[188:191]
    v_mfma_f32_16x16x32_bf16 v[192:195], a[80:83], v[112:115], v[192:195]
    v_mfma_f32_16x16x32_bf16 v[196:199], a[84:87], v[112:115], v[196:199]
    v_mfma_f32_16x16x32_bf16 v[200:203], a[88:91], v[112:115], v[200:203]
    v_mfma_f32_16x16x32_bf16 v[204:207], a[92:95], v[112:115], v[204:207]
    v_mfma_f32_16x16x32_bf16 v[208:211], a[80:83], v[116:119], v[208:211]
    v_mfma_f32_16x16x32_bf16 v[212:215], a[84:87], v[116:119], v[212:215]
    v_mfma_f32_16x16x32_bf16 v[216:219], a[88:91], v[116:119], v[216:219]
    v_mfma_f32_16x16x32_bf16 v[220:223], a[92:95], v[116:119], v[220:223]
    v_mfma_f32_16x16x32_bf16 v[224:227], a[80:83], v[120:123], v[224:227]
    v_mfma_f32_16x16x32_bf16 v[228:231], a[84:87], v[120:123], v[228:231]
    v_mfma_f32_16x16x32_bf16 v[232:235], a[88:91], v[120:123], v[232:235]
    v_mfma_f32_16x16x32_bf16 v[236:239], a[92:95], v[120:123], v[236:239]
    v_mfma_f32_16x16x32_bf16 v[240:243], a[80:83], v[124:127], v[240:243]
    v_mfma_f32_16x16x32_bf16 v[244:247], a[84:87], v[124:127], v[244:247]
    v_mfma_f32_16x16x32_bf16 v[248:251], a[88:91], v[124:127], v[248:251]
    v_mfma_f32_16x16x32_bf16 v[252:255], a[92:95], v[124:127], v[252:255]
    buffer_load_dwordx4 a[80:83], v8, s[12:15], s28 offen
    buffer_load_dwordx4 a[84:87], v8, s[12:15], s29 offen
    buffer_load_dwordx4 a[88:91], v8, s[12:15], s30 offen
    buffer_load_dwordx4 a[92:95], v8, s[12:15], s31 offen
    v_add_u32 v8, 1024, v8
    ds_read_b128 v[96:99], v6 offset:7168
    ds_read_b128 v[100:103], v6 offset:23552
    ds_read_b128 v[104:107], v6 offset:39936
    ds_read_b128 v[108:111], v6 offset:56320
    ds_read_b128 v[112:115], v9 offset:7168
    ds_read_b128 v[116:119], v9 offset:23552
    ds_read_b128 v[120:123], v9 offset:39936
    ds_read_b128 v[124:127], v9 offset:56320
    s_waitcnt vmcnt(28) lgkmcnt(8)
    v_mfma_f32_16x16x32_bf16 v[128:131], a[96:99], v[64:67], v[128:131]
    v_mfma_f32_16x16x32_bf16 v[132:135], a[100:103], v[64:67], v[132:135]
    v_mfma_f32_16x16x32_bf16 v[136:139], a[104:107], v[64:67], v[136:139]
    v_mfma_f32_16x16x32_bf16 v[140:143], a[108:111], v[64:67], v[140:143]
    v_mfma_f32_16x16x32_bf16 v[144:147], a[96:99], v[68:71], v[144:147]
    v_mfma_f32_16x16x32_bf16 v[148:151], a[100:103], v[68:71], v[148:151]
    v_mfma_f32_16x16x32_bf16 v[152:155], a[104:107], v[68:71], v[152:155]
    v_mfma_f32_16x16x32_bf16 v[156:159], a[108:111], v[68:71], v[156:159]
    v_mfma_f32_16x16x32_bf16 v[160:163], a[96:99], v[72:75], v[160:163]
    v_mfma_f32_16x16x32_bf16 v[164:167], a[100:103], v[72:75], v[164:167]
    v_mfma_f32_16x16x32_bf16 v[168:171], a[104:107], v[72:75], v[168:171]
    v_mfma_f32_16x16x32_bf16 v[172:175], a[108:111], v[72:75], v[172:175]
    v_mfma_f32_16x16x32_bf16 v[176:179], a[96:99], v[76:79], v[176:179]
    v_mfma_f32_16x16x32_bf16 v[180:183], a[100:103], v[76:79], v[180:183]
    v_mfma_f32_16x16x32_bf16 v[184:187], a[104:107], v[76:79], v[184:187]
    v_mfma_f32_16x16x32_bf16 v[188:191], a[108:111], v[76:79], v[188:191]
    v_mfma_f32_16x16x32_bf16 v[192:195], a[96:99], v[80:83], v[192:195]
    v_mfma_f32_16x16x32_bf16 v[196:199], a[100:103], v[80:83], v[196:199]
    v_mfma_f32_16x16x32_bf16 v[200:203], a[104:107], v[80:83], v[200:203]
    v_mfma_f32_16x16x32_bf16 v[204:207], a[108:111], v[80:83], v[204:207]
    v_mfma_f32_16x16x32_bf16 v[208:211], a[96:99], v[84:87], v[208:211]
    v_mfma_f32_16x16x32_bf16 v[212:215], a[100:103], v[84:87], v[212:215]
    v_mfma_f32_16x16x32_bf16 v[216:219], a[104:107], v[84:87], v[216:219]
    v_mfma_f32_16x16x32_bf16 v[220:223], a[108:111], v[84:87], v[220:223]
    v_mfma_f32_16x16x32_bf16 v[224:227], a[96:99], v[88:91], v[224:227]
    v_mfma_f32_16x16x32_bf16 v[228:231], a[100:103], v[88:91], v[228:231]
    v_mfma_f32_16x16x32_bf16 v[232:235], a[104:107], v[88:91], v[232:235]
    v_mfma_f32_16x16x32_bf16 v[236:239], a[108:111], v[88:91], v[236:239]
    v_mfma_f32_16x16x32_bf16 v[240:243], a[96:99], v[92:95], v[240:243]
    v_mfma_f32_16x16x32_bf16 v[244:247], a[100:103], v[92:95], v[244:247]
    v_mfma_f32_16x16x32_bf16 v[248:251], a[104:107], v[92:95], v[248:251]
    v_mfma_f32_16x16x32_bf16 v[252:255], a[108:111], v[92:95], v[252:255]
    buffer_load_dwordx4 a[96:99], v8, s[12:15], s28 offen
    buffer_load_dwordx4 a[100:103], v8, s[12:15], s29 offen
    buffer_load_dwordx4 a[104:107], v8, s[12:15], s30 offen
    buffer_load_dwordx4 a[108:111], v8, s[12:15], s31 offen
    v_add_u32 v8, 1024, v8
    ds_read_b128 v[64:67], v6 offset:8192
    ds_read_b128 v[68:71], v6 offset:24576
    ds_read_b128 v[72:75], v6 offset:40960
    ds_read_b128 v[76:79], v6 offset:57344
    ds_read_b128 v[80:83], v9 offset:8192
    ds_read_b128 v[84:87], v9 offset:24576
    ds_read_b128 v[88:91], v9 offset:40960
    ds_read_b128 v[92:95], v9 offset:57344
    s_waitcnt vmcnt(28) lgkmcnt(8)
    v_mfma_f32_16x16x32_bf16 v[128:131], a[112:115], v[96:99], v[128:131]
    v_mfma_f32_16x16x32_bf16 v[132:135], a[116:119], v[96:99], v[132:135]
    v_mfma_f32_16x16x32_bf16 v[136:139], a[120:123], v[96:99], v[136:139]
    v_mfma_f32_16x16x32_bf16 v[140:143], a[124:127], v[96:99], v[140:143]
    v_mfma_f32_16x16x32_bf16 v[144:147], a[112:115], v[100:103], v[144:147]
    v_mfma_f32_16x16x32_bf16 v[148:151], a[116:119], v[100:103], v[148:151]
    v_mfma_f32_16x16x32_bf16 v[152:155], a[120:123], v[100:103], v[152:155]
    v_mfma_f32_16x16x32_bf16 v[156:159], a[124:127], v[100:103], v[156:159]
    v_mfma_f32_16x16x32_bf16 v[160:163], a[112:115], v[104:107], v[160:163]
    v_mfma_f32_16x16x32_bf16 v[164:167], a[116:119], v[104:107], v[164:167]
    v_mfma_f32_16x16x32_bf16 v[168:171], a[120:123], v[104:107], v[168:171]
    v_mfma_f32_16x16x32_bf16 v[172:175], a[124:127], v[104:107], v[172:175]
    v_mfma_f32_16x16x32_bf16 v[176:179], a[112:115], v[108:111], v[176:179]
    v_mfma_f32_16x16x32_bf16 v[180:183], a[116:119], v[108:111], v[180:183]
    v_mfma_f32_16x16x32_bf16 v[184:187], a[120:123], v[108:111], v[184:187]
    v_mfma_f32_16x16x32_bf16 v[188:191], a[124:127], v[108:111], v[188:191]
    v_mfma_f32_16x16x32_bf16 v[192:195], a[112:115], v[112:115], v[192:195]
    v_mfma_f32_16x16x32_bf16 v[196:199], a[116:119], v[112:115], v[196:199]
    v_mfma_f32_16x16x32_bf16 v[200:203], a[120:123], v[112:115], v[200:203]
    v_mfma_f32_16x16x32_bf16 v[204:207], a[124:127], v[112:115], v[204:207]
    v_mfma_f32_16x16x32_bf16 v[208:211], a[112:115], v[116:119], v[208:211]
    v_mfma_f32_16x16x32_bf16 v[212:215], a[116:119], v[116:119], v[212:215]
    v_mfma_f32_16x16x32_bf16 v[216:219], a[120:123], v[116:119], v[216:219]
    v_mfma_f32_16x16x32_bf16 v[220:223], a[124:127], v[116:119], v[220:223]
    v_mfma_f32_16x16x32_bf16 v[224:227], a[112:115], v[120:123], v[224:227]
    v_mfma_f32_16x16x32_bf16 v[228:231], a[116:119], v[120:123], v[228:231]
    v_mfma_f32_16x16x32_bf16 v[232:235], a[120:123], v[120:123], v[232:235]
    v_mfma_f32_16x16x32_bf16 v[236:239], a[124:127], v[120:123], v[236:239]
    v_mfma_f32_16x16x32_bf16 v[240:243], a[112:115], v[124:127], v[240:243]
    v_mfma_f32_16x16x32_bf16 v[244:247], a[116:119], v[124:127], v[244:247]
    v_mfma_f32_16x16x32_bf16 v[248:251], a[120:123], v[124:127], v[248:251]
    v_mfma_f32_16x16x32_bf16 v[252:255], a[124:127], v[124:127], v[252:255]
    buffer_load_dwordx4 a[112:115], v8, s[12:15], s28 offen
    buffer_load_dwordx4 a[116:119], v8, s[12:15], s29 offen
    buffer_load_dwordx4 a[120:123], v8, s[12:15], s30 offen
    buffer_load_dwordx4 a[124:127], v8, s[12:15], s31 offen
    v_add_u32 v8, 1024, v8
    ds_read_b128 v[96:99], v6 offset:9216
    ds_read_b128 v[100:103], v6 offset:25600
    ds_read_b128 v[104:107], v6 offset:41984
    ds_read_b128 v[108:111], v6 offset:58368
    ds_read_b128 v[112:115], v9 offset:9216
    ds_read_b128 v[116:119], v9 offset:25600
    ds_read_b128 v[120:123], v9 offset:41984
    ds_read_b128 v[124:127], v9 offset:58368
    s_waitcnt vmcnt(28) lgkmcnt(8)
    v_mfma_f32_16x16x32_bf16 v[128:131], a[0:3], v[64:67], v[128:131]
    v_mfma_f32_16x16x32_bf16 v[132:135], a[4:7], v[64:67], v[132:135]
    v_mfma_f32_16x16x32_bf16 v[136:139], a[8:11], v[64:67], v[136:139]
    v_mfma_f32_16x16x32_bf16 v[140:143], a[12:15], v[64:67], v[140:143]
    v_mfma_f32_16x16x32_bf16 v[144:147], a[0:3], v[68:71], v[144:147]
    v_mfma_f32_16x16x32_bf16 v[148:151], a[4:7], v[68:71], v[148:151]
    v_mfma_f32_16x16x32_bf16 v[152:155], a[8:11], v[68:71], v[152:155]
    v_mfma_f32_16x16x32_bf16 v[156:159], a[12:15], v[68:71], v[156:159]
    v_mfma_f32_16x16x32_bf16 v[160:163], a[0:3], v[72:75], v[160:163]
    v_mfma_f32_16x16x32_bf16 v[164:167], a[4:7], v[72:75], v[164:167]
    v_mfma_f32_16x16x32_bf16 v[168:171], a[8:11], v[72:75], v[168:171]
    v_mfma_f32_16x16x32_bf16 v[172:175], a[12:15], v[72:75], v[172:175]
    v_mfma_f32_16x16x32_bf16 v[176:179], a[0:3], v[76:79], v[176:179]
    v_mfma_f32_16x16x32_bf16 v[180:183], a[4:7], v[76:79], v[180:183]
    v_mfma_f32_16x16x32_bf16 v[184:187], a[8:11], v[76:79], v[184:187]
    v_mfma_f32_16x16x32_bf16 v[188:191], a[12:15], v[76:79], v[188:191]
    v_mfma_f32_16x16x32_bf16 v[192:195], a[0:3], v[80:83], v[192:195]
    v_mfma_f32_16x16x32_bf16 v[196:199], a[4:7], v[80:83], v[196:199]
    v_mfma_f32_16x16x32_bf16 v[200:203], a[8:11], v[80:83], v[200:203]
    v_mfma_f32_16x16x32_bf16 v[204:207], a[12:15], v[80:83], v[204:207]
    v_mfma_f32_16x16x32_bf16 v[208:211], a[0:3], v[84:87], v[208:211]
    v_mfma_f32_16x16x32_bf16 v[212:215], a[4:7], v[84:87], v[212:215]
    v_mfma_f32_16x16x32_bf16 v[216:219], a[8:11], v[84:87], v[216:219]
    v_mfma_f32_16x16x32_bf16 v[220:223], a[12:15], v[84:87], v[220:223]
    v_mfma_f32_16x16x32_bf16 v[224:227], a[0:3], v[88:91], v[224:227]
    v_mfma_f32_16x16x32_bf16 v[228:231], a[4:7], v[88:91], v[228:231]
    v_mfma_f32_16x16x32_bf16 v[232:235], a[8:11], v[88:91], v[232:235]
    v_mfma_f32_16x16x32_bf16 v[236:239], a[12:15], v[88:91], v[236:239]
    v_mfma_f32_16x16x32_bf16 v[240:243], a[0:3], v[92:95], v[240:243]
    v_mfma_f32_16x16x32_bf16 v[244:247], a[4:7], v[92:95], v[244:247]
    v_mfma_f32_16x16x32_bf16 v[248:251], a[8:11], v[92:95], v[248:251]
    v_mfma_f32_16x16x32_bf16 v[252:255], a[12:15], v[92:95], v[252:255]
    v_mov_b32 v8, v6
    ds_read_b128 v[64:67], v6 offset:10240
    ds_read_b128 v[68:71], v6 offset:26624
    ds_read_b128 v[72:75], v6 offset:43008
    ds_read_b128 v[76:79], v6 offset:59392
    ds_read_b128 v[80:83], v9 offset:10240
    ds_read_b128 v[84:87], v9 offset:26624
    ds_read_b128 v[88:91], v9 offset:43008
    ds_read_b128 v[92:95], v9 offset:59392
    s_waitcnt vmcnt(24) lgkmcnt(8)
    v_mfma_f32_16x16x32_bf16 v[128:131], a[16:19], v[96:99], v[128:131]
    v_mfma_f32_16x16x32_bf16 v[132:135], a[20:23], v[96:99], v[132:135]
    v_mfma_f32_16x16x32_bf16 v[136:139], a[24:27], v[96:99], v[136:139]
    v_mfma_f32_16x16x32_bf16 v[140:143], a[28:31], v[96:99], v[140:143]
    v_mfma_f32_16x16x32_bf16 v[144:147], a[16:19], v[100:103], v[144:147]
    v_mfma_f32_16x16x32_bf16 v[148:151], a[20:23], v[100:103], v[148:151]
    v_mfma_f32_16x16x32_bf16 v[152:155], a[24:27], v[100:103], v[152:155]
    v_mfma_f32_16x16x32_bf16 v[156:159], a[28:31], v[100:103], v[156:159]
    v_mfma_f32_16x16x32_bf16 v[160:163], a[16:19], v[104:107], v[160:163]
    v_mfma_f32_16x16x32_bf16 v[164:167], a[20:23], v[104:107], v[164:167]
    v_mfma_f32_16x16x32_bf16 v[168:171], a[24:27], v[104:107], v[168:171]
    v_mfma_f32_16x16x32_bf16 v[172:175], a[28:31], v[104:107], v[172:175]
    v_mfma_f32_16x16x32_bf16 v[176:179], a[16:19], v[108:111], v[176:179]
    v_mfma_f32_16x16x32_bf16 v[180:183], a[20:23], v[108:111], v[180:183]
    v_mfma_f32_16x16x32_bf16 v[184:187], a[24:27], v[108:111], v[184:187]
    v_mfma_f32_16x16x32_bf16 v[188:191], a[28:31], v[108:111], v[188:191]
    v_mfma_f32_16x16x32_bf16 v[192:195], a[16:19], v[112:115], v[192:195]
    v_mfma_f32_16x16x32_bf16 v[196:199], a[20:23], v[112:115], v[196:199]
    v_mfma_f32_16x16x32_bf16 v[200:203], a[24:27], v[112:115], v[200:203]
    v_mfma_f32_16x16x32_bf16 v[204:207], a[28:31], v[112:115], v[204:207]
    v_mfma_f32_16x16x32_bf16 v[208:211], a[16:19], v[116:119], v[208:211]
    v_mfma_f32_16x16x32_bf16 v[212:215], a[20:23], v[116:119], v[212:215]
    v_mfma_f32_16x16x32_bf16 v[216:219], a[24:27], v[116:119], v[216:219]
    v_mfma_f32_16x16x32_bf16 v[220:223], a[28:31], v[116:119], v[220:223]
    v_mfma_f32_16x16x32_bf16 v[224:227], a[16:19], v[120:123], v[224:227]
    v_mfma_f32_16x16x32_bf16 v[228:231], a[20:23], v[120:123], v[228:231]
    v_mfma_f32_16x16x32_bf16 v[232:235], a[24:27], v[120:123], v[232:235]
    v_mfma_f32_16x16x32_bf16 v[236:239], a[28:31], v[120:123], v[236:239]
    v_mfma_f32_16x16x32_bf16 v[240:243], a[16:19], v[124:127], v[240:243]
    v_mfma_f32_16x16x32_bf16 v[244:247], a[20:23], v[124:127], v[244:247]
    v_mfma_f32_16x16x32_bf16 v[248:251], a[24:27], v[124:127], v[248:251]
    v_mfma_f32_16x16x32_bf16 v[252:255], a[28:31], v[124:127], v[252:255]
    ds_read_b128 v[96:99], v6 offset:11264
    ds_read_b128 v[100:103], v6 offset:27648
    ds_read_b128 v[104:107], v6 offset:44032
    ds_read_b128 v[108:111], v6 offset:60416
    ds_read_b128 v[112:115], v9 offset:11264
    ds_read_b128 v[116:119], v9 offset:27648
    ds_read_b128 v[120:123], v9 offset:44032
    ds_read_b128 v[124:127], v9 offset:60416
    s_waitcnt vmcnt(20) lgkmcnt(8)
    v_mfma_f32_16x16x32_bf16 v[128:131], a[32:35], v[64:67], v[128:131]
    v_mfma_f32_16x16x32_bf16 v[132:135], a[36:39], v[64:67], v[132:135]
    v_mfma_f32_16x16x32_bf16 v[136:139], a[40:43], v[64:67], v[136:139]
    v_mfma_f32_16x16x32_bf16 v[140:143], a[44:47], v[64:67], v[140:143]
    v_mfma_f32_16x16x32_bf16 v[144:147], a[32:35], v[68:71], v[144:147]
    v_mfma_f32_16x16x32_bf16 v[148:151], a[36:39], v[68:71], v[148:151]
    v_mfma_f32_16x16x32_bf16 v[152:155], a[40:43], v[68:71], v[152:155]
    v_mfma_f32_16x16x32_bf16 v[156:159], a[44:47], v[68:71], v[156:159]
    v_mfma_f32_16x16x32_bf16 v[160:163], a[32:35], v[72:75], v[160:163]
    v_mfma_f32_16x16x32_bf16 v[164:167], a[36:39], v[72:75], v[164:167]
    v_mfma_f32_16x16x32_bf16 v[168:171], a[40:43], v[72:75], v[168:171]
    v_mfma_f32_16x16x32_bf16 v[172:175], a[44:47], v[72:75], v[172:175]
    v_mfma_f32_16x16x32_bf16 v[176:179], a[32:35], v[76:79], v[176:179]
    v_mfma_f32_16x16x32_bf16 v[180:183], a[36:39], v[76:79], v[180:183]
    v_mfma_f32_16x16x32_bf16 v[184:187], a[40:43], v[76:79], v[184:187]
    v_mfma_f32_16x16x32_bf16 v[188:191], a[44:47], v[76:79], v[188:191]
    v_mfma_f32_16x16x32_bf16 v[192:195], a[32:35], v[80:83], v[192:195]
    v_mfma_f32_16x16x32_bf16 v[196:199], a[36:39], v[80:83], v[196:199]
    v_mfma_f32_16x16x32_bf16 v[200:203], a[40:43], v[80:83], v[200:203]
    v_mfma_f32_16x16x32_bf16 v[204:207], a[44:47], v[80:83], v[204:207]
    v_mfma_f32_16x16x32_bf16 v[208:211], a[32:35], v[84:87], v[208:211]
    v_mfma_f32_16x16x32_bf16 v[212:215], a[36:39], v[84:87], v[212:215]
    v_mfma_f32_16x16x32_bf16 v[216:219], a[40:43], v[84:87], v[216:219]
    v_mfma_f32_16x16x32_bf16 v[220:223], a[44:47], v[84:87], v[220:223]
    v_mfma_f32_16x16x32_bf16 v[224:227], a[32:35], v[88:91], v[224:227]
    v_mfma_f32_16x16x32_bf16 v[228:231], a[36:39], v[88:91], v[228:231]
    v_mfma_f32_16x16x32_bf16 v[232:235], a[40:43], v[88:91], v[232:235]
    v_mfma_f32_16x16x32_bf16 v[236:239], a[44:47], v[88:91], v[236:239]
    v_mfma_f32_16x16x32_bf16 v[240:243], a[32:35], v[92:95], v[240:243]
    v_mfma_f32_16x16x32_bf16 v[244:247], a[36:39], v[92:95], v[244:247]
    v_mfma_f32_16x16x32_bf16 v[248:251], a[40:43], v[92:95], v[248:251]
    v_mfma_f32_16x16x32_bf16 v[252:255], a[44:47], v[92:95], v[252:255]
    ds_read_b128 v[64:67], v6 offset:12288
    ds_read_b128 v[68:71], v6 offset:28672
    ds_read_b128 v[72:75], v6 offset:45056
    ds_read_b128 v[76:79], v6 offset:61440
    ds_read_b128 v[80:83], v9 offset:12288
    ds_read_b128 v[84:87], v9 offset:28672
    ds_read_b128 v[88:91], v9 offset:45056
    ds_read_b128 v[92:95], v9 offset:61440
    s_waitcnt vmcnt(16) lgkmcnt(8)
    v_mfma_f32_16x16x32_bf16 v[128:131], a[48:51], v[96:99], v[128:131]
    v_mfma_f32_16x16x32_bf16 v[132:135], a[52:55], v[96:99], v[132:135]
    v_mfma_f32_16x16x32_bf16 v[136:139], a[56:59], v[96:99], v[136:139]
    v_mfma_f32_16x16x32_bf16 v[140:143], a[60:63], v[96:99], v[140:143]
    v_mfma_f32_16x16x32_bf16 v[144:147], a[48:51], v[100:103], v[144:147]
    v_mfma_f32_16x16x32_bf16 v[148:151], a[52:55], v[100:103], v[148:151]
    v_mfma_f32_16x16x32_bf16 v[152:155], a[56:59], v[100:103], v[152:155]
    v_mfma_f32_16x16x32_bf16 v[156:159], a[60:63], v[100:103], v[156:159]
    v_mfma_f32_16x16x32_bf16 v[160:163], a[48:51], v[104:107], v[160:163]
    v_mfma_f32_16x16x32_bf16 v[164:167], a[52:55], v[104:107], v[164:167]
    v_mfma_f32_16x16x32_bf16 v[168:171], a[56:59], v[104:107], v[168:171]
    v_mfma_f32_16x16x32_bf16 v[172:175], a[60:63], v[104:107], v[172:175]
    v_mfma_f32_16x16x32_bf16 v[176:179], a[48:51], v[108:111], v[176:179]
    v_mfma_f32_16x16x32_bf16 v[180:183], a[52:55], v[108:111], v[180:183]
    v_mfma_f32_16x16x32_bf16 v[184:187], a[56:59], v[108:111], v[184:187]
    v_mfma_f32_16x16x32_bf16 v[188:191], a[60:63], v[108:111], v[188:191]
    v_mfma_f32_16x16x32_bf16 v[192:195], a[48:51], v[112:115], v[192:195]
    v_mfma_f32_16x16x32_bf16 v[196:199], a[52:55], v[112:115], v[196:199]
    v_mfma_f32_16x16x32_bf16 v[200:203], a[56:59], v[112:115], v[200:203]
    v_mfma_f32_16x16x32_bf16 v[204:207], a[60:63], v[112:115], v[204:207]
    v_mfma_f32_16x16x32_bf16 v[208:211], a[48:51], v[116:119], v[208:211]
    v_mfma_f32_16x16x32_bf16 v[212:215], a[52:55], v[116:119], v[212:215]
    v_mfma_f32_16x16x32_bf16 v[216:219], a[56:59], v[116:119], v[216:219]
    v_mfma_f32_16x16x32_bf16 v[220:223], a[60:63], v[116:119], v[220:223]
    v_mfma_f32_16x16x32_bf16 v[224:227], a[48:51], v[120:123], v[224:227]
    v_mfma_f32_16x16x32_bf16 v[228:231], a[52:55], v[120:123], v[228:231]
    v_mfma_f32_16x16x32_bf16 v[232:235], a[56:59], v[120:123], v[232:235]
    v_mfma_f32_16x16x32_bf16 v[236:239], a[60:63], v[120:123], v[236:239]
    v_mfma_f32_16x16x32_bf16 v[240:243], a[48:51], v[124:127], v[240:243]
    v_mfma_f32_16x16x32_bf16 v[244:247], a[52:55], v[124:127], v[244:247]
    v_mfma_f32_16x16x32_bf16 v[248:251], a[56:59], v[124:127], v[248:251]
    v_mfma_f32_16x16x32_bf16 v[252:255], a[60:63], v[124:127], v[252:255]
    ds_read_b128 v[96:99], v6 offset:13312
    ds_read_b128 v[100:103], v6 offset:29696
    ds_read_b128 v[104:107], v6 offset:46080
    ds_read_b128 v[108:111], v6 offset:62464
    ds_read_b128 v[112:115], v9 offset:13312
    ds_read_b128 v[116:119], v9 offset:29696
    ds_read_b128 v[120:123], v9 offset:46080
    ds_read_b128 v[124:127], v9 offset:62464
    s_waitcnt vmcnt(12) lgkmcnt(8)
    v_mfma_f32_16x16x32_bf16 v[128:131], a[64:67], v[64:67], v[128:131]
    v_mfma_f32_16x16x32_bf16 v[132:135], a[68:71], v[64:67], v[132:135]
    v_mfma_f32_16x16x32_bf16 v[136:139], a[72:75], v[64:67], v[136:139]
    v_mfma_f32_16x16x32_bf16 v[140:143], a[76:79], v[64:67], v[140:143]
    v_mfma_f32_16x16x32_bf16 v[144:147], a[64:67], v[68:71], v[144:147]
    v_mfma_f32_16x16x32_bf16 v[148:151], a[68:71], v[68:71], v[148:151]
    v_mfma_f32_16x16x32_bf16 v[152:155], a[72:75], v[68:71], v[152:155]
    v_mfma_f32_16x16x32_bf16 v[156:159], a[76:79], v[68:71], v[156:159]
    v_mfma_f32_16x16x32_bf16 v[160:163], a[64:67], v[72:75], v[160:163]
    v_mfma_f32_16x16x32_bf16 v[164:167], a[68:71], v[72:75], v[164:167]
    v_mfma_f32_16x16x32_bf16 v[168:171], a[72:75], v[72:75], v[168:171]
    v_mfma_f32_16x16x32_bf16 v[172:175], a[76:79], v[72:75], v[172:175]
    v_mfma_f32_16x16x32_bf16 v[176:179], a[64:67], v[76:79], v[176:179]
    v_mfma_f32_16x16x32_bf16 v[180:183], a[68:71], v[76:79], v[180:183]
    v_mfma_f32_16x16x32_bf16 v[184:187], a[72:75], v[76:79], v[184:187]
    v_mfma_f32_16x16x32_bf16 v[188:191], a[76:79], v[76:79], v[188:191]
    v_mfma_f32_16x16x32_bf16 v[192:195], a[64:67], v[80:83], v[192:195]
    v_mfma_f32_16x16x32_bf16 v[196:199], a[68:71], v[80:83], v[196:199]
    v_mfma_f32_16x16x32_bf16 v[200:203], a[72:75], v[80:83], v[200:203]
    v_mfma_f32_16x16x32_bf16 v[204:207], a[76:79], v[80:83], v[204:207]
    v_mfma_f32_16x16x32_bf16 v[208:211], a[64:67], v[84:87], v[208:211]
    v_mfma_f32_16x16x32_bf16 v[212:215], a[68:71], v[84:87], v[212:215]
    v_mfma_f32_16x16x32_bf16 v[216:219], a[72:75], v[84:87], v[216:219]
    v_mfma_f32_16x16x32_bf16 v[220:223], a[76:79], v[84:87], v[220:223]
    v_mfma_f32_16x16x32_bf16 v[224:227], a[64:67], v[88:91], v[224:227]
    v_mfma_f32_16x16x32_bf16 v[228:231], a[68:71], v[88:91], v[228:231]
    v_mfma_f32_16x16x32_bf16 v[232:235], a[72:75], v[88:91], v[232:235]
    v_mfma_f32_16x16x32_bf16 v[236:239], a[76:79], v[88:91], v[236:239]
    v_mfma_f32_16x16x32_bf16 v[240:243], a[64:67], v[92:95], v[240:243]
    v_mfma_f32_16x16x32_bf16 v[244:247], a[68:71], v[92:95], v[244:247]
    v_mfma_f32_16x16x32_bf16 v[248:251], a[72:75], v[92:95], v[248:251]
    v_mfma_f32_16x16x32_bf16 v[252:255], a[76:79], v[92:95], v[252:255]
    ds_read_b128 v[64:67], v6 offset:14336
    ds_read_b128 v[68:71], v6 offset:30720
    ds_read_b128 v[72:75], v6 offset:47104
    ds_read_b128 v[76:79], v6 offset:63488
    ds_read_b128 v[80:83], v9 offset:14336
    ds_read_b128 v[84:87], v9 offset:30720
    ds_read_b128 v[88:91], v9 offset:47104
    ds_read_b128 v[92:95], v9 offset:63488
    s_waitcnt vmcnt(8) lgkmcnt(8)
    v_mfma_f32_16x16x32_bf16 v[128:131], a[80:83], v[96:99], v[128:131]
    v_mfma_f32_16x16x32_bf16 v[132:135], a[84:87], v[96:99], v[132:135]
    v_mfma_f32_16x16x32_bf16 v[136:139], a[88:91], v[96:99], v[136:139]
    v_mfma_f32_16x16x32_bf16 v[140:143], a[92:95], v[96:99], v[140:143]
    v_mfma_f32_16x16x32_bf16 v[144:147], a[80:83], v[100:103], v[144:147]
    v_mfma_f32_16x16x32_bf16 v[148:151], a[84:87], v[100:103], v[148:151]
    v_mfma_f32_16x16x32_bf16 v[152:155], a[88:91], v[100:103], v[152:155]
    v_mfma_f32_16x16x32_bf16 v[156:159], a[92:95], v[100:103], v[156:159]
    v_mfma_f32_16x16x32_bf16 v[160:163], a[80:83], v[104:107], v[160:163]
    v_mfma_f32_16x16x32_bf16 v[164:167], a[84:87], v[104:107], v[164:167]
    v_mfma_f32_16x16x32_bf16 v[168:171], a[88:91], v[104:107], v[168:171]
    v_mfma_f32_16x16x32_bf16 v[172:175], a[92:95], v[104:107], v[172:175]
    v_mfma_f32_16x16x32_bf16 v[176:179], a[80:83], v[108:111], v[176:179]
    v_mfma_f32_16x16x32_bf16 v[180:183], a[84:87], v[108:111], v[180:183]
    v_mfma_f32_16x16x32_bf16 v[184:187], a[88:91], v[108:111], v[184:187]
    v_mfma_f32_16x16x32_bf16 v[188:191], a[92:95], v[108:111], v[188:191]
    v_mfma_f32_16x16x32_bf16 v[192:195], a[80:83], v[112:115], v[192:195]
    v_mfma_f32_16x16x32_bf16 v[196:199], a[84:87], v[112:115], v[196:199]
    v_mfma_f32_16x16x32_bf16 v[200:203], a[88:91], v[112:115], v[200:203]
    v_mfma_f32_16x16x32_bf16 v[204:207], a[92:95], v[112:115], v[204:207]
    v_mfma_f32_16x16x32_bf16 v[208:211], a[80:83], v[116:119], v[208:211]
    v_mfma_f32_16x16x32_bf16 v[212:215], a[84:87], v[116:119], v[212:215]
    v_mfma_f32_16x16x32_bf16 v[216:219], a[88:91], v[116:119], v[216:219]
    v_mfma_f32_16x16x32_bf16 v[220:223], a[92:95], v[116:119], v[220:223]
    v_mfma_f32_16x16x32_bf16 v[224:227], a[80:83], v[120:123], v[224:227]
    v_mfma_f32_16x16x32_bf16 v[228:231], a[84:87], v[120:123], v[228:231]
    v_mfma_f32_16x16x32_bf16 v[232:235], a[88:91], v[120:123], v[232:235]
    v_mfma_f32_16x16x32_bf16 v[236:239], a[92:95], v[120:123], v[236:239]
    v_mfma_f32_16x16x32_bf16 v[240:243], a[80:83], v[124:127], v[240:243]
    v_mfma_f32_16x16x32_bf16 v[244:247], a[84:87], v[124:127], v[244:247]
    v_mfma_f32_16x16x32_bf16 v[248:251], a[88:91], v[124:127], v[248:251]
    v_mfma_f32_16x16x32_bf16 v[252:255], a[92:95], v[124:127], v[252:255]
    ds_read_b128 v[96:99], v6 offset:15360
    ds_read_b128 v[100:103], v6 offset:31744
    ds_read_b128 v[104:107], v6 offset:48128
    ds_read_b128 v[108:111], v6 offset:64512
    ds_read_b128 v[112:115], v9 offset:15360
    ds_read_b128 v[116:119], v9 offset:31744
    ds_read_b128 v[120:123], v9 offset:48128
    ds_read_b128 v[124:127], v9 offset:64512
    s_waitcnt vmcnt(4) lgkmcnt(8)
    v_mfma_f32_16x16x32_bf16 v[128:131], a[96:99], v[64:67], v[128:131]
    v_mfma_f32_16x16x32_bf16 v[132:135], a[100:103], v[64:67], v[132:135]
    v_mfma_f32_16x16x32_bf16 v[136:139], a[104:107], v[64:67], v[136:139]
    v_mfma_f32_16x16x32_bf16 v[140:143], a[108:111], v[64:67], v[140:143]
    v_mfma_f32_16x16x32_bf16 v[144:147], a[96:99], v[68:71], v[144:147]
    v_mfma_f32_16x16x32_bf16 v[148:151], a[100:103], v[68:71], v[148:151]
    v_mfma_f32_16x16x32_bf16 v[152:155], a[104:107], v[68:71], v[152:155]
    v_mfma_f32_16x16x32_bf16 v[156:159], a[108:111], v[68:71], v[156:159]
    v_mfma_f32_16x16x32_bf16 v[160:163], a[96:99], v[72:75], v[160:163]
    v_mfma_f32_16x16x32_bf16 v[164:167], a[100:103], v[72:75], v[164:167]
    v_mfma_f32_16x16x32_bf16 v[168:171], a[104:107], v[72:75], v[168:171]
    v_mfma_f32_16x16x32_bf16 v[172:175], a[108:111], v[72:75], v[172:175]
    v_mfma_f32_16x16x32_bf16 v[176:179], a[96:99], v[76:79], v[176:179]
    v_mfma_f32_16x16x32_bf16 v[180:183], a[100:103], v[76:79], v[180:183]
    v_mfma_f32_16x16x32_bf16 v[184:187], a[104:107], v[76:79], v[184:187]
    v_mfma_f32_16x16x32_bf16 v[188:191], a[108:111], v[76:79], v[188:191]
    v_mfma_f32_16x16x32_bf16 v[192:195], a[96:99], v[80:83], v[192:195]
    v_mfma_f32_16x16x32_bf16 v[196:199], a[100:103], v[80:83], v[196:199]
    v_mfma_f32_16x16x32_bf16 v[200:203], a[104:107], v[80:83], v[200:203]
    v_mfma_f32_16x16x32_bf16 v[204:207], a[108:111], v[80:83], v[204:207]
    v_mfma_f32_16x16x32_bf16 v[208:211], a[96:99], v[84:87], v[208:211]
    v_mfma_f32_16x16x32_bf16 v[212:215], a[100:103], v[84:87], v[212:215]
    v_mfma_f32_16x16x32_bf16 v[216:219], a[104:107], v[84:87], v[216:219]
    v_mfma_f32_16x16x32_bf16 v[220:223], a[108:111], v[84:87], v[220:223]
    v_mfma_f32_16x16x32_bf16 v[224:227], a[96:99], v[88:91], v[224:227]
    v_mfma_f32_16x16x32_bf16 v[228:231], a[100:103], v[88:91], v[228:231]
    v_mfma_f32_16x16x32_bf16 v[232:235], a[104:107], v[88:91], v[232:235]
    v_mfma_f32_16x16x32_bf16 v[236:239], a[108:111], v[88:91], v[236:239]
    v_mfma_f32_16x16x32_bf16 v[240:243], a[96:99], v[92:95], v[240:243]
    v_mfma_f32_16x16x32_bf16 v[244:247], a[100:103], v[92:95], v[244:247]
    v_mfma_f32_16x16x32_bf16 v[248:251], a[104:107], v[92:95], v[248:251]
    v_mfma_f32_16x16x32_bf16 v[252:255], a[108:111], v[92:95], v[252:255]
    s_waitcnt vmcnt(0) lgkmcnt(0)
    v_mfma_f32_16x16x32_bf16 v[128:131], a[112:115], v[96:99], v[128:131]
    v_mfma_f32_16x16x32_bf16 v[132:135], a[116:119], v[96:99], v[132:135]
    v_mfma_f32_16x16x32_bf16 v[136:139], a[120:123], v[96:99], v[136:139]
    v_mfma_f32_16x16x32_bf16 v[140:143], a[124:127], v[96:99], v[140:143]
    v_mfma_f32_16x16x32_bf16 v[144:147], a[112:115], v[100:103], v[144:147]
    v_mfma_f32_16x16x32_bf16 v[148:151], a[116:119], v[100:103], v[148:151]
    v_mfma_f32_16x16x32_bf16 v[152:155], a[120:123], v[100:103], v[152:155]
    v_mfma_f32_16x16x32_bf16 v[156:159], a[124:127], v[100:103], v[156:159]
    v_mfma_f32_16x16x32_bf16 v[160:163], a[112:115], v[104:107], v[160:163]
    v_mfma_f32_16x16x32_bf16 v[164:167], a[116:119], v[104:107], v[164:167]
    v_mfma_f32_16x16x32_bf16 v[168:171], a[120:123], v[104:107], v[168:171]
    v_mfma_f32_16x16x32_bf16 v[172:175], a[124:127], v[104:107], v[172:175]
    v_mfma_f32_16x16x32_bf16 v[176:179], a[112:115], v[108:111], v[176:179]
    v_mfma_f32_16x16x32_bf16 v[180:183], a[116:119], v[108:111], v[180:183]
    v_mfma_f32_16x16x32_bf16 v[184:187], a[120:123], v[108:111], v[184:187]
    v_mfma_f32_16x16x32_bf16 v[188:191], a[124:127], v[108:111], v[188:191]
    v_mfma_f32_16x16x32_bf16 v[192:195], a[112:115], v[112:115], v[192:195]
    v_mfma_f32_16x16x32_bf16 v[196:199], a[116:119], v[112:115], v[196:199]
    v_mfma_f32_16x16x32_bf16 v[200:203], a[120:123], v[112:115], v[200:203]
    v_mfma_f32_16x16x32_bf16 v[204:207], a[124:127], v[112:115], v[204:207]
    v_mfma_f32_16x16x32_bf16 v[208:211], a[112:115], v[116:119], v[208:211]
    v_mfma_f32_16x16x32_bf16 v[212:215], a[116:119], v[116:119], v[212:215]
    v_mfma_f32_16x16x32_bf16 v[216:219], a[120:123], v[116:119], v[216:219]
    v_mfma_f32_16x16x32_bf16 v[220:223], a[124:127], v[116:119], v[220:223]
    v_mfma_f32_16x16x32_bf16 v[224:227], a[112:115], v[120:123], v[224:227]
    v_mfma_f32_16x16x32_bf16 v[228:231], a[116:119], v[120:123], v[228:231]
    v_mfma_f32_16x16x32_bf16 v[232:235], a[120:123], v[120:123], v[232:235]
    v_mfma_f32_16x16x32_bf16 v[236:239], a[124:127], v[120:123], v[236:239]
    v_mfma_f32_16x16x32_bf16 v[240:243], a[112:115], v[124:127], v[240:243]
    v_mfma_f32_16x16x32_bf16 v[244:247], a[116:119], v[124:127], v[244:247]
    v_mfma_f32_16x16x32_bf16 v[248:251], a[120:123], v[124:127], v[248:251]
    v_mfma_f32_16x16x32_bf16 v[252:255], a[124:127], v[124:127], v[252:255]
    s_nop 7
    s_nop 1
    s_lshr_b32 s34, s26, 6
    s_lshl_b32 s34, s34, 24
    s_and_b32 s35, s26, 63
    s_lshl_b32 s35, s35, 11
    s_add_u32 s34, s34, s35
    s_lshl_b32 s35, s6, 20
    s_add_u32 s34, s34, s35
    s_add_u32 s34, s34, 33554432
    v_cvt_pk_bf16_f32 v12, v128, v129
    v_cvt_pk_bf16_f32 v13, v130, v131
    v_cvt_pk_bf16_f32 v14, v132, v133
    v_cvt_pk_bf16_f32 v15, v134, v135
    buffer_store_dwordx4 v[12:15], v6, s[12:15], s34 offen offset:0 sc1
    v_cvt_pk_bf16_f32 v16, v136, v137
    v_cvt_pk_bf16_f32 v17, v138, v139
    v_cvt_pk_bf16_f32 v18, v140, v141
    v_cvt_pk_bf16_f32 v19, v142, v143
    buffer_store_dwordx4 v[16:19], v6, s[12:15], s34 offen offset:1024 sc1
    s_add_u32 s34, s34, 0x20000
    v_cvt_pk_bf16_f32 v20, v144, v145
    v_cvt_pk_bf16_f32 v21, v146, v147
    v_cvt_pk_bf16_f32 v22, v148, v149
    v_cvt_pk_bf16_f32 v23, v150, v151
    buffer_store_dwordx4 v[20:23], v6, s[12:15], s34 offen offset:0 sc1
    v_cvt_pk_bf16_f32 v24, v152, v153
    v_cvt_pk_bf16_f32 v25, v154, v155
    v_cvt_pk_bf16_f32 v26, v156, v157
    v_cvt_pk_bf16_f32 v27, v158, v159
    buffer_store_dwordx4 v[24:27], v6, s[12:15], s34 offen offset:1024 sc1
    s_add_u32 s34, s34, 0x20000
    v_cvt_pk_bf16_f32 v12, v160, v161
    v_cvt_pk_bf16_f32 v13, v162, v163
    v_cvt_pk_bf16_f32 v14, v164, v165
    v_cvt_pk_bf16_f32 v15, v166, v167
    buffer_store_dwordx4 v[12:15], v6, s[12:15], s34 offen offset:0 sc1
    v_cvt_pk_bf16_f32 v16, v168, v169
    v_cvt_pk_bf16_f32 v17, v170, v171
    v_cvt_pk_bf16_f32 v18, v172, v173
    v_cvt_pk_bf16_f32 v19, v174, v175
    buffer_store_dwordx4 v[16:19], v6, s[12:15], s34 offen offset:1024 sc1
    s_add_u32 s34, s34, 0x20000
    v_cvt_pk_bf16_f32 v20, v176, v177
    v_cvt_pk_bf16_f32 v21, v178, v179
    v_cvt_pk_bf16_f32 v22, v180, v181
    v_cvt_pk_bf16_f32 v23, v182, v183
    buffer_store_dwordx4 v[20:23], v6, s[12:15], s34 offen offset:0 sc1
    v_cvt_pk_bf16_f32 v24, v184, v185
    v_cvt_pk_bf16_f32 v25, v186, v187
    v_cvt_pk_bf16_f32 v26, v188, v189
    v_cvt_pk_bf16_f32 v27, v190, v191
    buffer_store_dwordx4 v[24:27], v6, s[12:15], s34 offen offset:1024 sc1
    s_add_u32 s34, s34, 0x20000
    v_cvt_pk_bf16_f32 v12, v192, v193
    v_cvt_pk_bf16_f32 v13, v194, v195
    v_cvt_pk_bf16_f32 v14, v196, v197
    v_cvt_pk_bf16_f32 v15, v198, v199
    buffer_store_dwordx4 v[12:15], v6, s[12:15], s34 offen offset:0 sc1
    v_cvt_pk_bf16_f32 v16, v200, v201
    v_cvt_pk_bf16_f32 v17, v202, v203
    v_cvt_pk_bf16_f32 v18, v204, v205
    v_cvt_pk_bf16_f32 v19, v206, v207
    buffer_store_dwordx4 v[16:19], v6, s[12:15], s34 offen offset:1024 sc1
    s_add_u32 s34, s34, 0x20000
    v_cvt_pk_bf16_f32 v20, v208, v209
    v_cvt_pk_bf16_f32 v21, v210, v211
    v_cvt_pk_bf16_f32 v22, v212, v213
    v_cvt_pk_bf16_f32 v23, v214, v215
    buffer_store_dwordx4 v[20:23], v6, s[12:15], s34 offen offset:0 sc1
    v_cvt_pk_bf16_f32 v24, v216, v217
    v_cvt_pk_bf16_f32 v25, v218, v219
    v_cvt_pk_bf16_f32 v26, v220, v221
    v_cvt_pk_bf16_f32 v27, v222, v223
    buffer_store_dwordx4 v[24:27], v6, s[12:15], s34 offen offset:1024 sc1
    s_add_u32 s34, s34, 0x20000
    v_cvt_pk_bf16_f32 v12, v224, v225
    v_cvt_pk_bf16_f32 v13, v226, v227
    v_cvt_pk_bf16_f32 v14, v228, v229
    v_cvt_pk_bf16_f32 v15, v230, v231
    buffer_store_dwordx4 v[12:15], v6, s[12:15], s34 offen offset:0 sc1
    v_cvt_pk_bf16_f32 v16, v232, v233
    v_cvt_pk_bf16_f32 v17, v234, v235
    v_cvt_pk_bf16_f32 v18, v236, v237
    v_cvt_pk_bf16_f32 v19, v238, v239
    buffer_store_dwordx4 v[16:19], v6, s[12:15], s34 offen offset:1024 sc1
    s_add_u32 s34, s34, 0x20000
    v_cvt_pk_bf16_f32 v20, v240, v241
    v_cvt_pk_bf16_f32 v21, v242, v243
    v_cvt_pk_bf16_f32 v22, v244, v245
    v_cvt_pk_bf16_f32 v23, v246, v247
    buffer_store_dwordx4 v[20:23], v6, s[12:15], s34 offen offset:0 sc1
    v_cvt_pk_bf16_f32 v24, v248, v249
    v_cvt_pk_bf16_f32 v25, v250, v251
    v_cvt_pk_bf16_f32 v26, v252, v253
    v_cvt_pk_bf16_f32 v27, v254, v255
    buffer_store_dwordx4 v[24:27], v6, s[12:15], s34 offen offset:1024 sc1
    s_add_u32 s34, s34, 0x20000
    s_branch qkv_next
qkv_vbody:
    buffer_load_dwordx4 a[112:115], v8, s[12:15], s28 offen
    buffer_load_dwordx4 a[116:119], v8, s[12:15], s29 offen
    buffer_load_dwordx4 a[120:123], v8, s[12:15], s30 offen
    buffer_load_dwordx4 a[124:127], v8, s[12:15], s31 offen
    v_add_u32 v8, 1024, v8
    ds_read_b128 v[96:99], v6 offset:1024
    ds_read_b128 v[100:103], v6 offset:17408
    ds_read_b128 v[104:107], v6 offset:33792
    ds_read_b128 v[108:111], v6 offset:50176
    ds_read_b128 v[112:115], v9 offset:1024
    ds_read_b128 v[116:119], v9 offset:17408
    ds_read_b128 v[120:123], v9 offset:33792
    ds_read_b128 v[124:127], v9 offset:50176
    s_waitcnt vmcnt(28) lgkmcnt(8)
    v_mfma_f32_16x16x32_bf16 v[128:131], v[64:67], a[0:3], 0
    v_mfma_f32_16x16x32_bf16 v[132:135], v[64:67], a[4:7], 0
    v_mfma_f32_16x16x32_bf16 v[136:139], v[64:67], a[8:11], 0
    v_mfma_f32_16x16x32_bf16 v[140:143], v[64:67], a[12:15], 0
    v_mfma_f32_16x16x32_bf16 v[144:147], v[68:71], a[0:3], 0
    v_mfma_f32_16x16x32_bf16 v[148:151], v[68:71], a[4:7], 0
    v_mfma_f32_16x16x32_bf16 v[152:155], v[68:71], a[8:11], 0
    v_mfma_f32_16x16x32_bf16 v[156:159], v[68:71], a[12:15], 0
    v_mfma_f32_16x16x32_bf16 v[160:163], v[72:75], a[0:3], 0
    v_mfma_f32_16x16x32_bf16 v[164:167], v[72:75], a[4:7], 0
    v_mfma_f32_16x16x32_bf16 v[168:171], v[72:75], a[8:11], 0
    v_mfma_f32_16x16x32_bf16 v[172:175], v[72:75], a[12:15], 0
    v_mfma_f32_16x16x32_bf16 v[176:179], v[76:79], a[0:3], 0
    v_mfma_f32_16x16x32_bf16 v[180:183], v[76:79], a[4:7], 0
    v_mfma_f32_16x16x32_bf16 v[184:187], v[76:79], a[8:11], 0
    v_mfma_f32_16x16x32_bf16 v[188:191], v[76:79], a[12:15], 0
    v_mfma_f32_16x16x32_bf16 v[192:195], v[80:83], a[0:3], 0
    v_mfma_f32_16x16x32_bf16 v[196:199], v[80:83], a[4:7], 0
    v_mfma_f32_16x16x32_bf16 v[200:203], v[80:83], a[8:11], 0
    v_mfma_f32_16x16x32_bf16 v[204:207], v[80:83], a[12:15], 0
    v_mfma_f32_16x16x32_bf16 v[208:211], v[84:87], a[0:3], 0
    v_mfma_f32_16x16x32_bf16 v[212:215], v[84:87], a[4:7], 0
    v_mfma_f32_16x16x32_bf16 v[216:219], v[84:87], a[8:11], 0
    v_mfma_f32_16x16x32_bf16 v[220:223], v[84:87], a[12:15], 0
    v_mfma_f32_16x16x32_bf16 v[224:227], v[88:91], a[0:3], 0
    v_mfma_f32_16x16x32_bf16 v[228:231], v[88:91], a[4:7], 0
    v_mfma_f32_16x16x32_bf16 v[232:235], v[88:91], a[8:11], 0
    v_mfma_f32_16x16x32_bf16 v[236:239], v[88:91], a[12:15], 0
    v_mfma_f32_16x16x32_bf16 v[240:243], v[92:95], a[0:3], 0
    v_mfma_f32_16x16x32_bf16 v[244:247], v[92:95], a[4:7], 0
    v_mfma_f32_16x16x32_bf16 v[248:251], v[92:95], a[8:11], 0
    v_mfma_f32_16x16x32_bf16 v[252:255], v[92:95], a[12:15], 0
    buffer_load_dwordx4 a[0:3], v8, s[12:15], s28 offen
    buffer_load_dwordx4 a[4:7], v8, s[12:15], s29 offen
    buffer_load_dwordx4 a[8:11], v8, s[12:15], s30 offen
    buffer_load_dwordx4 a[12:15], v8, s[12:15], s31 offen
    v_add_u32 v8, 1024, v8
    ds_read_b128 v[64:67], v6 offset:2048
    ds_read_b128 v[68:71], v6 offset:18432
    ds_read_b128 v[72:75], v6 offset:34816
    ds_read_b128 v[76:79], v6 offset:51200
    ds_read_b128 v[80:83], v9 offset:2048
    ds_read_b128 v[84:87], v9 offset:18432
    ds_read_b128 v[88:91], v9 offset:34816
    ds_read_b128 v[92:95], v9 offset:51200
    s_waitcnt vmcnt(28) lgkmcnt(8)
    v_mfma_f32_16x16x32_bf16 v[128:131], v[96:99], a[16:19], v[128:131]
    v_mfma_f32_16x16x32_bf16 v[132:135], v[96:99], a[20:23], v[132:135]
    v_mfma_f32_16x16x32_bf16 v[136:139], v[96:99], a[24:27], v[136:139]
    v_mfma_f32_16x16x32_bf16 v[140:143], v[96:99], a[28:31], v[140:143]
    v_mfma_f32_16x16x32_bf16 v[144:147], v[100:103], a[16:19], v[144:147]
    v_mfma_f32_16x16x32_bf16 v[148:151], v[100:103], a[20:23], v[148:151]
    v_mfma_f32_16x16x32_bf16 v[152:155], v[100:103], a[24:27], v[152:155]
    v_mfma_f32_16x16x32_bf16 v[156:159], v[100:103], a[28:31], v[156:159]
    v_mfma_f32_16x16x32_bf16 v[160:163], v[104:107], a[16:19], v[160:163]
    v_mfma_f32_16x16x32_bf16 v[164:167], v[104:107], a[20:23], v[164:167]
    v_mfma_f32_16x16x32_bf16 v[168:171], v[104:107], a[24:27], v[168:171]
    v_mfma_f32_16x16x32_bf16 v[172:175], v[104:107], a[28:31], v[172:175]
    v_mfma_f32_16x16x32_bf16 v[176:179], v[108:111], a[16:19], v[176:179]
    v_mfma_f32_16x16x32_bf16 v[180:183], v[108:111], a[20:23], v[180:183]
    v_mfma_f32_16x16x32_bf16 v[184:187], v[108:111], a[24:27], v[184:187]
    v_mfma_f32_16x16x32_bf16 v[188:191], v[108:111], a[28:31], v[188:191]
    v_mfma_f32_16x16x32_bf16 v[192:195], v[112:115], a[16:19], v[192:195]
    v_mfma_f32_16x16x32_bf16 v[196:199], v[112:115], a[20:23], v[196:199]
    v_mfma_f32_16x16x32_bf16 v[200:203], v[112:115], a[24:27], v[200:203]
    v_mfma_f32_16x16x32_bf16 v[204:207], v[112:115], a[28:31], v[204:207]
    v_mfma_f32_16x16x32_bf16 v[208:211], v[116:119], a[16:19], v[208:211]
    v_mfma_f32_16x16x32_bf16 v[212:215], v[116:119], a[20:23], v[212:215]
    v_mfma_f32_16x16x32_bf16 v[216:219], v[116:119], a[24:27], v[216:219]
    v_mfma_f32_16x16x32_bf16 v[220:223], v[116:119], a[28:31], v[220:223]
    v_mfma_f32_16x16x32_bf16 v[224:227], v[120:123], a[16:19], v[224:227]
    v_mfma_f32_16x16x32_bf16 v[228:231], v[120:123], a[20:23], v[228:231]
    v_mfma_f32_16x16x32_bf16 v[232:235], v[120:123], a[24:27], v[232:235]
    v_mfma_f32_16x16x32_bf16 v[236:239], v[120:123], a[28:31], v[236:239]
    v_mfma_f32_16x16x32_bf16 v[240:243], v[124:127], a[16:19], v[240:243]
    v_mfma_f32_16x16x32_bf16 v[244:247], v[124:127], a[20:23], v[244:247]
    v_mfma_f32_16x16x32_bf16 v[248:251], v[124:127], a[24:27], v[248:251]
    v_mfma_f32_16x16x32_bf16 v[252:255], v[124:127], a[28:31], v[252:255]
    buffer_load_dwordx4 a[16:19], v8, s[12:15], s28 offen
    buffer_load_dwordx4 a[20:23], v8, s[12:15], s29 offen
    buffer_load_dwordx4 a[24:27], v8, s[12:15], s30 offen
    buffer_load_dwordx4 a[28:31], v8, s[12:15], s31 offen
    v_add_u32 v8, 1024, v8
    ds_read_b128 v[96:99], v6 offset:3072
    ds_read_b128 v[100:103], v6 offset:19456
    ds_read_b128 v[104:107], v6 offset:35840
    ds_read_b128 v[108:111], v6 offset:52224
    ds_read_b128 v[112:115], v9 offset:3072
    ds_read_b128 v[116:119], v9 offset:19456
    ds_read_b128 v[120:123], v9 offset:35840
    ds_read_b128 v[124:127], v9 offset:52224
    s_waitcnt vmcnt(28) lgkmcnt(8)
    v_mfma_f32_16x16x32_bf16 v[128:131], v[64:67], a[32:35], v[128:131]
    v_mfma_f32_16x16x32_bf16 v[132:135], v[64:67], a[36:39], v[132:135]
    v_mfma_f32_16x16x32_bf16 v[136:139], v[64:67], a[40:43], v[136:139]
    v_mfma_f32_16x16x32_bf16 v[140:143], v[64:67], a[44:47], v[140:143]
    v_mfma_f32_16x16x32_bf16 v[144:147], v[68:71], a[32:35], v[144:147]
    v_mfma_f32_16x16x32_bf16 v[148:151], v[68:71], a[36:39], v[148:151]
    v_mfma_f32_16x16x32_bf16 v[152:155], v[68:71], a[40:43], v[152:155]
    v_mfma_f32_16x16x32_bf16 v[156:159], v[68:71], a[44:47], v[156:159]
    v_mfma_f32_16x16x32_bf16 v[160:163], v[72:75], a[32:35], v[160:163]
    v_mfma_f32_16x16x32_bf16 v[164:167], v[72:75], a[36:39], v[164:167]
    v_mfma_f32_16x16x32_bf16 v[168:171], v[72:75], a[40:43], v[168:171]
    v_mfma_f32_16x16x32_bf16 v[172:175], v[72:75], a[44:47], v[172:175]
    v_mfma_f32_16x16x32_bf16 v[176:179], v[76:79], a[32:35], v[176:179]
    v_mfma_f32_16x16x32_bf16 v[180:183], v[76:79], a[36:39], v[180:183]
    v_mfma_f32_16x16x32_bf16 v[184:187], v[76:79], a[40:43], v[184:187]
    v_mfma_f32_16x16x32_bf16 v[188:191], v[76:79], a[44:47], v[188:191]
    v_mfma_f32_16x16x32_bf16 v[192:195], v[80:83], a[32:35], v[192:195]
    v_mfma_f32_16x16x32_bf16 v[196:199], v[80:83], a[36:39], v[196:199]
    v_mfma_f32_16x16x32_bf16 v[200:203], v[80:83], a[40:43], v[200:203]
    v_mfma_f32_16x16x32_bf16 v[204:207], v[80:83], a[44:47], v[204:207]
    v_mfma_f32_16x16x32_bf16 v[208:211], v[84:87], a[32:35], v[208:211]
    v_mfma_f32_16x16x32_bf16 v[212:215], v[84:87], a[36:39], v[212:215]
    v_mfma_f32_16x16x32_bf16 v[216:219], v[84:87], a[40:43], v[216:219]
    v_mfma_f32_16x16x32_bf16 v[220:223], v[84:87], a[44:47], v[220:223]
    v_mfma_f32_16x16x32_bf16 v[224:227], v[88:91], a[32:35], v[224:227]
    v_mfma_f32_16x16x32_bf16 v[228:231], v[88:91], a[36:39], v[228:231]
    v_mfma_f32_16x16x32_bf16 v[232:235], v[88:91], a[40:43], v[232:235]
    v_mfma_f32_16x16x32_bf16 v[236:239], v[88:91], a[44:47], v[236:239]
    v_mfma_f32_16x16x32_bf16 v[240:243], v[92:95], a[32:35], v[240:243]
    v_mfma_f32_16x16x32_bf16 v[244:247], v[92:95], a[36:39], v[244:247]
    v_mfma_f32_16x16x32_bf16 v[248:251], v[92:95], a[40:43], v[248:251]
    v_mfma_f32_16x16x32_bf16 v[252:255], v[92:95], a[44:47], v[252:255]
    buffer_load_dwordx4 a[32:35], v8, s[12:15], s28 offen
    buffer_load_dwordx4 a[36:39], v8, s[12:15], s29 offen
    buffer_load_dwordx4 a[40:43], v8, s[12:15], s30 offen
    buffer_load_dwordx4 a[44:47], v8, s[12:15], s31 offen
    v_add_u32 v8, 1024, v8
    ds_read_b128 v[64:67], v6 offset:4096
    ds_read_b128 v[68:71], v6 offset:20480
    ds_read_b128 v[72:75], v6 offset:36864
    ds_read_b128 v[76:79], v6 offset:53248
    ds_read_b128 v[80:83], v9 offset:4096
    ds_read_b128 v[84:87], v9 offset:20480
    ds_read_b128 v[88:91], v9 offset:36864
    ds_read_b128 v[92:95], v9 offset:53248
    s_waitcnt vmcnt(28) lgkmcnt(8)
    v_mfma_f32_16x16x32_bf16 v[128:131], v[96:99], a[48:51], v[128:131]
    v_mfma_f32_16x16x32_bf16 v[132:135], v[96:99], a[52:55], v[132:135]
    v_mfma_f32_16x16x32_bf16 v[136:139], v[96:99], a[56:59], v[136:139]
    v_mfma_f32_16x16x32_bf16 v[140:143], v[96:99], a[60:63], v[140:143]
    v_mfma_f32_16x16x32_bf16 v[144:147], v[100:103], a[48:51], v[144:147]
    v_mfma_f32_16x16x32_bf16 v[148:151], v[100:103], a[52:55], v[148:151]
    v_mfma_f32_16x16x32_bf16 v[152:155], v[100:103], a[56:59], v[152:155]
    v_mfma_f32_16x16x32_bf16 v[156:159], v[100:103], a[60:63], v[156:159]
    v_mfma_f32_16x16x32_bf16 v[160:163], v[104:107], a[48:51], v[160:163]
    v_mfma_f32_16x16x32_bf16 v[164:167], v[104:107], a[52:55], v[164:167]
    v_mfma_f32_16x16x32_bf16 v[168:171], v[104:107], a[56:59], v[168:171]
    v_mfma_f32_16x16x32_bf16 v[172:175], v[104:107], a[60:63], v[172:175]
    v_mfma_f32_16x16x32_bf16 v[176:179], v[108:111], a[48:51], v[176:179]
    v_mfma_f32_16x16x32_bf16 v[180:183], v[108:111], a[52:55], v[180:183]
    v_mfma_f32_16x16x32_bf16 v[184:187], v[108:111], a[56:59], v[184:187]
    v_mfma_f32_16x16x32_bf16 v[188:191], v[108:111], a[60:63], v[188:191]
    v_mfma_f32_16x16x32_bf16 v[192:195], v[112:115], a[48:51], v[192:195]
    v_mfma_f32_16x16x32_bf16 v[196:199], v[112:115], a[52:55], v[196:199]
    v_mfma_f32_16x16x32_bf16 v[200:203], v[112:115], a[56:59], v[200:203]
    v_mfma_f32_16x16x32_bf16 v[204:207], v[112:115], a[60:63], v[204:207]
    v_mfma_f32_16x16x32_bf16 v[208:211], v[116:119], a[48:51], v[208:211]
    v_mfma_f32_16x16x32_bf16 v[212:215], v[116:119], a[52:55], v[212:215]
    v_mfma_f32_16x16x32_bf16 v[216:219], v[116:119], a[56:59], v[216:219]
    v_mfma_f32_16x16x32_bf16 v[220:223], v[116:119], a[60:63], v[220:223]
    v_mfma_f32_16x16x32_bf16 v[224:227], v[120:123], a[48:51], v[224:227]
    v_mfma_f32_16x16x32_bf16 v[228:231], v[120:123], a[52:55], v[228:231]
    v_mfma_f32_16x16x32_bf16 v[232:235], v[120:123], a[56:59], v[232:235]
    v_mfma_f32_16x16x32_bf16 v[236:239], v[120:123], a[60:63], v[236:239]
    v_mfma_f32_16x16x32_bf16 v[240:243], v[124:127], a[48:51], v[240:243]
    v_mfma_f32_16x16x32_bf16 v[244:247], v[124:127], a[52:55], v[244:247]
    v_mfma_f32_16x16x32_bf16 v[248:251], v[124:127], a[56:59], v[248:251]
    v_mfma_f32_16x16x32_bf16 v[252:255], v[124:127], a[60:63], v[252:255]
    buffer_load_dwordx4 a[48:51], v8, s[12:15], s28 offen
    buffer_load_dwordx4 a[52:55], v8, s[12:15], s29 offen
    buffer_load_dwordx4 a[56:59], v8, s[12:15], s30 offen
    buffer_load_dwordx4 a[60:63], v8, s[12:15], s31 offen
    v_add_u32 v8, 1024, v8
    ds_read_b128 v[96:99], v6 offset:5120
    ds_read_b128 v[100:103], v6 offset:21504
    ds_read_b128 v[104:107], v6 offset:37888
    ds_read_b128 v[108:111], v6 offset:54272
    ds_read_b128 v[112:115], v9 offset:5120
    ds_read_b128 v[116:119], v9 offset:21504
    ds_read_b128 v[120:123], v9 offset:37888
    ds_read_b128 v[124:127], v9 offset:54272
    s_waitcnt vmcnt(28) lgkmcnt(8)
    v_mfma_f32_16x16x32_bf16 v[128:131], v[64:67], a[64:67], v[128:131]
    v_mfma_f32_16x16x32_bf16 v[132:135], v[64:67], a[68:71], v[132:135]
    v_mfma_f32_16x16x32_bf16 v[136:139], v[64:67], a[72:75], v[136:139]
    v_mfma_f32_16x16x32_bf16 v[140:143], v[64:67], a[76:79], v[140:143]
    v_mfma_f32_16x16x32_bf16 v[144:147], v[68:71], a[64:67], v[144:147]
    v_mfma_f32_16x16x32_bf16 v[148:151], v[68:71], a[68:71], v[148:151]
    v_mfma_f32_16x16x32_bf16 v[152:155], v[68:71], a[72:75], v[152:155]
    v_mfma_f32_16x16x32_bf16 v[156:159], v[68:71], a[76:79], v[156:159]
    v_mfma_f32_16x16x32_bf16 v[160:163], v[72:75], a[64:67], v[160:163]
    v_mfma_f32_16x16x32_bf16 v[164:167], v[72:75], a[68:71], v[164:167]
    v_mfma_f32_16x16x32_bf16 v[168:171], v[72:75], a[72:75], v[168:171]
    v_mfma_f32_16x16x32_bf16 v[172:175], v[72:75], a[76:79], v[172:175]
    v_mfma_f32_16x16x32_bf16 v[176:179], v[76:79], a[64:67], v[176:179]
    v_mfma_f32_16x16x32_bf16 v[180:183], v[76:79], a[68:71], v[180:183]
    v_mfma_f32_16x16x32_bf16 v[184:187], v[76:79], a[72:75], v[184:187]
    v_mfma_f32_16x16x32_bf16 v[188:191], v[76:79], a[76:79], v[188:191]
    v_mfma_f32_16x16x32_bf16 v[192:195], v[80:83], a[64:67], v[192:195]
    v_mfma_f32_16x16x32_bf16 v[196:199], v[80:83], a[68:71], v[196:199]
    v_mfma_f32_16x16x32_bf16 v[200:203], v[80:83], a[72:75], v[200:203]
    v_mfma_f32_16x16x32_bf16 v[204:207], v[80:83], a[76:79], v[204:207]
    v_mfma_f32_16x16x32_bf16 v[208:211], v[84:87], a[64:67], v[208:211]
    v_mfma_f32_16x16x32_bf16 v[212:215], v[84:87], a[68:71], v[212:215]
    v_mfma_f32_16x16x32_bf16 v[216:219], v[84:87], a[72:75], v[216:219]
    v_mfma_f32_16x16x32_bf16 v[220:223], v[84:87], a[76:79], v[220:223]
    v_mfma_f32_16x16x32_bf16 v[224:227], v[88:91], a[64:67], v[224:227]
    v_mfma_f32_16x16x32_bf16 v[228:231], v[88:91], a[68:71], v[228:231]
    v_mfma_f32_16x16x32_bf16 v[232:235], v[88:91], a[72:75], v[232:235]
    v_mfma_f32_16x16x32_bf16 v[236:239], v[88:91], a[76:79], v[236:239]
    v_mfma_f32_16x16x32_bf16 v[240:243], v[92:95], a[64:67], v[240:243]
    v_mfma_f32_16x16x32_bf16 v[244:247], v[92:95], a[68:71], v[244:247]
    v_mfma_f32_16x16x32_bf16 v[248:251], v[92:95], a[72:75], v[248:251]
    v_mfma_f32_16x16x32_bf16 v[252:255], v[92:95], a[76:79], v[252:255]
    buffer_load_dwordx4 a[64:67], v8, s[12:15], s28 offen
    buffer_load_dwordx4 a[68:71], v8, s[12:15], s29 offen
    buffer_load_dwordx4 a[72:75], v8, s[12:15], s30 offen
    buffer_load_dwordx4 a[76:79], v8, s[12:15], s31 offen
    v_add_u32 v8, 1024, v8
    ds_read_b128 v[64:67], v6 offset:6144
    ds_read_b128 v[68:71], v6 offset:22528
    ds_read_b128 v[72:75], v6 offset:38912
    ds_read_b128 v[76:79], v6 offset:55296
    ds_read_b128 v[80:83], v9 offset:6144
    ds_read_b128 v[84:87], v9 offset:22528
    ds_read_b128 v[88:91], v9 offset:38912
    ds_read_b128 v[92:95], v9 offset:55296
    s_waitcnt vmcnt(28) lgkmcnt(8)
    v_mfma_f32_16x16x32_bf16 v[128:131], v[96:99], a[80:83], v[128:131]
    v_mfma_f32_16x16x32_bf16 v[132:135], v[96:99], a[84:87], v[132:135]
    v_mfma_f32_16x16x32_bf16 v[136:139], v[96:99], a[88:91], v[136:139]
    v_mfma_f32_16x16x32_bf16 v[140:143], v[96:99], a[92:95], v[140:143]
    v_mfma_f32_16x16x32_bf16 v[144:147], v[100:103], a[80:83], v[144:147]
    v_mfma_f32_16x16x32_bf16 v[148:151], v[100:103], a[84:87], v[148:151]
    v_mfma_f32_16x16x32_bf16 v[152:155], v[100:103], a[88:91], v[152:155]
    v_mfma_f32_16x16x32_bf16 v[156:159], v[100:103], a[92:95], v[156:159]
    v_mfma_f32_16x16x32_bf16 v[160:163], v[104:107], a[80:83], v[160:163]
    v_mfma_f32_16x16x32_bf16 v[164:167], v[104:107], a[84:87], v[164:167]
    v_mfma_f32_16x16x32_bf16 v[168:171], v[104:107], a[88:91], v[168:171]
    v_mfma_f32_16x16x32_bf16 v[172:175], v[104:107], a[92:95], v[172:175]
    v_mfma_f32_16x16x32_bf16 v[176:179], v[108:111], a[80:83], v[176:179]
    v_mfma_f32_16x16x32_bf16 v[180:183], v[108:111], a[84:87], v[180:183]
    v_mfma_f32_16x16x32_bf16 v[184:187], v[108:111], a[88:91], v[184:187]
    v_mfma_f32_16x16x32_bf16 v[188:191], v[108:111], a[92:95], v[188:191]
    v_mfma_f32_16x16x32_bf16 v[192:195], v[112:115], a[80:83], v[192:195]
    v_mfma_f32_16x16x32_bf16 v[196:199], v[112:115], a[84:87], v[196:199]
    v_mfma_f32_16x16x32_bf16 v[200:203], v[112:115], a[88:91], v[200:203]
    v_mfma_f32_16x16x32_bf16 v[204:207], v[112:115], a[92:95], v[204:207]
    v_mfma_f32_16x16x32_bf16 v[208:211], v[116:119], a[80:83], v[208:211]
    v_mfma_f32_16x16x32_bf16 v[212:215], v[116:119], a[84:87], v[212:215]
    v_mfma_f32_16x16x32_bf16 v[216:219], v[116:119], a[88:91], v[216:219]
    v_mfma_f32_16x16x32_bf16 v[220:223], v[116:119], a[92:95], v[220:223]
    v_mfma_f32_16x16x32_bf16 v[224:227], v[120:123], a[80:83], v[224:227]
    v_mfma_f32_16x16x32_bf16 v[228:231], v[120:123], a[84:87], v[228:231]
    v_mfma_f32_16x16x32_bf16 v[232:235], v[120:123], a[88:91], v[232:235]
    v_mfma_f32_16x16x32_bf16 v[236:239], v[120:123], a[92:95], v[236:239]
    v_mfma_f32_16x16x32_bf16 v[240:243], v[124:127], a[80:83], v[240:243]
    v_mfma_f32_16x16x32_bf16 v[244:247], v[124:127], a[84:87], v[244:247]
    v_mfma_f32_16x16x32_bf16 v[248:251], v[124:127], a[88:91], v[248:251]
    v_mfma_f32_16x16x32_bf16 v[252:255], v[124:127], a[92:95], v[252:255]
    buffer_load_dwordx4 a[80:83], v8, s[12:15], s28 offen
    buffer_load_dwordx4 a[84:87], v8, s[12:15], s29 offen
    buffer_load_dwordx4 a[88:91], v8, s[12:15], s30 offen
    buffer_load_dwordx4 a[92:95], v8, s[12:15], s31 offen
    v_add_u32 v8, 1024, v8
    ds_read_b128 v[96:99], v6 offset:7168
    ds_read_b128 v[100:103], v6 offset:23552
    ds_read_b128 v[104:107], v6 offset:39936
    ds_read_b128 v[108:111], v6 offset:56320
    ds_read_b128 v[112:115], v9 offset:7168
    ds_read_b128 v[116:119], v9 offset:23552
    ds_read_b128 v[120:123], v9 offset:39936
    ds_read_b128 v[124:127], v9 offset:56320
    s_waitcnt vmcnt(28) lgkmcnt(8)
    v_mfma_f32_16x16x32_bf16 v[128:131], v[64:67], a[96:99], v[128:131]
    v_mfma_f32_16x16x32_bf16 v[132:135], v[64:67], a[100:103], v[132:135]
    v_mfma_f32_16x16x32_bf16 v[136:139], v[64:67], a[104:107], v[136:139]
    v_mfma_f32_16x16x32_bf16 v[140:143], v[64:67], a[108:111], v[140:143]
    v_mfma_f32_16x16x32_bf16 v[144:147], v[68:71], a[96:99], v[144:147]
    v_mfma_f32_16x16x32_bf16 v[148:151], v[68:71], a[100:103], v[148:151]
    v_mfma_f32_16x16x32_bf16 v[152:155], v[68:71], a[104:107], v[152:155]
    v_mfma_f32_16x16x32_bf16 v[156:159], v[68:71], a[108:111], v[156:159]
    v_mfma_f32_16x16x32_bf16 v[160:163], v[72:75], a[96:99], v[160:163]
    v_mfma_f32_16x16x32_bf16 v[164:167], v[72:75], a[100:103], v[164:167]
    v_mfma_f32_16x16x32_bf16 v[168:171], v[72:75], a[104:107], v[168:171]
    v_mfma_f32_16x16x32_bf16 v[172:175], v[72:75], a[108:111], v[172:175]
    v_mfma_f32_16x16x32_bf16 v[176:179], v[76:79], a[96:99], v[176:179]
    v_mfma_f32_16x16x32_bf16 v[180:183], v[76:79], a[100:103], v[180:183]
    v_mfma_f32_16x16x32_bf16 v[184:187], v[76:79], a[104:107], v[184:187]
    v_mfma_f32_16x16x32_bf16 v[188:191], v[76:79], a[108:111], v[188:191]
    v_mfma_f32_16x16x32_bf16 v[192:195], v[80:83], a[96:99], v[192:195]
    v_mfma_f32_16x16x32_bf16 v[196:199], v[80:83], a[100:103], v[196:199]
    v_mfma_f32_16x16x32_bf16 v[200:203], v[80:83], a[104:107], v[200:203]
    v_mfma_f32_16x16x32_bf16 v[204:207], v[80:83], a[108:111], v[204:207]
    v_mfma_f32_16x16x32_bf16 v[208:211], v[84:87], a[96:99], v[208:211]
    v_mfma_f32_16x16x32_bf16 v[212:215], v[84:87], a[100:103], v[212:215]
    v_mfma_f32_16x16x32_bf16 v[216:219], v[84:87], a[104:107], v[216:219]
    v_mfma_f32_16x16x32_bf16 v[220:223], v[84:87], a[108:111], v[220:223]
    v_mfma_f32_16x16x32_bf16 v[224:227], v[88:91], a[96:99], v[224:227]
    v_mfma_f32_16x16x32_bf16 v[228:231], v[88:91], a[100:103], v[228:231]
    v_mfma_f32_16x16x32_bf16 v[232:235], v[88:91], a[104:107], v[232:235]
    v_mfma_f32_16x16x32_bf16 v[236:239], v[88:91], a[108:111], v[236:239]
    v_mfma_f32_16x16x32_bf16 v[240:243], v[92:95], a[96:99], v[240:243]
    v_mfma_f32_16x16x32_bf16 v[244:247], v[92:95], a[100:103], v[244:247]
    v_mfma_f32_16x16x32_bf16 v[248:251], v[92:95], a[104:107], v[248:251]
    v_mfma_f32_16x16x32_bf16 v[252:255], v[92:95], a[108:111], v[252:255]
    buffer_load_dwordx4 a[96:99], v8, s[12:15], s28 offen
    buffer_load_dwordx4 a[100:103], v8, s[12:15], s29 offen
    buffer_load_dwordx4 a[104:107], v8, s[12:15], s30 offen
    buffer_load_dwordx4 a[108:111], v8, s[12:15], s31 offen
    v_add_u32 v8, 1024, v8
    ds_read_b128 v[64:67], v6 offset:8192
    ds_read_b128 v[68:71], v6 offset:24576
    ds_read_b128 v[72:75], v6 offset:40960
    ds_read_b128 v[76:79], v6 offset:57344
    ds_read_b128 v[80:83], v9 offset:8192
    ds_read_b128 v[84:87], v9 offset:24576
    ds_read_b128 v[88:91], v9 offset:40960
    ds_read_b128 v[92:95], v9 offset:57344
    s_waitcnt vmcnt(28) lgkmcnt(8)
    v_mfma_f32_16x16x32_bf16 v[128:131], v[96:99], a[112:115], v[128:131]
    v_mfma_f32_16x16x32_bf16 v[132:135], v[96:99], a[116:119], v[132:135]
    v_mfma_f32_16x16x32_bf16 v[136:139], v[96:99], a[120:123], v[136:139]
    v_mfma_f32_16x16x32_bf16 v[140:143], v[96:99], a[124:127], v[140:143]
    v_mfma_f32_16x16x32_bf16 v[144:147], v[100:103], a[112:115], v[144:147]
    v_mfma_f32_16x16x32_bf16 v[148:151], v[100:103], a[116:119], v[148:151]
    v_mfma_f32_16x16x32_bf16 v[152:155], v[100:103], a[120:123], v[152:155]
    v_mfma_f32_16x16x32_bf16 v[156:159], v[100:103], a[124:127], v[156:159]
    v_mfma_f32_16x16x32_bf16 v[160:163], v[104:107], a[112:115], v[160:163]
    v_mfma_f32_16x16x32_bf16 v[164:167], v[104:107], a[116:119], v[164:167]
    v_mfma_f32_16x16x32_bf16 v[168:171], v[104:107], a[120:123], v[168:171]
    v_mfma_f32_16x16x32_bf16 v[172:175], v[104:107], a[124:127], v[172:175]
    v_mfma_f32_16x16x32_bf16 v[176:179], v[108:111], a[112:115], v[176:179]
    v_mfma_f32_16x16x32_bf16 v[180:183], v[108:111], a[116:119], v[180:183]
    v_mfma_f32_16x16x32_bf16 v[184:187], v[108:111], a[120:123], v[184:187]
    v_mfma_f32_16x16x32_bf16 v[188:191], v[108:111], a[124:127], v[188:191]
    v_mfma_f32_16x16x32_bf16 v[192:195], v[112:115], a[112:115], v[192:195]
    v_mfma_f32_16x16x32_bf16 v[196:199], v[112:115], a[116:119], v[196:199]
    v_mfma_f32_16x16x32_bf16 v[200:203], v[112:115], a[120:123], v[200:203]
    v_mfma_f32_16x16x32_bf16 v[204:207], v[112:115], a[124:127], v[204:207]
    v_mfma_f32_16x16x32_bf16 v[208:211], v[116:119], a[112:115], v[208:211]
    v_mfma_f32_16x16x32_bf16 v[212:215], v[116:119], a[116:119], v[212:215]
    v_mfma_f32_16x16x32_bf16 v[216:219], v[116:119], a[120:123], v[216:219]
    v_mfma_f32_16x16x32_bf16 v[220:223], v[116:119], a[124:127], v[220:223]
    v_mfma_f32_16x16x32_bf16 v[224:227], v[120:123], a[112:115], v[224:227]
    v_mfma_f32_16x16x32_bf16 v[228:231], v[120:123], a[116:119], v[228:231]
    v_mfma_f32_16x16x32_bf16 v[232:235], v[120:123], a[120:123], v[232:235]
    v_mfma_f32_16x16x32_bf16 v[236:239], v[120:123], a[124:127], v[236:239]
    v_mfma_f32_16x16x32_bf16 v[240:243], v[124:127], a[112:115], v[240:243]
    v_mfma_f32_16x16x32_bf16 v[244:247], v[124:127], a[116:119], v[244:247]
    v_mfma_f32_16x16x32_bf16 v[248:251], v[124:127], a[120:123], v[248:251]
    v_mfma_f32_16x16x32_bf16 v[252:255], v[124:127], a[124:127], v[252:255]
    buffer_load_dwordx4 a[112:115], v8, s[12:15], s28 offen
    buffer_load_dwordx4 a[116:119], v8, s[12:15], s29 offen
    buffer_load_dwordx4 a[120:123], v8, s[12:15], s30 offen
    buffer_load_dwordx4 a[124:127], v8, s[12:15], s31 offen
    v_add_u32 v8, 1024, v8
    ds_read_b128 v[96:99], v6 offset:9216
    ds_read_b128 v[100:103], v6 offset:25600
    ds_read_b128 v[104:107], v6 offset:41984
    ds_read_b128 v[108:111], v6 offset:58368
    ds_read_b128 v[112:115], v9 offset:9216
    ds_read_b128 v[116:119], v9 offset:25600
    ds_read_b128 v[120:123], v9 offset:41984
    ds_read_b128 v[124:127], v9 offset:58368
    s_waitcnt vmcnt(28) lgkmcnt(8)
    v_mfma_f32_16x16x32_bf16 v[128:131], v[64:67], a[0:3], v[128:131]
    v_mfma_f32_16x16x32_bf16 v[132:135], v[64:67], a[4:7], v[132:135]
    v_mfma_f32_16x16x32_bf16 v[136:139], v[64:67], a[8:11], v[136:139]
    v_mfma_f32_16x16x32_bf16 v[140:143], v[64:67], a[12:15], v[140:143]
    v_mfma_f32_16x16x32_bf16 v[144:147], v[68:71], a[0:3], v[144:147]
    v_mfma_f32_16x16x32_bf16 v[148:151], v[68:71], a[4:7], v[148:151]
    v_mfma_f32_16x16x32_bf16 v[152:155], v[68:71], a[8:11], v[152:155]
    v_mfma_f32_16x16x32_bf16 v[156:159], v[68:71], a[12:15], v[156:159]
    v_mfma_f32_16x16x32_bf16 v[160:163], v[72:75], a[0:3], v[160:163]
    v_mfma_f32_16x16x32_bf16 v[164:167], v[72:75], a[4:7], v[164:167]
    v_mfma_f32_16x16x32_bf16 v[168:171], v[72:75], a[8:11], v[168:171]
    v_mfma_f32_16x16x32_bf16 v[172:175], v[72:75], a[12:15], v[172:175]
    v_mfma_f32_16x16x32_bf16 v[176:179], v[76:79], a[0:3], v[176:179]
    v_mfma_f32_16x16x32_bf16 v[180:183], v[76:79], a[4:7], v[180:183]
    v_mfma_f32_16x16x32_bf16 v[184:187], v[76:79], a[8:11], v[184:187]
    v_mfma_f32_16x16x32_bf16 v[188:191], v[76:79], a[12:15], v[188:191]
    v_mfma_f32_16x16x32_bf16 v[192:195], v[80:83], a[0:3], v[192:195]
    v_mfma_f32_16x16x32_bf16 v[196:199], v[80:83], a[4:7], v[196:199]
    v_mfma_f32_16x16x32_bf16 v[200:203], v[80:83], a[8:11], v[200:203]
    v_mfma_f32_16x16x32_bf16 v[204:207], v[80:83], a[12:15], v[204:207]
    v_mfma_f32_16x16x32_bf16 v[208:211], v[84:87], a[0:3], v[208:211]
    v_mfma_f32_16x16x32_bf16 v[212:215], v[84:87], a[4:7], v[212:215]
    v_mfma_f32_16x16x32_bf16 v[216:219], v[84:87], a[8:11], v[216:219]
    v_mfma_f32_16x16x32_bf16 v[220:223], v[84:87], a[12:15], v[220:223]
    v_mfma_f32_16x16x32_bf16 v[224:227], v[88:91], a[0:3], v[224:227]
    v_mfma_f32_16x16x32_bf16 v[228:231], v[88:91], a[4:7], v[228:231]
    v_mfma_f32_16x16x32_bf16 v[232:235], v[88:91], a[8:11], v[232:235]
    v_mfma_f32_16x16x32_bf16 v[236:239], v[88:91], a[12:15], v[236:239]
    v_mfma_f32_16x16x32_bf16 v[240:243], v[92:95], a[0:3], v[240:243]
    v_mfma_f32_16x16x32_bf16 v[244:247], v[92:95], a[4:7], v[244:247]
    v_mfma_f32_16x16x32_bf16 v[248:251], v[92:95], a[8:11], v[248:251]
    v_mfma_f32_16x16x32_bf16 v[252:255], v[92:95], a[12:15], v[252:255]
    v_mov_b32 v8, v6
    ds_read_b128 v[64:67], v6 offset:10240
    ds_read_b128 v[68:71], v6 offset:26624
    ds_read_b128 v[72:75], v6 offset:43008
    ds_read_b128 v[76:79], v6 offset:59392
    ds_read_b128 v[80:83], v9 offset:10240
    ds_read_b128 v[84:87], v9 offset:26624
    ds_read_b128 v[88:91], v9 offset:43008
    ds_read_b128 v[92:95], v9 offset:59392
    s_waitcnt vmcnt(24) lgkmcnt(8)
    v_mfma_f32_16x16x32_bf16 v[128:131], v[96:99], a[16:19], v[128:131]
    v_mfma_f32_16x16x32_bf16 v[132:135], v[96:99], a[20:23], v[132:135]
    v_mfma_f32_16x16x32_bf16 v[136:139], v[96:99], a[24:27], v[136:139]
    v_mfma_f32_16x16x32_bf16 v[140:143], v[96:99], a[28:31], v[140:143]
    v_mfma_f32_16x16x32_bf16 v[144:147], v[100:103], a[16:19], v[144:147]
    v_mfma_f32_16x16x32_bf16 v[148:151], v[100:103], a[20:23], v[148:151]
    v_mfma_f32_16x16x32_bf16 v[152:155], v[100:103], a[24:27], v[152:155]
    v_mfma_f32_16x16x32_bf16 v[156:159], v[100:103], a[28:31], v[156:159]
    v_mfma_f32_16x16x32_bf16 v[160:163], v[104:107], a[16:19], v[160:163]
    v_mfma_f32_16x16x32_bf16 v[164:167], v[104:107], a[20:23], v[164:167]
    v_mfma_f32_16x16x32_bf16 v[168:171], v[104:107], a[24:27], v[168:171]
    v_mfma_f32_16x16x32_bf16 v[172:175], v[104:107], a[28:31], v[172:175]
    v_mfma_f32_16x16x32_bf16 v[176:179], v[108:111], a[16:19], v[176:179]
    v_mfma_f32_16x16x32_bf16 v[180:183], v[108:111], a[20:23], v[180:183]
    v_mfma_f32_16x16x32_bf16 v[184:187], v[108:111], a[24:27], v[184:187]
    v_mfma_f32_16x16x32_bf16 v[188:191], v[108:111], a[28:31], v[188:191]
    v_mfma_f32_16x16x32_bf16 v[192:195], v[112:115], a[16:19], v[192:195]
    v_mfma_f32_16x16x32_bf16 v[196:199], v[112:115], a[20:23], v[196:199]
    v_mfma_f32_16x16x32_bf16 v[200:203], v[112:115], a[24:27], v[200:203]
    v_mfma_f32_16x16x32_bf16 v[204:207], v[112:115], a[28:31], v[204:207]
    v_mfma_f32_16x16x32_bf16 v[208:211], v[116:119], a[16:19], v[208:211]
    v_mfma_f32_16x16x32_bf16 v[212:215], v[116:119], a[20:23], v[212:215]
    v_mfma_f32_16x16x32_bf16 v[216:219], v[116:119], a[24:27], v[216:219]
    v_mfma_f32_16x16x32_bf16 v[220:223], v[116:119], a[28:31], v[220:223]
    v_mfma_f32_16x16x32_bf16 v[224:227], v[120:123], a[16:19], v[224:227]
    v_mfma_f32_16x16x32_bf16 v[228:231], v[120:123], a[20:23], v[228:231]
    v_mfma_f32_16x16x32_bf16 v[232:235], v[120:123], a[24:27], v[232:235]
    v_mfma_f32_16x16x32_bf16 v[236:239], v[120:123], a[28:31], v[236:239]
    v_mfma_f32_16x16x32_bf16 v[240:243], v[124:127], a[16:19], v[240:243]
    v_mfma_f32_16x16x32_bf16 v[244:247], v[124:127], a[20:23], v[244:247]
    v_mfma_f32_16x16x32_bf16 v[248:251], v[124:127], a[24:27], v[248:251]
    v_mfma_f32_16x16x32_bf16 v[252:255], v[124:127], a[28:31], v[252:255]
    ds_read_b128 v[96:99], v6 offset:11264
    ds_read_b128 v[100:103], v6 offset:27648
    ds_read_b128 v[104:107], v6 offset:44032
    ds_read_b128 v[108:111], v6 offset:60416
    ds_read_b128 v[112:115], v9 offset:11264
    ds_read_b128 v[116:119], v9 offset:27648
    ds_read_b128 v[120:123], v9 offset:44032
    ds_read_b128 v[124:127], v9 offset:60416
    s_waitcnt vmcnt(20) lgkmcnt(8)
    v_mfma_f32_16x16x32_bf16 v[128:131], v[64:67], a[32:35], v[128:131]
    v_mfma_f32_16x16x32_bf16 v[132:135], v[64:67], a[36:39], v[132:135]
    v_mfma_f32_16x16x32_bf16 v[136:139], v[64:67], a[40:43], v[136:139]
    v_mfma_f32_16x16x32_bf16 v[140:143], v[64:67], a[44:47], v[140:143]
    v_mfma_f32_16x16x32_bf16 v[144:147], v[68:71], a[32:35], v[144:147]
    v_mfma_f32_16x16x32_bf16 v[148:151], v[68:71], a[36:39], v[148:151]
    v_mfma_f32_16x16x32_bf16 v[152:155], v[68:71], a[40:43], v[152:155]
    v_mfma_f32_16x16x32_bf16 v[156:159], v[68:71], a[44:47], v[156:159]
    v_mfma_f32_16x16x32_bf16 v[160:163], v[72:75], a[32:35], v[160:163]
    v_mfma_f32_16x16x32_bf16 v[164:167], v[72:75], a[36:39], v[164:167]
    v_mfma_f32_16x16x32_bf16 v[168:171], v[72:75], a[40:43], v[168:171]
    v_mfma_f32_16x16x32_bf16 v[172:175], v[72:75], a[44:47], v[172:175]
    v_mfma_f32_16x16x32_bf16 v[176:179], v[76:79], a[32:35], v[176:179]
    v_mfma_f32_16x16x32_bf16 v[180:183], v[76:79], a[36:39], v[180:183]
    v_mfma_f32_16x16x32_bf16 v[184:187], v[76:79], a[40:43], v[184:187]
    v_mfma_f32_16x16x32_bf16 v[188:191], v[76:79], a[44:47], v[188:191]
    v_mfma_f32_16x16x32_bf16 v[192:195], v[80:83], a[32:35], v[192:195]
    v_mfma_f32_16x16x32_bf16 v[196:199], v[80:83], a[36:39], v[196:199]
    v_mfma_f32_16x16x32_bf16 v[200:203], v[80:83], a[40:43], v[200:203]
    v_mfma_f32_16x16x32_bf16 v[204:207], v[80:83], a[44:47], v[204:207]
    v_mfma_f32_16x16x32_bf16 v[208:211], v[84:87], a[32:35], v[208:211]
    v_mfma_f32_16x16x32_bf16 v[212:215], v[84:87], a[36:39], v[212:215]
    v_mfma_f32_16x16x32_bf16 v[216:219], v[84:87], a[40:43], v[216:219]
    v_mfma_f32_16x16x32_bf16 v[220:223], v[84:87], a[44:47], v[220:223]
    v_mfma_f32_16x16x32_bf16 v[224:227], v[88:91], a[32:35], v[224:227]
    v_mfma_f32_16x16x32_bf16 v[228:231], v[88:91], a[36:39], v[228:231]
    v_mfma_f32_16x16x32_bf16 v[232:235], v[88:91], a[40:43], v[232:235]
    v_mfma_f32_16x16x32_bf16 v[236:239], v[88:91], a[44:47], v[236:239]
    v_mfma_f32_16x16x32_bf16 v[240:243], v[92:95], a[32:35], v[240:243]
    v_mfma_f32_16x16x32_bf16 v[244:247], v[92:95], a[36:39], v[244:247]
    v_mfma_f32_16x16x32_bf16 v[248:251], v[92:95], a[40:43], v[248:251]
    v_mfma_f32_16x16x32_bf16 v[252:255], v[92:95], a[44:47], v[252:255]
    ds_read_b128 v[64:67], v6 offset:12288
    ds_read_b128 v[68:71], v6 offset:28672
    ds_read_b128 v[72:75], v6 offset:45056
    ds_read_b128 v[76:79], v6 offset:61440
    ds_read_b128 v[80:83], v9 offset:12288
    ds_read_b128 v[84:87], v9 offset:28672
    ds_read_b128 v[88:91], v9 offset:45056
    ds_read_b128 v[92:95], v9 offset:61440
    s_waitcnt vmcnt(16) lgkmcnt(8)
    v_mfma_f32_16x16x32_bf16 v[128:131], v[96:99], a[48:51], v[128:131]
    v_mfma_f32_16x16x32_bf16 v[132:135], v[96:99], a[52:55], v[132:135]
    v_mfma_f32_16x16x32_bf16 v[136:139], v[96:99], a[56:59], v[136:139]
    v_mfma_f32_16x16x32_bf16 v[140:143], v[96:99], a[60:63], v[140:143]
    v_mfma_f32_16x16x32_bf16 v[144:147], v[100:103], a[48:51], v[144:147]
    v_mfma_f32_16x16x32_bf16 v[148:151], v[100:103], a[52:55], v[148:151]
    v_mfma_f32_16x16x32_bf16 v[152:155], v[100:103], a[56:59], v[152:155]
    v_mfma_f32_16x16x32_bf16 v[156:159], v[100:103], a[60:63], v[156:159]
    v_mfma_f32_16x16x32_bf16 v[160:163], v[104:107], a[48:51], v[160:163]
    v_mfma_f32_16x16x32_bf16 v[164:167], v[104:107], a[52:55], v[164:167]
    v_mfma_f32_16x16x32_bf16 v[168:171], v[104:107], a[56:59], v[168:171]
    v_mfma_f32_16x16x32_bf16 v[172:175], v[104:107], a[60:63], v[172:175]
    v_mfma_f32_16x16x32_bf16 v[176:179], v[108:111], a[48:51], v[176:179]
    v_mfma_f32_16x16x32_bf16 v[180:183], v[108:111], a[52:55], v[180:183]
    v_mfma_f32_16x16x32_bf16 v[184:187], v[108:111], a[56:59], v[184:187]
    v_mfma_f32_16x16x32_bf16 v[188:191], v[108:111], a[60:63], v[188:191]
    v_mfma_f32_16x16x32_bf16 v[192:195], v[112:115], a[48:51], v[192:195]
    v_mfma_f32_16x16x32_bf16 v[196:199], v[112:115], a[52:55], v[196:199]
    v_mfma_f32_16x16x32_bf16 v[200:203], v[112:115], a[56:59], v[200:203]
    v_mfma_f32_16x16x32_bf16 v[204:207], v[112:115], a[60:63], v[204:207]
    v_mfma_f32_16x16x32_bf16 v[208:211], v[116:119], a[48:51], v[208:211]
    v_mfma_f32_16x16x32_bf16 v[212:215], v[116:119], a[52:55], v[212:215]
    v_mfma_f32_16x16x32_bf16 v[216:219], v[116:119], a[56:59], v[216:219]
    v_mfma_f32_16x16x32_bf16 v[220:223], v[116:119], a[60:63], v[220:223]
    v_mfma_f32_16x16x32_bf16 v[224:227], v[120:123], a[48:51], v[224:227]
    v_mfma_f32_16x16x32_bf16 v[228:231], v[120:123], a[52:55], v[228:231]
    v_mfma_f32_16x16x32_bf16 v[232:235], v[120:123], a[56:59], v[232:235]
    v_mfma_f32_16x16x32_bf16 v[236:239], v[120:123], a[60:63], v[236:239]
    v_mfma_f32_16x16x32_bf16 v[240:243], v[124:127], a[48:51], v[240:243]
    v_mfma_f32_16x16x32_bf16 v[244:247], v[124:127], a[52:55], v[244:247]
    v_mfma_f32_16x16x32_bf16 v[248:251], v[124:127], a[56:59], v[248:251]
    v_mfma_f32_16x16x32_bf16 v[252:255], v[124:127], a[60:63], v[252:255]
    ds_read_b128 v[96:99], v6 offset:13312
    ds_read_b128 v[100:103], v6 offset:29696
    ds_read_b128 v[104:107], v6 offset:46080
    ds_read_b128 v[108:111], v6 offset:62464
    ds_read_b128 v[112:115], v9 offset:13312
    ds_read_b128 v[116:119], v9 offset:29696
    ds_read_b128 v[120:123], v9 offset:46080
    ds_read_b128 v[124:127], v9 offset:62464
    s_waitcnt vmcnt(12) lgkmcnt(8)
    v_mfma_f32_16x16x32_bf16 v[128:131], v[64:67], a[64:67], v[128:131]
    v_mfma_f32_16x16x32_bf16 v[132:135], v[64:67], a[68:71], v[132:135]
    v_mfma_f32_16x16x32_bf16 v[136:139], v[64:67], a[72:75], v[136:139]
    v_mfma_f32_16x16x32_bf16 v[140:143], v[64:67], a[76:79], v[140:143]
    v_mfma_f32_16x16x32_bf16 v[144:147], v[68:71], a[64:67], v[144:147]
    v_mfma_f32_16x16x32_bf16 v[148:151], v[68:71], a[68:71], v[148:151]
    v_mfma_f32_16x16x32_bf16 v[152:155], v[68:71], a[72:75], v[152:155]
    v_mfma_f32_16x16x32_bf16 v[156:159], v[68:71], a[76:79], v[156:159]
    v_mfma_f32_16x16x32_bf16 v[160:163], v[72:75], a[64:67], v[160:163]
    v_mfma_f32_16x16x32_bf16 v[164:167], v[72:75], a[68:71], v[164:167]
    v_mfma_f32_16x16x32_bf16 v[168:171], v[72:75], a[72:75], v[168:171]
    v_mfma_f32_16x16x32_bf16 v[172:175], v[72:75], a[76:79], v[172:175]
    v_mfma_f32_16x16x32_bf16 v[176:179], v[76:79], a[64:67], v[176:179]
    v_mfma_f32_16x16x32_bf16 v[180:183], v[76:79], a[68:71], v[180:183]
    v_mfma_f32_16x16x32_bf16 v[184:187], v[76:79], a[72:75], v[184:187]
    v_mfma_f32_16x16x32_bf16 v[188:191], v[76:79], a[76:79], v[188:191]
    v_mfma_f32_16x16x32_bf16 v[192:195], v[80:83], a[64:67], v[192:195]
    v_mfma_f32_16x16x32_bf16 v[196:199], v[80:83], a[68:71], v[196:199]
    v_mfma_f32_16x16x32_bf16 v[200:203], v[80:83], a[72:75], v[200:203]
    v_mfma_f32_16x16x32_bf16 v[204:207], v[80:83], a[76:79], v[204:207]
    v_mfma_f32_16x16x32_bf16 v[208:211], v[84:87], a[64:67], v[208:211]
    v_mfma_f32_16x16x32_bf16 v[212:215], v[84:87], a[68:71], v[212:215]
    v_mfma_f32_16x16x32_bf16 v[216:219], v[84:87], a[72:75], v[216:219]
    v_mfma_f32_16x16x32_bf16 v[220:223], v[84:87], a[76:79], v[220:223]
    v_mfma_f32_16x16x32_bf16 v[224:227], v[88:91], a[64:67], v[224:227]
    v_mfma_f32_16x16x32_bf16 v[228:231], v[88:91], a[68:71], v[228:231]
    v_mfma_f32_16x16x32_bf16 v[232:235], v[88:91], a[72:75], v[232:235]
    v_mfma_f32_16x16x32_bf16 v[236:239], v[88:91], a[76:79], v[236:239]
    v_mfma_f32_16x16x32_bf16 v[240:243], v[92:95], a[64:67], v[240:243]
    v_mfma_f32_16x16x32_bf16 v[244:247], v[92:95], a[68:71], v[244:247]
    v_mfma_f32_16x16x32_bf16 v[248:251], v[92:95], a[72:75], v[248:251]
    v_mfma_f32_16x16x32_bf16 v[252:255], v[92:95], a[76:79], v[252:255]
    ds_read_b128 v[64:67], v6 offset:14336
    ds_read_b128 v[68:71], v6 offset:30720
    ds_read_b128 v[72:75], v6 offset:47104
    ds_read_b128 v[76:79], v6 offset:63488
    ds_read_b128 v[80:83], v9 offset:14336
    ds_read_b128 v[84:87], v9 offset:30720
    ds_read_b128 v[88:91], v9 offset:47104
    ds_read_b128 v[92:95], v9 offset:63488
    s_waitcnt vmcnt(8) lgkmcnt(8)
    v_mfma_f32_16x16x32_bf16 v[128:131], v[96:99], a[80:83], v[128:131]
    v_mfma_f32_16x16x32_bf16 v[132:135], v[96:99], a[84:87], v[132:135]
    v_mfma_f32_16x16x32_bf16 v[136:139], v[96:99], a[88:91], v[136:139]
    v_mfma_f32_16x16x32_bf16 v[140:143], v[96:99], a[92:95], v[140:143]
    v_mfma_f32_16x16x32_bf16 v[144:147], v[100:103], a[80:83], v[144:147]
    v_mfma_f32_16x16x32_bf16 v[148:151], v[100:103], a[84:87], v[148:151]
    v_mfma_f32_16x16x32_bf16 v[152:155], v[100:103], a[88:91], v[152:155]
    v_mfma_f32_16x16x32_bf16 v[156:159], v[100:103], a[92:95], v[156:159]
    v_mfma_f32_16x16x32_bf16 v[160:163], v[104:107], a[80:83], v[160:163]
    v_mfma_f32_16x16x32_bf16 v[164:167], v[104:107], a[84:87], v[164:167]
    v_mfma_f32_16x16x32_bf16 v[168:171], v[104:107], a[88:91], v[168:171]
    v_mfma_f32_16x16x32_bf16 v[172:175], v[104:107], a[92:95], v[172:175]
    v_mfma_f32_16x16x32_bf16 v[176:179], v[108:111], a[80:83], v[176:179]
    v_mfma_f32_16x16x32_bf16 v[180:183], v[108:111], a[84:87], v[180:183]
    v_mfma_f32_16x16x32_bf16 v[184:187], v[108:111], a[88:91], v[184:187]
    v_mfma_f32_16x16x32_bf16 v[188:191], v[108:111], a[92:95], v[188:191]
    v_mfma_f32_16x16x32_bf16 v[192:195], v[112:115], a[80:83], v[192:195]
    v_mfma_f32_16x16x32_bf16 v[196:199], v[112:115], a[84:87], v[196:199]
    v_mfma_f32_16x16x32_bf16 v[200:203], v[112:115], a[88:91], v[200:203]
    v_mfma_f32_16x16x32_bf16 v[204:207], v[112:115], a[92:95], v[204:207]
    v_mfma_f32_16x16x32_bf16 v[208:211], v[116:119], a[80:83], v[208:211]
    v_mfma_f32_16x16x32_bf16 v[212:215], v[116:119], a[84:87], v[212:215]
    v_mfma_f32_16x16x32_bf16 v[216:219], v[116:119], a[88:91], v[216:219]
    v_mfma_f32_16x16x32_bf16 v[220:223], v[116:119], a[92:95], v[220:223]
    v_mfma_f32_16x16x32_bf16 v[224:227], v[120:123], a[80:83], v[224:227]
    v_mfma_f32_16x16x32_bf16 v[228:231], v[120:123], a[84:87], v[228:231]
    v_mfma_f32_16x16x32_bf16 v[232:235], v[120:123], a[88:91], v[232:235]
    v_mfma_f32_16x16x32_bf16 v[236:239], v[120:123], a[92:95], v[236:239]
    v_mfma_f32_16x16x32_bf16 v[240:243], v[124:127], a[80:83], v[240:243]
    v_mfma_f32_16x16x32_bf16 v[244:247], v[124:127], a[84:87], v[244:247]
    v_mfma_f32_16x16x32_bf16 v[248:251], v[124:127], a[88:91], v[248:251]
    v_mfma_f32_16x16x32_bf16 v[252:255], v[124:127], a[92:95], v[252:255]
    ds_read_b128 v[96:99], v6 offset:15360
    ds_read_b128 v[100:103], v6 offset:31744
    ds_read_b128 v[104:107], v6 offset:48128
    ds_read_b128 v[108:111], v6 offset:64512
    ds_read_b128 v[112:115], v9 offset:15360
    ds_read_b128 v[116:119], v9 offset:31744
    ds_read_b128 v[120:123], v9 offset:48128
    ds_read_b128 v[124:127], v9 offset:64512
    s_waitcnt vmcnt(4) lgkmcnt(8)
    v_mfma_f32_16x16x32_bf16 v[128:131], v[64:67], a[96:99], v[128:131]
    v_mfma_f32_16x16x32_bf16 v[132:135], v[64:67], a[100:103], v[132:135]
    v_mfma_f32_16x16x32_bf16 v[136:139], v[64:67], a[104:107], v[136:139]
    v_mfma_f32_16x16x32_bf16 v[140:143], v[64:67], a[108:111], v[140:143]
    v_mfma_f32_16x16x32_bf16 v[144:147], v[68:71], a[96:99], v[144:147]
    v_mfma_f32_16x16x32_bf16 v[148:151], v[68:71], a[100:103], v[148:151]
    v_mfma_f32_16x16x32_bf16 v[152:155], v[68:71], a[104:107], v[152:155]
    v_mfma_f32_16x16x32_bf16 v[156:159], v[68:71], a[108:111], v[156:159]
    v_mfma_f32_16x16x32_bf16 v[160:163], v[72:75], a[96:99], v[160:163]
    v_mfma_f32_16x16x32_bf16 v[164:167], v[72:75], a[100:103], v[164:167]
    v_mfma_f32_16x16x32_bf16 v[168:171], v[72:75], a[104:107], v[168:171]
    v_mfma_f32_16x16x32_bf16 v[172:175], v[72:75], a[108:111], v[172:175]
    v_mfma_f32_16x16x32_bf16 v[176:179], v[76:79], a[96:99], v[176:179]
    v_mfma_f32_16x16x32_bf16 v[180:183], v[76:79], a[100:103], v[180:183]
    v_mfma_f32_16x16x32_bf16 v[184:187], v[76:79], a[104:107], v[184:187]
    v_mfma_f32_16x16x32_bf16 v[188:191], v[76:79], a[108:111], v[188:191]
    v_mfma_f32_16x16x32_bf16 v[192:195], v[80:83], a[96:99], v[192:195]
    v_mfma_f32_16x16x32_bf16 v[196:199], v[80:83], a[100:103], v[196:199]
    v_mfma_f32_16x16x32_bf16 v[200:203], v[80:83], a[104:107], v[200:203]
    v_mfma_f32_16x16x32_bf16 v[204:207], v[80:83], a[108:111], v[204:207]
    v_mfma_f32_16x16x32_bf16 v[208:211], v[84:87], a[96:99], v[208:211]
    v_mfma_f32_16x16x32_bf16 v[212:215], v[84:87], a[100:103], v[212:215]
    v_mfma_f32_16x16x32_bf16 v[216:219], v[84:87], a[104:107], v[216:219]
    v_mfma_f32_16x16x32_bf16 v[220:223], v[84:87], a[108:111], v[220:223]
    v_mfma_f32_16x16x32_bf16 v[224:227], v[88:91], a[96:99], v[224:227]
    v_mfma_f32_16x16x32_bf16 v[228:231], v[88:91], a[100:103], v[228:231]
    v_mfma_f32_16x16x32_bf16 v[232:235], v[88:91], a[104:107], v[232:235]
    v_mfma_f32_16x16x32_bf16 v[236:239], v[88:91], a[108:111], v[236:239]
    v_mfma_f32_16x16x32_bf16 v[240:243], v[92:95], a[96:99], v[240:243]
    v_mfma_f32_16x16x32_bf16 v[244:247], v[92:95], a[100:103], v[244:247]
    v_mfma_f32_16x16x32_bf16 v[248:251], v[92:95], a[104:107], v[248:251]
    v_mfma_f32_16x16x32_bf16 v[252:255], v[92:95], a[108:111], v[252:255]
    s_waitcnt vmcnt(0) lgkmcnt(0)
    v_mfma_f32_16x16x32_bf16 v[128:131], v[96:99], a[112:115], v[128:131]
    v_mfma_f32_16x16x32_bf16 v[132:135], v[96:99], a[116:119], v[132:135]
    v_mfma_f32_16x16x32_bf16 v[136:139], v[96:99], a[120:123], v[136:139]
    v_mfma_f32_16x16x32_bf16 v[140:143], v[96:99], a[124:127], v[140:143]
    v_mfma_f32_16x16x32_bf16 v[144:147], v[100:103], a[112:115], v[144:147]
    v_mfma_f32_16x16x32_bf16 v[148:151], v[100:103], a[116:119], v[148:151]
    v_mfma_f32_16x16x32_bf16 v[152:155], v[100:103], a[120:123], v[152:155]
    v_mfma_f32_16x16x32_bf16 v[156:159], v[100:103], a[124:127], v[156:159]
    v_mfma_f32_16x16x32_bf16 v[160:163], v[104:107], a[112:115], v[160:163]
    v_mfma_f32_16x16x32_bf16 v[164:167], v[104:107], a[116:119], v[164:167]
    v_mfma_f32_16x16x32_bf16 v[168:171], v[104:107], a[120:123], v[168:171]
    v_mfma_f32_16x16x32_bf16 v[172:175], v[104:107], a[124:127], v[172:175]
    v_mfma_f32_16x16x32_bf16 v[176:179], v[108:111], a[112:115], v[176:179]
    v_mfma_f32_16x16x32_bf16 v[180:183], v[108:111], a[116:119], v[180:183]
    v_mfma_f32_16x16x32_bf16 v[184:187], v[108:111], a[120:123], v[184:187]
    v_mfma_f32_16x16x32_bf16 v[188:191], v[108:111], a[124:127], v[188:191]
    v_mfma_f32_16x16x32_bf16 v[192:195], v[112:115], a[112:115], v[192:195]
    v_mfma_f32_16x16x32_bf16 v[196:199], v[112:115], a[116:119], v[196:199]
    v_mfma_f32_16x16x32_bf16 v[200:203], v[112:115], a[120:123], v[200:203]
    v_mfma_f32_16x16x32_bf16 v[204:207], v[112:115], a[124:127], v[204:207]
    v_mfma_f32_16x16x32_bf16 v[208:211], v[116:119], a[112:115], v[208:211]
    v_mfma_f32_16x16x32_bf16 v[212:215], v[116:119], a[116:119], v[212:215]
    v_mfma_f32_16x16x32_bf16 v[216:219], v[116:119], a[120:123], v[216:219]
    v_mfma_f32_16x16x32_bf16 v[220:223], v[116:119], a[124:127], v[220:223]
    v_mfma_f32_16x16x32_bf16 v[224:227], v[120:123], a[112:115], v[224:227]
    v_mfma_f32_16x16x32_bf16 v[228:231], v[120:123], a[116:119], v[228:231]
    v_mfma_f32_16x16x32_bf16 v[232:235], v[120:123], a[120:123], v[232:235]
    v_mfma_f32_16x16x32_bf16 v[236:239], v[120:123], a[124:127], v[236:239]
    v_mfma_f32_16x16x32_bf16 v[240:243], v[124:127], a[112:115], v[240:243]
    v_mfma_f32_16x16x32_bf16 v[244:247], v[124:127], a[116:119], v[244:247]
    v_mfma_f32_16x16x32_bf16 v[248:251], v[124:127], a[120:123], v[248:251]
    v_mfma_f32_16x16x32_bf16 v[252:255], v[124:127], a[124:127], v[252:255]
    s_nop 7
    s_nop 1
    s_sub_u32 s34, s26, 128
    s_lshl_b32 s34, s34, 12
    s_lshl_b32 s35, s6, 20
    s_add_u32 s34, s34, s35
    s_add_u32 s34, s34, 67108864
    v_cvt_pk_bf16_f32 v12, v128, v129
    v_cvt_pk_bf16_f32 v13, v130, v131
    v_cvt_pk_bf16_f32 v14, v144, v145
    v_cvt_pk_bf16_f32 v15, v146, v147
    buffer_store_dwordx4 v[12:15], v6, s[12:15], s34 offen offset:0 sc1
    v_cvt_pk_bf16_f32 v16, v132, v133
    v_cvt_pk_bf16_f32 v17, v134, v135
    v_cvt_pk_bf16_f32 v18, v148, v149
    v_cvt_pk_bf16_f32 v19, v150, v151
    buffer_store_dwordx4 v[16:19], v6, s[12:15], s34 offen offset:1024 sc1
    v_cvt_pk_bf16_f32 v20, v136, v137
    v_cvt_pk_bf16_f32 v21, v138, v139
    v_cvt_pk_bf16_f32 v22, v152, v153
    v_cvt_pk_bf16_f32 v23, v154, v155
    buffer_store_dwordx4 v[20:23], v6, s[12:15], s34 offen offset:2048 sc1
    v_cvt_pk_bf16_f32 v24, v140, v141
    v_cvt_pk_bf16_f32 v25, v142, v143
    v_cvt_pk_bf16_f32 v26, v156, v157
    v_cvt_pk_bf16_f32 v27, v158, v159
    buffer_store_dwordx4 v[24:27], v6, s[12:15], s34 offen offset:3072 sc1
    s_add_u32 s34, s34, 0x40000
    v_cvt_pk_bf16_f32 v12, v160, v161
    v_cvt_pk_bf16_f32 v13, v162, v163
    v_cvt_pk_bf16_f32 v14, v176, v177
    v_cvt_pk_bf16_f32 v15, v178, v179
    buffer_store_dwordx4 v[12:15], v6, s[12:15], s34 offen offset:0 sc1
    v_cvt_pk_bf16_f32 v16, v164, v165
    v_cvt_pk_bf16_f32 v17, v166, v167
    v_cvt_pk_bf16_f32 v18, v180, v181
    v_cvt_pk_bf16_f32 v19, v182, v183
    buffer_store_dwordx4 v[16:19], v6, s[12:15], s34 offen offset:1024 sc1
    v_cvt_pk_bf16_f32 v20, v168, v169
    v_cvt_pk_bf16_f32 v21, v170, v171
    v_cvt_pk_bf16_f32 v22, v184, v185
    v_cvt_pk_bf16_f32 v23, v186, v187
    buffer_store_dwordx4 v[20:23], v6, s[12:15], s34 offen offset:2048 sc1
    v_cvt_pk_bf16_f32 v24, v172, v173
    v_cvt_pk_bf16_f32 v25, v174, v175
    v_cvt_pk_bf16_f32 v26, v188, v189
    v_cvt_pk_bf16_f32 v27, v190, v191
    buffer_store_dwordx4 v[24:27], v6, s[12:15], s34 offen offset:3072 sc1
    s_add_u32 s34, s34, 0x40000
    v_cvt_pk_bf16_f32 v12, v192, v193
    v_cvt_pk_bf16_f32 v13, v194, v195
    v_cvt_pk_bf16_f32 v14, v208, v209
    v_cvt_pk_bf16_f32 v15, v210, v211
    buffer_store_dwordx4 v[12:15], v6, s[12:15], s34 offen offset:0 sc1
    v_cvt_pk_bf16_f32 v16, v196, v197
    v_cvt_pk_bf16_f32 v17, v198, v199
    v_cvt_pk_bf16_f32 v18, v212, v213
    v_cvt_pk_bf16_f32 v19, v214, v215
    buffer_store_dwordx4 v[16:19], v6, s[12:15], s34 offen offset:1024 sc1
    v_cvt_pk_bf16_f32 v20, v200, v201
    v_cvt_pk_bf16_f32 v21, v202, v203
    v_cvt_pk_bf16_f32 v22, v216, v217
    v_cvt_pk_bf16_f32 v23, v218, v219
    buffer_store_dwordx4 v[20:23], v6, s[12:15], s34 offen offset:2048 sc1
    v_cvt_pk_bf16_f32 v24, v204, v205
    v_cvt_pk_bf16_f32 v25, v206, v207
    v_cvt_pk_bf16_f32 v26, v220, v221
    v_cvt_pk_bf16_f32 v27, v222, v223
    buffer_store_dwordx4 v[24:27], v6, s[12:15], s34 offen offset:3072 sc1
    s_add_u32 s34, s34, 0x40000
    v_cvt_pk_bf16_f32 v12, v224, v225
    v_cvt_pk_bf16_f32 v13, v226, v227
    v_cvt_pk_bf16_f32 v14, v240, v241
    v_cvt_pk_bf16_f32 v15, v242, v243
    buffer_store_dwordx4 v[12:15], v6, s[12:15], s34 offen offset:0 sc1
    v_cvt_pk_bf16_f32 v16, v228, v229
    v_cvt_pk_bf16_f32 v17, v230, v231
    v_cvt_pk_bf16_f32 v18, v244, v245
    v_cvt_pk_bf16_f32 v19, v246, v247
    buffer_store_dwordx4 v[16:19], v6, s[12:15], s34 offen offset:1024 sc1
    v_cvt_pk_bf16_f32 v20, v232, v233
    v_cvt_pk_bf16_f32 v21, v234, v235
    v_cvt_pk_bf16_f32 v22, v248, v249
    v_cvt_pk_bf16_f32 v23, v250, v251
    buffer_store_dwordx4 v[20:23], v6, s[12:15], s34 offen offset:2048 sc1
    v_cvt_pk_bf16_f32 v24, v236, v237
    v_cvt_pk_bf16_f32 v25, v238, v239
    v_cvt_pk_bf16_f32 v26, v252, v253
    v_cvt_pk_bf16_f32 v27, v254, v255
    buffer_store_dwordx4 v[24:27], v6, s[12:15], s34 offen offset:3072 sc1
    s_add_u32 s34, s34, 0x40000
qkv_next:
    s_waitcnt vmcnt(0)
    s_barrier
    s_cmp_lg_u32 s3, 0
    s_cbranch_scc1 h_task_n
    v_cmp_eq_u32 vcc, 0, v2
    s_and_saveexec_b64 s[42:43], vcc
    v_mov_b32 v12, 1
    buffer_atomic_add v12, off, s[12:15], s36 sc1
    s_mov_b64 exec, s[42:43]
h_task_n:
    s_add_u32 s8, s8, 224
    s_cmp_lt_u32 s8, 768
    s_cbranch_scc1 h_task
    v_lshlrev_b32 v7, 13, v3
    v_lshl_add_u32 v7, v4, 4, v7
    v_lshlrev_b32 v8, 6, v3
    v_lshl_add_u32 v8, v4, 4, v8
    s_mov_b32 s40, 0
    s_mov_b32 s41, -1
    v_lshlrev_b32 v9, 2, v4
    v_add_u32 v10, 0, v9
    v_cmp_gt_u32 s[44:45], v10, v3
    v_add_u32 v10, 1, v9
    v_cmp_gt_u32 s[46:47], v10, v3
    v_add_u32 v10, 2, v9
    v_cmp_gt_u32 s[48:49], v10, v3
    v_add_u32 v10, 3, v9
    v_cmp_gt_u32 s[50:51], v10, v3
    s_lshl_b32 s6, s9, 2
    s_add_u32 s6, s6, s3
a_unit:
    s_lshr_b32 s7, s6, 5
    s_and_b32 s8, s6, 31
    s_lshl_b32 s20, s8, 4
    s_lshr_b32 s21, s7, 2
    s_lshl_b32 s21, s21, 2
    s_add_u32 s22, s21, 512
    s_add_u32 s23, s21, 576
    s_add_u32 s24, s7, 1
    v_and_b32 v11, 3, v2
    v_lshl_add_u32 v11, v11, 2, s20
    v_mov_b32 v12, s24
    v_cmp_eq_u32 vcc, 4, v2
    v_mov_b32 v13, s22
    v_mov_b32 v14, 32
    v_cndmask_b32 v11, v11, v13, vcc
    v_cndmask_b32 v12, v12, v14, vcc
    v_cmp_eq_u32 vcc, 5, v2
    v_mov_b32 v13, s23
    v_mov_b32 v14, 16
    v_cndmask_b32 v11, v11, v13, vcc
    v_cndmask_b32 v12, v12, v14, vcc
    s_mov_b32 s25, 126615552
    s_mov_b32 s30, 0
a_wait:
    buffer_load_dword v13, v11, s[12:15], s25 offen sc1
    s_waitcnt vmcnt(0)
    v_cmp_lt_u32 vcc, v13, v12
    s_cbranch_vccz a_go
    s_sleep 12
    s_add_u32 s30, s30, 1
    s_cmp_lt_u32 s30, 200000
    s_cbranch_scc1 a_wait
a_go:
    s_lshl_b32 s20, s7, 18
    s_lshl_b32 s21, s8, 12
    s_add_u32 s20, s20, s21
    s_add_u32 s22, s20, 33554432
    s_add_u32 s23, s20, 33685504
    s_add_u32 s24, s20, 50331648
    s_add_u32 s25, s20, 50462720
    buffer_load_dwordx4 v[32:35], v6, s[12:15], s22 offen offset:0
    buffer_load_dwordx4 v[36:39], v6, s[12:15], s22 offen offset:1024
    buffer_load_dwordx4 v[40:43], v6, s[12:15], s22 offen offset:2048
    buffer_load_dwordx4 v[44:47], v6, s[12:15], s22 offen offset:3072
    buffer_load_dwordx4 v[48:51], v6, s[12:15], s23 offen offset:0
    buffer_load_dwordx4 v[52:55], v6, s[12:15], s23 offen offset:1024
    buffer_load_dwordx4 v[56:59], v6, s[12:15], s23 offen offset:2048
    buffer_load_dwordx4 v[60:63], v6, s[12:15], s23 offen offset:3072
    buffer_load_dwordx4 v[64:67], v6, s[12:15], s24 offen offset:0
    buffer_load_dwordx4 v[68:71], v6, s[12:15], s24 offen offset:1024
    buffer_load_dwordx4 v[72:75], v6, s[12:15], s24 offen offset:2048
    buffer_load_dwordx4 v[76:79], v6, s[12:15], s24 offen offset:3072
    buffer_load_dwordx4 v[80:83], v6, s[12:15], s25 offen offset:0
    buffer_load_dwordx4 v[84:87], v6, s[12:15], s25 offen offset:1024
    buffer_load_dwordx4 v[88:91], v6, s[12:15], s25 offen offset:2048
    buffer_load_dwordx4 v[92:95], v6, s[12:15], s25 offen offset:3072
    s_lshl_b32 s26, s6, 12
    s_add_u32 s30, s26, 109051904
    s_add_u32 s26, s26, 100663296
    buffer_load_dwordx4 v[96:99], v6, s[12:15], s26 offen offset:0
    buffer_load_dwordx4 v[100:103], v6, s[12:15], s26 offen offset:1024
    buffer_load_dwordx4 v[104:107], v6, s[12:15], s26 offen offset:2048
    buffer_load_dwordx4 v[108:111], v6, s[12:15], s26 offen offset:3072
    s_lshl_b32 s27, s6, 13
    s_add_u32 s28, s27, 67108864
    s_add_u32 s29, s27, 67112960
    buffer_load_dwordx4 v[112:115], v6, s[12:15], s28 offen offset:0
    buffer_load_dwordx4 v[116:119], v6, s[12:15], s28 offen offset:1024
    buffer_load_dwordx4 v[120:123], v6, s[12:15], s28 offen offset:2048
    buffer_load_dwordx4 v[124:127], v6, s[12:15], s28 offen offset:3072
    buffer_load_dwordx4 v[128:131], v6, s[12:15], s29 offen offset:0
    buffer_load_dwordx4 v[132:135], v6, s[12:15], s29 offen offset:1024
    buffer_load_dwordx4 v[136:139], v6, s[12:15], s29 offen offset:2048
    buffer_load_dwordx4 v[140:143], v6, s[12:15], s29 offen offset:3072
    buffer_load_dwordx4 v[216:219], v6, s[12:15], s30 offen offset:0
    buffer_load_dwordx4 v[220:223], v6, s[12:15], s30 offen offset:1024
    buffer_load_dwordx4 v[224:227], v6, s[12:15], s30 offen offset:2048
    buffer_load_dwordx4 v[228:231], v6, s[12:15], s30 offen offset:3072
    s_waitcnt vmcnt(12)
    v_mfma_f32_16x16x32_bf16 v[176:179], v[96:99], v[32:35], 0
    v_mfma_f32_16x16x32_bf16 v[176:179], v[100:103], v[36:39], v[176:179]
    v_mfma_f32_16x16x32_bf16 v[176:179], v[104:107], v[40:43], v[176:179]
    v_mfma_f32_16x16x32_bf16 v[176:179], v[108:111], v[44:47], v[176:179]
    v_mfma_f32_16x16x32_bf16 v[180:183], v[64:67], v[32:35], 0
    v_mfma_f32_16x16x32_bf16 v[180:183], v[68:71], v[36:39], v[180:183]
    v_mfma_f32_16x16x32_bf16 v[180:183], v[72:75], v[40:43], v[180:183]
    v_mfma_f32_16x16x32_bf16 v[180:183], v[76:79], v[44:47], v[180:183]
    v_mfma_f32_16x16x32_bf16 v[188:191], v[96:99], v[48:51], 0
    v_mfma_f32_16x16x32_bf16 v[188:191], v[100:103], v[52:55], v[188:191]
    v_mfma_f32_16x16x32_bf16 v[188:191], v[104:107], v[56:59], v[188:191]
    v_mfma_f32_16x16x32_bf16 v[188:191], v[108:111], v[60:63], v[188:191]
    v_mfma_f32_16x16x32_bf16 v[192:195], v[64:67], v[48:51], 0
    v_mfma_f32_16x16x32_bf16 v[192:195], v[68:71], v[52:55], v[192:195]
    v_mfma_f32_16x16x32_bf16 v[192:195], v[72:75], v[56:59], v[192:195]
    v_mfma_f32_16x16x32_bf16 v[192:195], v[76:79], v[60:63], v[192:195]
    v_mfma_f32_16x16x32_bf16 v[196:199], v[80:83], v[48:51], 0
    v_mfma_f32_16x16x32_bf16 v[196:199], v[84:87], v[52:55], v[196:199]
    v_mfma_f32_16x16x32_bf16 v[196:199], v[88:91], v[56:59], v[196:199]
    v_mfma_f32_16x16x32_bf16 v[196:199], v[92:95], v[60:63], v[196:199]
    s_nop 7
    v_cvt_pk_bf16_f32 v12, v176, v177
    v_lshlrev_b32 v176, 16, v12
    v_and_b32 v177, 0xffff0000, v12
    v_cvt_pk_bf16_f32 v12, v178, v179
    v_lshlrev_b32 v178, 16, v12
    v_and_b32 v179, 0xffff0000, v12
    v_cvt_pk_bf16_f32 v12, v180, v181
    v_lshlrev_b32 v180, 16, v12
    v_and_b32 v181, 0xffff0000, v12
    v_cvt_pk_bf16_f32 v12, v182, v183
    v_lshlrev_b32 v182, 16, v12
    v_and_b32 v183, 0xffff0000, v12
    v_mul_f32 v176, 0x3db504f3, v176
    v_mul_f32 v177, 0x3db504f3, v177
    v_mul_f32 v178, 0x3db504f3, v178
    v_mul_f32 v179, 0x3db504f3, v179
    v_mul_f32 v180, 0x3db504f3, v180
    v_mul_f32 v181, 0x3db504f3, v181
    v_mul_f32 v182, 0x3db504f3, v182
    v_mul_f32 v183, 0x3db504f3, v183
    v_cvt_pk_bf16_f32 v12, v176, v177
    v_lshlrev_b32 v176, 16, v12
    v_and_b32 v177, 0xffff0000, v12
    v_cvt_pk_bf16_f32 v12, v178, v179
    v_lshlrev_b32 v178, 16, v12
    v_and_b32 v179, 0xffff0000, v12
    v_cvt_pk_bf16_f32 v12, v180, v181
    v_lshlrev_b32 v180, 16, v12
    v_and_b32 v181, 0xffff0000, v12
    v_cvt_pk_bf16_f32 v12, v182, v183
    v_lshlrev_b32 v182, 16, v12
    v_and_b32 v183, 0xffff0000, v12
    v_mov_b32 v12, 0xff800000
    v_cndmask_b32 v176, v176, v12, s[40:41]
    v_cndmask_b32 v177, v177, v12, s[40:41]
    v_cndmask_b32 v178, v178, v12, s[40:41]
    v_cndmask_b32 v179, v179, v12, s[40:41]
    v_cndmask_b32 v180, v180, v12, s[44:45]
    v_cndmask_b32 v181, v181, v12, s[46:47]
    v_cndmask_b32 v182, v182, v12, s[48:49]
    v_cndmask_b32 v183, v183, v12, s[50:51]
    v_max3_f32 v12, v176, v177, v178
    v_max3_f32 v12, v12, v179, v180
    v_max3_f32 v12, v12, v181, v182
    v_max_f32 v12, v12, v183
    v_mov_b32 v13, v12
    v_mov_b32 v14, v12
    s_nop 1
    v_permlane16_swap_b32 v13, v14
    s_nop 1
    v_max_f32 v12, v13, v14
    v_mov_b32 v13, v12
    v_mov_b32 v14, v12
    s_nop 1
    v_permlane32_swap_b32 v13, v14
    s_nop 1
    v_max_f32 v12, v13, v14
    v_sub_f32 v176, v176, v12
    v_mul_f32 v176, 0x3fb8aa3b, v176
    v_exp_f32 v176, v176
    v_sub_f32 v177, v177, v12
    v_mul_f32 v177, 0x3fb8aa3b, v177
    v_exp_f32 v177, v177
    v_sub_f32 v178, v178, v12
    v_mul_f32 v178, 0x3fb8aa3b, v178
    v_exp_f32 v178, v178
    v_sub_f32 v179, v179, v12
    v_mul_f32 v179, 0x3fb8aa3b, v179
    v_exp_f32 v179, v179
    v_sub_f32 v180, v180, v12
    v_mul_f32 v180, 0x3fb8aa3b, v180
    v_exp_f32 v180, v180
    v_sub_f32 v181, v181, v12
    v_mul_f32 v181, 0x3fb8aa3b, v181
    v_exp_f32 v181, v181
    v_sub_f32 v182, v182, v12
    v_mul_f32 v182, 0x3fb8aa3b, v182
    v_exp_f32 v182, v182
    v_sub_f32 v183, v183, v12
    v_mul_f32 v183, 0x3fb8aa3b, v183
    v_exp_f32 v183, v183
    s_nop 0
    v_add_f32 v12, v176, v177
    v_add_f32 v12, v12, v178
    v_add_f32 v12, v12, v179
    v_add_f32 v12, v12, v180
    v_add_f32 v12, v12, v181
    v_add_f32 v12, v12, v182
    v_add_f32 v12, v12, v183
    v_mov_b32 v13, v12
    v_mov_b32 v14, v12
    s_nop 1
    v_permlane16_swap_b32 v13, v14
    s_nop 1
    v_add_f32 v12, v13, v14
    v_mov_b32 v13, v12
    v_mov_b32 v14, v12
    s_nop 1
    v_permlane32_swap_b32 v13, v14
    s_nop 1
    v_add_f32 v12, v13, v14
    v_rcp_f32 v12, v12
    s_nop 0
    v_mul_f32 v176, v176, v12
    v_mul_f32 v177, v177, v12
    v_mul_f32 v178, v178, v12
    v_mul_f32 v179, v179, v12
    v_mul_f32 v180, v180, v12
    v_mul_f32 v181, v181, v12
    v_mul_f32 v182, v182, v12
    v_mul_f32 v183, v183, v12
    v_cvt_pk_bf16_f32 v200, v180, v181
    v_cvt_pk_bf16_f32 v201, v182, v183
    v_mov_b32 v202, 0
    v_mov_b32 v203, 0
    v_cvt_pk_bf16_f32 v204, v176, v177
    v_cvt_pk_bf16_f32 v205, v178, v179
    v_mov_b32 v206, 0
    v_mov_b32 v207, 0
    v_cvt_pk_bf16_f32 v12, v188, v189
    v_lshlrev_b32 v188, 16, v12
    v_and_b32 v189, 0xffff0000, v12
    v_cvt_pk_bf16_f32 v12, v190, v191
    v_lshlrev_b32 v190, 16, v12
    v_and_b32 v191, 0xffff0000, v12
    v_cvt_pk_bf16_f32 v12, v192, v193
    v_lshlrev_b32 v192, 16, v12
    v_and_b32 v193, 0xffff0000, v12
    v_cvt_pk_bf16_f32 v12, v194, v195
    v_lshlrev_b32 v194, 16, v12
    v_and_b32 v195, 0xffff0000, v12
    v_cvt_pk_bf16_f32 v12, v196, v197
    v_lshlrev_b32 v196, 16, v12
    v_and_b32 v197, 0xffff0000, v12
    v_cvt_pk_bf16_f32 v12, v198, v199
    v_lshlrev_b32 v198, 16, v12
    v_and_b32 v199, 0xffff0000, v12
    v_mul_f32 v188, 0x3db504f3, v188
    v_mul_f32 v189, 0x3db504f3, v189
    v_mul_f32 v190, 0x3db504f3, v190
    v_mul_f32 v191, 0x3db504f3, v191
    v_mul_f32 v192, 0x3db504f3, v192
    v_mul_f32 v193, 0x3db504f3, v193
    v_mul_f32 v194, 0x3db504f3, v194
    v_mul_f32 v195, 0x3db504f3, v195
    v_mul_f32 v196, 0x3db504f3, v196
    v_mul_f32 v197, 0x3db504f3, v197
    v_mul_f32 v198, 0x3db504f3, v198
    v_mul_f32 v199, 0x3db504f3, v199
    v_cvt_pk_bf16_f32 v12, v188, v189
    v_lshlrev_b32 v188, 16, v12
    v_and_b32 v189, 0xffff0000, v12
    v_cvt_pk_bf16_f32 v12, v190, v191
    v_lshlrev_b32 v190, 16, v12
    v_and_b32 v191, 0xffff0000, v12
    v_cvt_pk_bf16_f32 v12, v192, v193
    v_lshlrev_b32 v192, 16, v12
    v_and_b32 v193, 0xffff0000, v12
    v_cvt_pk_bf16_f32 v12, v194, v195
    v_lshlrev_b32 v194, 16, v12
    v_and_b32 v195, 0xffff0000, v12
    v_cvt_pk_bf16_f32 v12, v196, v197
    v_lshlrev_b32 v196, 16, v12
    v_and_b32 v197, 0xffff0000, v12
    v_cvt_pk_bf16_f32 v12, v198, v199
    v_lshlrev_b32 v198, 16, v12
    v_and_b32 v199, 0xffff0000, v12
    v_mov_b32 v12, 0xff800000
    v_cndmask_b32 v188, v188, v12, s[40:41]
    v_cndmask_b32 v189, v189, v12, s[40:41]
    v_cndmask_b32 v190, v190, v12, s[40:41]
    v_cndmask_b32 v191, v191, v12, s[40:41]
    v_cndmask_b32 v196, v196, v12, s[44:45]
    v_cndmask_b32 v197, v197, v12, s[46:47]
    v_cndmask_b32 v198, v198, v12, s[48:49]
    v_cndmask_b32 v199, v199, v12, s[50:51]
    v_max3_f32 v12, v188, v189, v190
    v_max3_f32 v12, v12, v191, v192
    v_max3_f32 v12, v12, v193, v194
    v_max3_f32 v12, v12, v195, v196
    v_max3_f32 v12, v12, v197, v198
    v_max_f32 v12, v12, v199
    v_mov_b32 v13, v12
    v_mov_b32 v14, v12
    s_nop 1
    v_permlane16_swap_b32 v13, v14
    s_nop 1
    v_max_f32 v12, v13, v14
    v_mov_b32 v13, v12
    v_mov_b32 v14, v12
    s_nop 1
    v_permlane32_swap_b32 v13, v14
    s_nop 1
    v_max_f32 v12, v13, v14
    v_sub_f32 v188, v188, v12
    v_mul_f32 v188, 0x3fb8aa3b, v188
    v_exp_f32 v188, v188
    v_sub_f32 v189, v189, v12
    v_mul_f32 v189, 0x3fb8aa3b, v189
    v_exp_f32 v189, v189
    v_sub_f32 v190, v190, v12
    v_mul_f32 v190, 0x3fb8aa3b, v190
    v_exp_f32 v190, v190
    v_sub_f32 v191, v191, v12
    v_mul_f32 v191, 0x3fb8aa3b, v191
    v_exp_f32 v191, v191
    v_sub_f32 v192, v192, v12
    v_mul_f32 v192, 0x3fb8aa3b, v192
    v_exp_f32 v192, v192
    v_sub_f32 v193, v193, v12
    v_mul_f32 v193, 0x3fb8aa3b, v193
    v_exp_f32 v193, v193
    v_sub_f32 v194, v194, v12
    v_mul_f32 v194, 0x3fb8aa3b, v194
    v_exp_f32 v194, v194
    v_sub_f32 v195, v195, v12
    v_mul_f32 v195, 0x3fb8aa3b, v195
    v_exp_f32 v195, v195
    v_sub_f32 v196, v196, v12
    v_mul_f32 v196, 0x3fb8aa3b, v196
    v_exp_f32 v196, v196
    v_sub_f32 v197, v197, v12
    v_mul_f32 v197, 0x3fb8aa3b, v197
    v_exp_f32 v197, v197
    v_sub_f32 v198, v198, v12
    v_mul_f32 v198, 0x3fb8aa3b, v198
    v_exp_f32 v198, v198
    v_sub_f32 v199, v199, v12
    v_mul_f32 v199, 0x3fb8aa3b, v199
    v_exp_f32 v199, v199
    s_nop 0
    v_add_f32 v12, v188, v189
    v_add_f32 v12, v12, v190
    v_add_f32 v12, v12, v191
    v_add_f32 v12, v12, v192
    v_add_f32 v12, v12, v193
    v_add_f32 v12, v12, v194
    v_add_f32 v12, v12, v195
    v_add_f32 v12, v12, v196
    v_add_f32 v12, v12, v197
    v_add_f32 v12, v12, v198
    v_add_f32 v12, v12, v199
    v_mov_b32 v13, v12
    v_mov_b32 v14, v12
    s_nop 1
    v_permlane16_swap_b32 v13, v14
    s_nop 1
    v_add_f32 v12, v13, v14
    v_mov_b32 v13, v12
    v_mov_b32 v14, v12
    s_nop 1
    v_permlane32_swap_b32 v13, v14
    s_nop 1
    v_add_f32 v12, v13, v14
    v_rcp_f32 v12, v12
    s_nop 0
    v_mul_f32 v188, v188, v12
    v_mul_f32 v189, v189, v12
    v_mul_f32 v190, v190, v12
    v_mul_f32 v191, v191, v12
    v_mul_f32 v192, v192, v12
    v_mul_f32 v193, v193, v12
    v_mul_f32 v194, v194, v12
    v_mul_f32 v195, v195, v12
    v_mul_f32 v196, v196, v12
    v_mul_f32 v197, v197, v12
    v_mul_f32 v198, v198, v12
    v_mul_f32 v199, v199, v12
    v_cvt_pk_bf16_f32 v208, v192, v193
    v_cvt_pk_bf16_f32 v209, v194, v195
    v_cvt_pk_bf16_f32 v210, v196, v197
    v_cvt_pk_bf16_f32 v211, v198, v199
    v_cvt_pk_bf16_f32 v212, v188, v189
    v_cvt_pk_bf16_f32 v213, v190, v191
    v_mov_b32 v214, 0
    v_mov_b32 v215, 0
    s_waitcnt vmcnt(0)
    v_mov_b32 v144, v216
    v_mov_b32 v145, v217
    v_mov_b32 v146, 0
    v_mov_b32 v147, 0
    v_mov_b32 v148, v218
    v_mov_b32 v149, v219
    v_mov_b32 v150, 0
    v_mov_b32 v151, 0
    v_mov_b32 v152, v220
    v_mov_b32 v153, v221
    v_mov_b32 v154, 0
    v_mov_b32 v155, 0
    v_mov_b32 v156, v222
    v_mov_b32 v157, v223
    v_mov_b32 v158, 0
    v_mov_b32 v159, 0
    v_mov_b32 v160, v224
    v_mov_b32 v161, v225
    v_mov_b32 v162, 0
    v_mov_b32 v163, 0
    v_mov_b32 v164, v226
    v_mov_b32 v165, v227
    v_mov_b32 v166, 0
    v_mov_b32 v167, 0
    v_mov_b32 v168, v228
    v_mov_b32 v169, v229
    v_mov_b32 v170, 0
    v_mov_b32 v171, 0
    v_mov_b32 v172, v230
    v_mov_b32 v173, v231
    v_mov_b32 v174, 0
    v_mov_b32 v175, 0
    s_nop 1
    v_mfma_f32_16x16x32_bf16 v[32:35], v[112:115], v[200:203], 0
    v_mfma_f32_16x16x32_bf16 v[36:39], v[116:119], v[200:203], 0
    v_mfma_f32_16x16x32_bf16 v[40:43], v[120:123], v[200:203], 0
    v_mfma_f32_16x16x32_bf16 v[44:47], v[124:127], v[200:203], 0
    v_mfma_f32_16x16x32_bf16 v[48:51], v[128:131], v[200:203], 0
    v_mfma_f32_16x16x32_bf16 v[52:55], v[132:135], v[200:203], 0
    v_mfma_f32_16x16x32_bf16 v[56:59], v[136:139], v[200:203], 0
    v_mfma_f32_16x16x32_bf16 v[60:63], v[140:143], v[200:203], 0
    v_mfma_f32_16x16x32_bf16 v[32:35], v[144:147], v[204:207], v[32:35]
    v_mfma_f32_16x16x32_bf16 v[36:39], v[148:151], v[204:207], v[36:39]
    v_mfma_f32_16x16x32_bf16 v[40:43], v[152:155], v[204:207], v[40:43]
    v_mfma_f32_16x16x32_bf16 v[44:47], v[156:159], v[204:207], v[44:47]
    v_mfma_f32_16x16x32_bf16 v[48:51], v[160:163], v[204:207], v[48:51]
    v_mfma_f32_16x16x32_bf16 v[52:55], v[164:167], v[204:207], v[52:55]
    v_mfma_f32_16x16x32_bf16 v[56:59], v[168:171], v[204:207], v[56:59]
    v_mfma_f32_16x16x32_bf16 v[60:63], v[172:175], v[204:207], v[60:63]
    v_mfma_f32_16x16x32_bf16 v[64:67], v[112:115], v[208:211], 0
    v_mfma_f32_16x16x32_bf16 v[68:71], v[116:119], v[208:211], 0
    v_mfma_f32_16x16x32_bf16 v[72:75], v[120:123], v[208:211], 0
    v_mfma_f32_16x16x32_bf16 v[76:79], v[124:127], v[208:211], 0
    v_mfma_f32_16x16x32_bf16 v[80:83], v[128:131], v[208:211], 0
    v_mfma_f32_16x16x32_bf16 v[84:87], v[132:135], v[208:211], 0
    v_mfma_f32_16x16x32_bf16 v[88:91], v[136:139], v[208:211], 0
    v_mfma_f32_16x16x32_bf16 v[92:95], v[140:143], v[208:211], 0
    v_mfma_f32_16x16x32_bf16 v[64:67], v[144:147], v[212:215], v[64:67]
    v_mfma_f32_16x16x32_bf16 v[68:71], v[148:151], v[212:215], v[68:71]
    v_mfma_f32_16x16x32_bf16 v[72:75], v[152:155], v[212:215], v[72:75]
    v_mfma_f32_16x16x32_bf16 v[76:79], v[156:159], v[212:215], v[76:79]
    v_mfma_f32_16x16x32_bf16 v[80:83], v[160:163], v[212:215], v[80:83]
    v_mfma_f32_16x16x32_bf16 v[84:87], v[164:167], v[212:215], v[84:87]
    v_mfma_f32_16x16x32_bf16 v[88:91], v[168:171], v[212:215], v[88:91]
    v_mfma_f32_16x16x32_bf16 v[92:95], v[172:175], v[212:215], v[92:95]
    s_nop 7
    s_lshl_b32 s22, s7, 18
    s_lshl_b32 s23, s8, 12
    s_add_u32 s22, s22, s23
    s_add_u32 s22, s22, 83886080
    s_add_u32 s23, s22, 0x20000
    v_cvt_pk_bf16_f32 v176, v32, v33
    v_cvt_pk_bf16_f32 v177, v34, v35
    v_cvt_pk_bf16_f32 v178, v36, v37
    v_cvt_pk_bf16_f32 v179, v38, v39
    buffer_store_dwordx4 v[176:179], v6, s[12:15], s22 offen offset:0
    v_cvt_pk_bf16_f32 v180, v40, v41
    v_cvt_pk_bf16_f32 v181, v42, v43
    v_cvt_pk_bf16_f32 v182, v44, v45
    v_cvt_pk_bf16_f32 v183, v46, v47
    buffer_store_dwordx4 v[180:183], v6, s[12:15], s22 offen offset:1024
    v_cvt_pk_bf16_f32 v184, v48, v49
    v_cvt_pk_bf16_f32 v185, v50, v51
    v_cvt_pk_bf16_f32 v186, v52, v53
    v_cvt_pk_bf16_f32 v187, v54, v55
    buffer_store_dwordx4 v[184:187], v6, s[12:15], s22 offen offset:2048
    v_cvt_pk_bf16_f32 v188, v56, v57
    v_cvt_pk_bf16_f32 v189, v58, v59
    v_cvt_pk_bf16_f32 v190, v60, v61
    v_cvt_pk_bf16_f32 v191, v62, v63
    buffer_store_dwordx4 v[188:191], v6, s[12:15], s22 offen offset:3072
    v_cvt_pk_bf16_f32 v192, v64, v65
    v_cvt_pk_bf16_f32 v193, v66, v67
    v_cvt_pk_bf16_f32 v194, v68, v69
    v_cvt_pk_bf16_f32 v195, v70, v71
    buffer_store_dwordx4 v[192:195], v6, s[12:15], s23 offen offset:0
    v_cvt_pk_bf16_f32 v196, v72, v73
    v_cvt_pk_bf16_f32 v197, v74, v75
    v_cvt_pk_bf16_f32 v198, v76, v77
    v_cvt_pk_bf16_f32 v199, v78, v79
    buffer_store_dwordx4 v[196:199], v6, s[12:15], s23 offen offset:1024
    v_cvt_pk_bf16_f32 v200, v80, v81
    v_cvt_pk_bf16_f32 v201, v82, v83
    v_cvt_pk_bf16_f32 v202, v84, v85
    v_cvt_pk_bf16_f32 v203, v86, v87
    buffer_store_dwordx4 v[200:203], v6, s[12:15], s23 offen offset:2048
    v_cvt_pk_bf16_f32 v204, v88, v89
    v_cvt_pk_bf16_f32 v205, v90, v91
    v_cvt_pk_bf16_f32 v206, v92, v93
    v_cvt_pk_bf16_f32 v207, v94, v95
    buffer_store_dwordx4 v[204:207], v6, s[12:15], s23 offen offset:3072
    s_add_u32 s6, s6, 896
    s_cmp_lt_u32 s6, 2048
    s_cbranch_scc1 a_unit
main_end:
    s_endpgm
.globl oproj_kernel
.p2align 8
.type oproj_kernel,@function
oproj_kernel:
    s_cmp_ge_u32 s2, 256
    s_cbranch_scc1 oproj_kernel_end
    s_load_dwordx2 s[4:5], s[0:1], 128
    s_load_dwordx2 s[8:9], s[0:1], 112
    s_load_dwordx2 s[10:11], s[0:1], 88
    v_lshrrev_b32 v1, 6, v0
    v_and_b32 v2, 63, v0
    s_nop 0
    v_readfirstlane_b32 s3, v1
    s_and_b32 s6, s2, 7
    s_lshl_b32 s6, s6, 2
    s_bfe_u32 s7, s2, 0x20003
    s_add_u32 s6, s6, s7
    s_lshr_b32 s7, s2, 5
    s_waitcnt lgkmcnt(0)
    s_mov_b32 s12, s4
    s_mov_b32 s13, s5
    s_and_b32 s13, s13, 0xffff
    s_mov_b32 s14, 268435455
    s_mov_b32 s15, 0x00020000
    v_and_b32 v3, 15, v2
    v_lshrrev_b32 v4, 4, v2
    v_lshlrev_b32 v6, 4, v2
    v_mov_b32 v7, v6
    s_mul_i32 s21, s6, 524288
    s_mul_i32 s22, s3, 32768
    s_add_u32 s21, s21, s22
    s_add_u32 s24, s21, 83886080
    s_add_u32 s25, s24, 131072
    s_add_u32 s26, s24, 262144
    s_add_u32 s27, s24, 393216
    s_mul_i32 s28, s3, 1048576
    s_lshl_b32 s29, s7, 12
    s_add_u32 s28, s28, s29
    s_add_u32 s28, s28, 16777216
    buffer_load_dwordx4 a[0:3], v7, s[12:15], s24 offen
    buffer_load_dwordx4 a[4:7], v7, s[12:15], s25 offen
    buffer_load_dwordx4 a[8:11], v7, s[12:15], s26 offen
    buffer_load_dwordx4 a[12:15], v7, s[12:15], s27 offen
    buffer_load_dwordx4 a[16:19], v6, s[12:15], s28 offen offset:0
    buffer_load_dwordx4 a[20:23], v6, s[12:15], s28 offen offset:1024
    buffer_load_dwordx4 a[24:27], v6, s[12:15], s28 offen offset:2048
    buffer_load_dwordx4 a[28:31], v6, s[12:15], s28 offen offset:3072
    v_add_u32 v7, 1024, v7
    s_add_u32 s28, s28, 32768
    buffer_load_dwordx4 a[32:35], v7, s[12:15], s24 offen
    buffer_load_dwordx4 a[36:39], v7, s[12:15], s25 offen
    buffer_load_dwordx4 a[40:43], v7, s[12:15], s26 offen
    buffer_load_dwordx4 a[44:47], v7, s[12:15], s27 offen
    buffer_load_dwordx4 a[48:51], v6, s[12:15], s28 offen offset:0
    buffer_load_dwordx4 a[52:55], v6, s[12:15], s28 offen offset:1024
    buffer_load_dwordx4 a[56:59], v6, s[12:15], s28 offen offset:2048
    buffer_load_dwordx4 a[60:63], v6, s[12:15], s28 offen offset:3072
    v_add_u32 v7, 1024, v7
    s_add_u32 s28, s28, 32768
    buffer_load_dwordx4 a[64:67], v7, s[12:15], s24 offen
    buffer_load_dwordx4 a[68:71], v7, s[12:15], s25 offen
    buffer_load_dwordx4 a[72:75], v7, s[12:15], s26 offen
    buffer_load_dwordx4 a[76:79], v7, s[12:15], s27 offen
    buffer_load_dwordx4 a[80:83], v6, s[12:15], s28 offen offset:0
    buffer_load_dwordx4 a[84:87], v6, s[12:15], s28 offen offset:1024
    buffer_load_dwordx4 a[88:91], v6, s[12:15], s28 offen offset:2048
    buffer_load_dwordx4 a[92:95], v6, s[12:15], s28 offen offset:3072
    v_add_u32 v7, 1024, v7
    s_add_u32 s28, s28, 32768
    buffer_load_dwordx4 a[96:99], v7, s[12:15], s24 offen
    buffer_load_dwordx4 a[100:103], v7, s[12:15], s25 offen
    buffer_load_dwordx4 a[104:107], v7, s[12:15], s26 offen
    buffer_load_dwordx4 a[108:111], v7, s[12:15], s27 offen
    buffer_load_dwordx4 a[112:115], v6, s[12:15], s28 offen offset:0
    buffer_load_dwordx4 a[116:119], v6, s[12:15], s28 offen offset:1024
    buffer_load_dwordx4 a[120:123], v6, s[12:15], s28 offen offset:2048
    buffer_load_dwordx4 a[124:127], v6, s[12:15], s28 offen offset:3072
    v_add_u32 v7, 1024, v7
    s_add_u32 s28, s28, 32768
    buffer_load_dwordx4 a[128:131], v7, s[12:15], s24 offen
    buffer_load_dwordx4 a[132:135], v7, s[12:15], s25 offen
    buffer_load_dwordx4 a[136:139], v7, s[12:15], s26 offen
    buffer_load_dwordx4 a[140:143], v7, s[12:15], s27 offen
    buffer_load_dwordx4 a[144:147], v6, s[12:15], s28 offen offset:0
    buffer_load_dwordx4 a[148:151], v6, s[12:15], s28 offen offset:1024
    buffer_load_dwordx4 a[152:155], v6, s[12:15], s28 offen offset:2048
    buffer_load_dwordx4 a[156:159], v6, s[12:15], s28 offen offset:3072
    v_add_u32 v7, 1024, v7
    s_add_u32 s28, s28, 32768
    buffer_load_dwordx4 a[160:163], v7, s[12:15], s24 offen
    buffer_load_dwordx4 a[164:167], v7, s[12:15], s25 offen
    buffer_load_dwordx4 a[168:171], v7, s[12:15], s26 offen
    buffer_load_dwordx4 a[172:175], v7, s[12:15], s27 offen
    buffer_load_dwordx4 a[176:179], v6, s[12:15], s28 offen offset:0
    buffer_load_dwordx4 a[180:183], v6, s[12:15], s28 offen offset:1024
    buffer_load_dwordx4 a[184:187], v6, s[12:15], s28 offen offset:2048
    buffer_load_dwordx4 a[188:191], v6, s[12:15], s28 offen offset:3072
    v_add_u32 v7, 1024, v7
    s_add_u32 s28, s28, 32768
    buffer_load_dwordx4 a[192:195], v7, s[12:15], s24 offen
    buffer_load_dwordx4 a[196:199], v7, s[12:15], s25 offen
    buffer_load_dwordx4 a[200:203], v7, s[12:15], s26 offen
    buffer_load_dwordx4 a[204:207], v7, s[12:15], s27 offen
    buffer_load_dwordx4 a[208:211], v6, s[12:15], s28 offen offset:0
    buffer_load_dwordx4 a[212:215], v6, s[12:15], s28 offen offset:1024
    buffer_load_dwordx4 a[216:219], v6, s[12:15], s28 offen offset:2048
    buffer_load_dwordx4 a[220:223], v6, s[12:15], s28 offen offset:3072
    v_add_u32 v7, 1024, v7
    s_add_u32 s28, s28, 32768
    buffer_load_dwordx4 a[224:227], v7, s[12:15], s24 offen
    buffer_load_dwordx4 a[228:231], v7, s[12:15], s25 offen
    buffer_load_dwordx4 a[232:235], v7, s[12:15], s26 offen
    buffer_load_dwordx4 a[236:239], v7, s[12:15], s27 offen
    buffer_load_dwordx4 a[240:243], v6, s[12:15], s28 offen offset:0
    buffer_load_dwordx4 a[244:247], v6, s[12:15], s28 offen offset:1024
    buffer_load_dwordx4 a[248:251], v6, s[12:15], s28 offen offset:2048
    buffer_load_dwordx4 a[252:255], v6, s[12:15], s28 offen offset:3072
    v_add_u32 v7, 1024, v7
    s_add_u32 s28, s28, 32768
    s_waitcnt vmcnt(56)
    v_mfma_f32_16x16x32_bf16 v[128:131], a[16:19], a[0:3], 0
    v_mfma_f32_16x16x32_bf16 v[132:135], a[20:23], a[0:3], 0
    v_mfma_f32_16x16x32_bf16 v[136:139], a[24:27], a[0:3], 0
    v_mfma_f32_16x16x32_bf16 v[140:143], a[28:31], a[0:3], 0
    v_mfma_f32_16x16x32_bf16 v[144:147], a[16:19], a[4:7], 0
    v_mfma_f32_16x16x32_bf16 v[148:151], a[20:23], a[4:7], 0
    v_mfma_f32_16x16x32_bf16 v[152:155], a[24:27], a[4:7], 0
    v_mfma_f32_16x16x32_bf16 v[156:159], a[28:31], a[4:7], 0
    v_mfma_f32_16x16x32_bf16 v[160:163], a[16:19], a[8:11], 0
    v_mfma_f32_16x16x32_bf16 v[164:167], a[20:23], a[8:11], 0
    v_mfma_f32_16x16x32_bf16 v[168:171], a[24:27], a[8:11], 0
    v_mfma_f32_16x16x32_bf16 v[172:175], a[28:31], a[8:11], 0
    v_mfma_f32_16x16x32_bf16 v[176:179], a[16:19], a[12:15], 0
    v_mfma_f32_16x16x32_bf16 v[180:183], a[20:23], a[12:15], 0
    v_mfma_f32_16x16x32_bf16 v[184:187], a[24:27], a[12:15], 0
    v_mfma_f32_16x16x32_bf16 v[188:191], a[28:31], a[12:15], 0
    buffer_load_dwordx4 a[0:3], v7, s[12:15], s24 offen
    buffer_load_dwordx4 a[4:7], v7, s[12:15], s25 offen
    buffer_load_dwordx4 a[8:11], v7, s[12:15], s26 offen
    buffer_load_dwordx4 a[12:15], v7, s[12:15], s27 offen
    buffer_load_dwordx4 a[16:19], v6, s[12:15], s28 offen offset:0
    buffer_load_dwordx4 a[20:23], v6, s[12:15], s28 offen offset:1024
    buffer_load_dwordx4 a[24:27], v6, s[12:15], s28 offen offset:2048
    buffer_load_dwordx4 a[28:31], v6, s[12:15], s28 offen offset:3072
    v_add_u32 v7, 1024, v7
    s_add_u32 s28, s28, 32768
    s_waitcnt vmcnt(56)
    v_mfma_f32_16x16x32_bf16 v[128:131], a[48:51], a[32:35], v[128:131]
    v_mfma_f32_16x16x32_bf16 v[132:135], a[52:55], a[32:35], v[132:135]
    v_mfma_f32_16x16x32_bf16 v[136:139], a[56:59], a[32:35], v[136:139]
    v_mfma_f32_16x16x32_bf16 v[140:143], a[60:63], a[32:35], v[140:143]
    v_mfma_f32_16x16x32_bf16 v[144:147], a[48:51], a[36:39], v[144:147]
    v_mfma_f32_16x16x32_bf16 v[148:151], a[52:55], a[36:39], v[148:151]
    v_mfma_f32_16x16x32_bf16 v[152:155], a[56:59], a[36:39], v[152:155]
    v_mfma_f32_16x16x32_bf16 v[156:159], a[60:63], a[36:39], v[156:159]
    v_mfma_f32_16x16x32_bf16 v[160:163], a[48:51], a[40:43], v[160:163]
    v_mfma_f32_16x16x32_bf16 v[164:167], a[52:55], a[40:43], v[164:167]
    v_mfma_f32_16x16x32_bf16 v[168:171], a[56:59], a[40:43], v[168:171]
    v_mfma_f32_16x16x32_bf16 v[172:175], a[60:63], a[40:43], v[172:175]
    v_mfma_f32_16x16x32_bf16 v[176:179], a[48:51], a[44:47], v[176:179]
    v_mfma_f32_16x16x32_bf16 v[180:183], a[52:55], a[44:47], v[180:183]
    v_mfma_f32_16x16x32_bf16 v[184:187], a[56:59], a[44:47], v[184:187]
    v_mfma_f32_16x16x32_bf16 v[188:191], a[60:63], a[44:47], v[188:191]
    buffer_load_dwordx4 a[32:35], v7, s[12:15], s24 offen
    buffer_load_dwordx4 a[36:39], v7, s[12:15], s25 offen
    buffer_load_dwordx4 a[40:43], v7, s[12:15], s26 offen
    buffer_load_dwordx4 a[44:47], v7, s[12:15], s27 offen
    buffer_load_dwordx4 a[48:51], v6, s[12:15], s28 offen offset:0
    buffer_load_dwordx4 a[52:55], v6, s[12:15], s28 offen offset:1024
    buffer_load_dwordx4 a[56:59], v6, s[12:15], s28 offen offset:2048
    buffer_load_dwordx4 a[60:63], v6, s[12:15], s28 offen offset:3072
    v_add_u32 v7, 1024, v7
    s_add_u32 s28, s28, 32768
    s_waitcnt vmcnt(56)
    v_mfma_f32_16x16x32_bf16 v[128:131], a[80:83], a[64:67], v[128:131]
    v_mfma_f32_16x16x32_bf16 v[132:135], a[84:87], a[64:67], v[132:135]
    v_mfma_f32_16x16x32_bf16 v[136:139], a[88:91], a[64:67], v[136:139]
    v_mfma_f32_16x16x32_bf16 v[140:143], a[92:95], a[64:67], v[140:143]
    v_mfma_f32_16x16x32_bf16 v[144:147], a[80:83], a[68:71], v[144:147]
    v_mfma_f32_16x16x32_bf16 v[148:151], a[84:87], a[68:71], v[148:151]
    v_mfma_f32_16x16x32_bf16 v[152:155], a[88:91], a[68:71], v[152:155]
    v_mfma_f32_16x16x32_bf16 v[156:159], a[92:95], a[68:71], v[156:159]
    v_mfma_f32_16x16x32_bf16 v[160:163], a[80:83], a[72:75], v[160:163]
    v_mfma_f32_16x16x32_bf16 v[164:167], a[84:87], a[72:75], v[164:167]
    v_mfma_f32_16x16x32_bf16 v[168:171], a[88:91], a[72:75], v[168:171]
    v_mfma_f32_16x16x32_bf16 v[172:175], a[92:95], a[72:75], v[172:175]
    v_mfma_f32_16x16x32_bf16 v[176:179], a[80:83], a[76:79], v[176:179]
    v_mfma_f32_16x16x32_bf16 v[180:183], a[84:87], a[76:79], v[180:183]
    v_mfma_f32_16x16x32_bf16 v[184:187], a[88:91], a[76:79], v[184:187]
    v_mfma_f32_16x16x32_bf16 v[188:191], a[92:95], a[76:79], v[188:191]
    buffer_load_dwordx4 a[64:67], v7, s[12:15], s24 offen
    buffer_load_dwordx4 a[68:71], v7, s[12:15], s25 offen
    buffer_load_dwordx4 a[72:75], v7, s[12:15], s26 offen
    buffer_load_dwordx4 a[76:79], v7, s[12:15], s27 offen
    buffer_load_dwordx4 a[80:83], v6, s[12:15], s28 offen offset:0
    buffer_load_dwordx4 a[84:87], v6, s[12:15], s28 offen offset:1024
    buffer_load_dwordx4 a[88:91], v6, s[12:15], s28 offen offset:2048
    buffer_load_dwordx4 a[92:95], v6, s[12:15], s28 offen offset:3072
    v_add_u32 v7, 1024, v7
    s_add_u32 s28, s28, 32768
    s_waitcnt vmcnt(56)
    v_mfma_f32_16x16x32_bf16 v[128:131], a[112:115], a[96:99], v[128:131]
    v_mfma_f32_16x16x32_bf16 v[132:135], a[116:119], a[96:99], v[132:135]
    v_mfma_f32_16x16x32_bf16 v[136:139], a[120:123], a[96:99], v[136:139]
    v_mfma_f32_16x16x32_bf16 v[140:143], a[124:127], a[96:99], v[140:143]
    v_mfma_f32_16x16x32_bf16 v[144:147], a[112:115], a[100:103], v[144:147]
    v_mfma_f32_16x16x32_bf16 v[148:151], a[116:119], a[100:103], v[148:151]
    v_mfma_f32_16x16x32_bf16 v[152:155], a[120:123], a[100:103], v[152:155]
    v_mfma_f32_16x16x32_bf16 v[156:159], a[124:127], a[100:103], v[156:159]
    v_mfma_f32_16x16x32_bf16 v[160:163], a[112:115], a[104:107], v[160:163]
    v_mfma_f32_16x16x32_bf16 v[164:167], a[116:119], a[104:107], v[164:167]
    v_mfma_f32_16x16x32_bf16 v[168:171], a[120:123], a[104:107], v[168:171]
    v_mfma_f32_16x16x32_bf16 v[172:175], a[124:127], a[104:107], v[172:175]
    v_mfma_f32_16x16x32_bf16 v[176:179], a[112:115], a[108:111], v[176:179]
    v_mfma_f32_16x16x32_bf16 v[180:183], a[116:119], a[108:111], v[180:183]
    v_mfma_f32_16x16x32_bf16 v[184:187], a[120:123], a[108:111], v[184:187]
    v_mfma_f32_16x16x32_bf16 v[188:191], a[124:127], a[108:111], v[188:191]
    buffer_load_dwordx4 a[96:99], v7, s[12:15], s24 offen
    buffer_load_dwordx4 a[100:103], v7, s[12:15], s25 offen
    buffer_load_dwordx4 a[104:107], v7, s[12:15], s26 offen
    buffer_load_dwordx4 a[108:111], v7, s[12:15], s27 offen
    buffer_load_dwordx4 a[112:115], v6, s[12:15], s28 offen offset:0
    buffer_load_dwordx4 a[116:119], v6, s[12:15], s28 offen offset:1024
    buffer_load_dwordx4 a[120:123], v6, s[12:15], s28 offen offset:2048
    buffer_load_dwordx4 a[124:127], v6, s[12:15], s28 offen offset:3072
    v_add_u32 v7, 1024, v7
    s_add_u32 s28, s28, 32768
    s_waitcnt vmcnt(56)
    v_mfma_f32_16x16x32_bf16 v[128:131], a[144:147], a[128:131], v[128:131]
    v_mfma_f32_16x16x32_bf16 v[132:135], a[148:151], a[128:131], v[132:135]
    v_mfma_f32_16x16x32_bf16 v[136:139], a[152:155], a[128:131], v[136:139]
    v_mfma_f32_16x16x32_bf16 v[140:143], a[156:159], a[128:131], v[140:143]
    v_mfma_f32_16x16x32_bf16 v[144:147], a[144:147], a[132:135], v[144:147]
    v_mfma_f32_16x16x32_bf16 v[148:151], a[148:151], a[132:135], v[148:151]
    v_mfma_f32_16x16x32_bf16 v[152:155], a[152:155], a[132:135], v[152:155]
    v_mfma_f32_16x16x32_bf16 v[156:159], a[156:159], a[132:135], v[156:159]
    v_mfma_f32_16x16x32_bf16 v[160:163], a[144:147], a[136:139], v[160:163]
    v_mfma_f32_16x16x32_bf16 v[164:167], a[148:151], a[136:139], v[164:167]
    v_mfma_f32_16x16x32_bf16 v[168:171], a[152:155], a[136:139], v[168:171]
    v_mfma_f32_16x16x32_bf16 v[172:175], a[156:159], a[136:139], v[172:175]
    v_mfma_f32_16x16x32_bf16 v[176:179], a[144:147], a[140:143], v[176:179]
    v_mfma_f32_16x16x32_bf16 v[180:183], a[148:151], a[140:143], v[180:183]
    v_mfma_f32_16x16x32_bf16 v[184:187], a[152:155], a[140:143], v[184:187]
    v_mfma_f32_16x16x32_bf16 v[188:191], a[156:159], a[140:143], v[188:191]
    buffer_load_dwordx4 a[128:131], v7, s[12:15], s24 offen
    buffer_load_dwordx4 a[132:135], v7, s[12:15], s25 offen
    buffer_load_dwordx4 a[136:139], v7, s[12:15], s26 offen
    buffer_load_dwordx4 a[140:143], v7, s[12:15], s27 offen
    buffer_load_dwordx4 a[144:147], v6, s[12:15], s28 offen offset:0
    buffer_load_dwordx4 a[148:151], v6, s[12:15], s28 offen offset:1024
    buffer_load_dwordx4 a[152:155], v6, s[12:15], s28 offen offset:2048
    buffer_load_dwordx4 a[156:159], v6, s[12:15], s28 offen offset:3072
    v_add_u32 v7, 1024, v7
    s_add_u32 s28, s28, 32768
    s_waitcnt vmcnt(56)
    v_mfma_f32_16x16x32_bf16 v[128:131], a[176:179], a[160:163], v[128:131]
    v_mfma_f32_16x16x32_bf16 v[132:135], a[180:183], a[160:163], v[132:135]
    v_mfma_f32_16x16x32_bf16 v[136:139], a[184:187], a[160:163], v[136:139]
    v_mfma_f32_16x16x32_bf16 v[140:143], a[188:191], a[160:163], v[140:143]
    v_mfma_f32_16x16x32_bf16 v[144:147], a[176:179], a[164:167], v[144:147]
    v_mfma_f32_16x16x32_bf16 v[148:151], a[180:183], a[164:167], v[148:151]
    v_mfma_f32_16x16x32_bf16 v[152:155], a[184:187], a[164:167], v[152:155]
    v_mfma_f32_16x16x32_bf16 v[156:159], a[188:191], a[164:167], v[156:159]
    v_mfma_f32_16x16x32_bf16 v[160:163], a[176:179], a[168:171], v[160:163]
    v_mfma_f32_16x16x32_bf16 v[164:167], a[180:183], a[168:171], v[164:167]
    v_mfma_f32_16x16x32_bf16 v[168:171], a[184:187], a[168:171], v[168:171]
    v_mfma_f32_16x16x32_bf16 v[172:175], a[188:191], a[168:171], v[172:175]
    v_mfma_f32_16x16x32_bf16 v[176:179], a[176:179], a[172:175], v[176:179]
    v_mfma_f32_16x16x32_bf16 v[180:183], a[180:183], a[172:175], v[180:183]
    v_mfma_f32_16x16x32_bf16 v[184:187], a[184:187], a[172:175], v[184:187]
    v_mfma_f32_16x16x32_bf16 v[188:191], a[188:191], a[172:175], v[188:191]
    buffer_load_dwordx4 a[160:163], v7, s[12:15], s24 offen
    buffer_load_dwordx4 a[164:167], v7, s[12:15], s25 offen
    buffer_load_dwordx4 a[168:171], v7, s[12:15], s26 offen
    buffer_load_dwordx4 a[172:175], v7, s[12:15], s27 offen
    buffer_load_dwordx4 a[176:179], v6, s[12:15], s28 offen offset:0
    buffer_load_dwordx4 a[180:183], v6, s[12:15], s28 offen offset:1024
    buffer_load_dwordx4 a[184:187], v6, s[12:15], s28 offen offset:2048
    buffer_load_dwordx4 a[188:191], v6, s[12:15], s28 offen offset:3072
    v_add_u32 v7, 1024, v7
    s_add_u32 s28, s28, 32768
    s_waitcnt vmcnt(56)
    v_mfma_f32_16x16x32_bf16 v[128:131], a[208:211], a[192:195], v[128:131]
    v_mfma_f32_16x16x32_bf16 v[132:135], a[212:215], a[192:195], v[132:135]
    v_mfma_f32_16x16x32_bf16 v[136:139], a[216:219], a[192:195], v[136:139]
    v_mfma_f32_16x16x32_bf16 v[140:143], a[220:223], a[192:195], v[140:143]
    v_mfma_f32_16x16x32_bf16 v[144:147], a[208:211], a[196:199], v[144:147]
    v_mfma_f32_16x16x32_bf16 v[148:151], a[212:215], a[196:199], v[148:151]
    v_mfma_f32_16x16x32_bf16 v[152:155], a[216:219], a[196:199], v[152:155]
    v_mfma_f32_16x16x32_bf16 v[156:159], a[220:223], a[196:199], v[156:159]
    v_mfma_f32_16x16x32_bf16 v[160:163], a[208:211], a[200:203], v[160:163]
    v_mfma_f32_16x16x32_bf16 v[164:167], a[212:215], a[200:203], v[164:167]
    v_mfma_f32_16x16x32_bf16 v[168:171], a[216:219], a[200:203], v[168:171]
    v_mfma_f32_16x16x32_bf16 v[172:175], a[220:223], a[200:203], v[172:175]
    v_mfma_f32_16x16x32_bf16 v[176:179], a[208:211], a[204:207], v[176:179]
    v_mfma_f32_16x16x32_bf16 v[180:183], a[212:215], a[204:207], v[180:183]
    v_mfma_f32_16x16x32_bf16 v[184:187], a[216:219], a[204:207], v[184:187]
    v_mfma_f32_16x16x32_bf16 v[188:191], a[220:223], a[204:207], v[188:191]
    buffer_load_dwordx4 a[192:195], v7, s[12:15], s24 offen
    buffer_load_dwordx4 a[196:199], v7, s[12:15], s25 offen
    buffer_load_dwordx4 a[200:203], v7, s[12:15], s26 offen
    buffer_load_dwordx4 a[204:207], v7, s[12:15], s27 offen
    buffer_load_dwordx4 a[208:211], v6, s[12:15], s28 offen offset:0
    buffer_load_dwordx4 a[212:215], v6, s[12:15], s28 offen offset:1024
    buffer_load_dwordx4 a[216:219], v6, s[12:15], s28 offen offset:2048
    buffer_load_dwordx4 a[220:223], v6, s[12:15], s28 offen offset:3072
    v_add_u32 v7, 1024, v7
    s_add_u32 s28, s28, 32768
    s_waitcnt vmcnt(56)
    v_mfma_f32_16x16x32_bf16 v[128:131], a[240:243], a[224:227], v[128:131]
    v_mfma_f32_16x16x32_bf16 v[132:135], a[244:247], a[224:227], v[132:135]
    v_mfma_f32_16x16x32_bf16 v[136:139], a[248:251], a[224:227], v[136:139]
    v_mfma_f32_16x16x32_bf16 v[140:143], a[252:255], a[224:227], v[140:143]
    v_mfma_f32_16x16x32_bf16 v[144:147], a[240:243], a[228:231], v[144:147]
    v_mfma_f32_16x16x32_bf16 v[148:151], a[244:247], a[228:231], v[148:151]
    v_mfma_f32_16x16x32_bf16 v[152:155], a[248:251], a[228:231], v[152:155]
    v_mfma_f32_16x16x32_bf16 v[156:159], a[252:255], a[228:231], v[156:159]
    v_mfma_f32_16x16x32_bf16 v[160:163], a[240:243], a[232:235], v[160:163]
    v_mfma_f32_16x16x32_bf16 v[164:167], a[244:247], a[232:235], v[164:167]
    v_mfma_f32_16x16x32_bf16 v[168:171], a[248:251], a[232:235], v[168:171]
    v_mfma_f32_16x16x32_bf16 v[172:175], a[252:255], a[232:235], v[172:175]
    v_mfma_f32_16x16x32_bf16 v[176:179], a[240:243], a[236:239], v[176:179]
    v_mfma_f32_16x16x32_bf16 v[180:183], a[244:247], a[236:239], v[180:183]
    v_mfma_f32_16x16x32_bf16 v[184:187], a[248:251], a[236:239], v[184:187]
    v_mfma_f32_16x16x32_bf16 v[188:191], a[252:255], a[236:239], v[188:191]
    buffer_load_dwordx4 a[224:227], v7, s[12:15], s24 offen
    buffer_load_dwordx4 a[228:231], v7, s[12:15], s25 offen
    buffer_load_dwordx4 a[232:235], v7, s[12:15], s26 offen
    buffer_load_dwordx4 a[236:239], v7, s[12:15], s27 offen
    buffer_load_dwordx4 a[240:243], v6, s[12:15], s28 offen offset:0
    buffer_load_dwordx4 a[244:247], v6, s[12:15], s28 offen offset:1024
    buffer_load_dwordx4 a[248:251], v6, s[12:15], s28 offen offset:2048
    buffer_load_dwordx4 a[252:255], v6, s[12:15], s28 offen offset:3072
    v_add_u32 v7, 1024, v7
    s_add_u32 s28, s28, 32768
    s_waitcnt vmcnt(56)
    v_mfma_f32_16x16x32_bf16 v[128:131], a[16:19], a[0:3], v[128:131]
    v_mfma_f32_16x16x32_bf16 v[132:135], a[20:23], a[0:3], v[132:135]
    v_mfma_f32_16x16x32_bf16 v[136:139], a[24:27], a[0:3], v[136:139]
    v_mfma_f32_16x16x32_bf16 v[140:143], a[28:31], a[0:3], v[140:143]
    v_mfma_f32_16x16x32_bf16 v[144:147], a[16:19], a[4:7], v[144:147]
    v_mfma_f32_16x16x32_bf16 v[148:151], a[20:23], a[4:7], v[148:151]
    v_mfma_f32_16x16x32_bf16 v[152:155], a[24:27], a[4:7], v[152:155]
    v_mfma_f32_16x16x32_bf16 v[156:159], a[28:31], a[4:7], v[156:159]
    v_mfma_f32_16x16x32_bf16 v[160:163], a[16:19], a[8:11], v[160:163]
    v_mfma_f32_16x16x32_bf16 v[164:167], a[20:23], a[8:11], v[164:167]
    v_mfma_f32_16x16x32_bf16 v[168:171], a[24:27], a[8:11], v[168:171]
    v_mfma_f32_16x16x32_bf16 v[172:175], a[28:31], a[8:11], v[172:175]
    v_mfma_f32_16x16x32_bf16 v[176:179], a[16:19], a[12:15], v[176:179]
    v_mfma_f32_16x16x32_bf16 v[180:183], a[20:23], a[12:15], v[180:183]
    v_mfma_f32_16x16x32_bf16 v[184:187], a[24:27], a[12:15], v[184:187]
    v_mfma_f32_16x16x32_bf16 v[188:191], a[28:31], a[12:15], v[188:191]
    buffer_load_dwordx4 a[0:3], v7, s[12:15], s24 offen
    buffer_load_dwordx4 a[4:7], v7, s[12:15], s25 offen
    buffer_load_dwordx4 a[8:11], v7, s[12:15], s26 offen
    buffer_load_dwordx4 a[12:15], v7, s[12:15], s27 offen
    buffer_load_dwordx4 a[16:19], v6, s[12:15], s28 offen offset:0
    buffer_load_dwordx4 a[20:23], v6, s[12:15], s28 offen offset:1024
    buffer_load_dwordx4 a[24:27], v6, s[12:15], s28 offen offset:2048
    buffer_load_dwordx4 a[28:31], v6, s[12:15], s28 offen offset:3072
    v_add_u32 v7, 1024, v7
    s_add_u32 s28, s28, 32768
    s_waitcnt vmcnt(56)
    v_mfma_f32_16x16x32_bf16 v[128:131], a[48:51], a[32:35], v[128:131]
    v_mfma_f32_16x16x32_bf16 v[132:135], a[52:55], a[32:35], v[132:135]
    v_mfma_f32_16x16x32_bf16 v[136:139], a[56:59], a[32:35], v[136:139]
    v_mfma_f32_16x16x32_bf16 v[140:143], a[60:63], a[32:35], v[140:143]
    v_mfma_f32_16x16x32_bf16 v[144:147], a[48:51], a[36:39], v[144:147]
    v_mfma_f32_16x16x32_bf16 v[148:151], a[52:55], a[36:39], v[148:151]
    v_mfma_f32_16x16x32_bf16 v[152:155], a[56:59], a[36:39], v[152:155]
    v_mfma_f32_16x16x32_bf16 v[156:159], a[60:63], a[36:39], v[156:159]
    v_mfma_f32_16x16x32_bf16 v[160:163], a[48:51], a[40:43], v[160:163]
    v_mfma_f32_16x16x32_bf16 v[164:167], a[52:55], a[40:43], v[164:167]
    v_mfma_f32_16x16x32_bf16 v[168:171], a[56:59], a[40:43], v[168:171]
    v_mfma_f32_16x16x32_bf16 v[172:175], a[60:63], a[40:43], v[172:175]
    v_mfma_f32_16x16x32_bf16 v[176:179], a[48:51], a[44:47], v[176:179]
    v_mfma_f32_16x16x32_bf16 v[180:183], a[52:55], a[44:47], v[180:183]
    v_mfma_f32_16x16x32_bf16 v[184:187], a[56:59], a[44:47], v[184:187]
    v_mfma_f32_16x16x32_bf16 v[188:191], a[60:63], a[44:47], v[188:191]
    buffer_load_dwordx4 a[32:35], v7, s[12:15], s24 offen
    buffer_load_dwordx4 a[36:39], v7, s[12:15], s25 offen
    buffer_load_dwordx4 a[40:43], v7, s[12:15], s26 offen
    buffer_load_dwordx4 a[44:47], v7, s[12:15], s27 offen
    buffer_load_dwordx4 a[48:51], v6, s[12:15], s28 offen offset:0
    buffer_load_dwordx4 a[52:55], v6, s[12:15], s28 offen offset:1024
    buffer_load_dwordx4 a[56:59], v6, s[12:15], s28 offen offset:2048
    buffer_load_dwordx4 a[60:63], v6, s[12:15], s28 offen offset:3072
    v_add_u32 v7, 1024, v7
    s_add_u32 s28, s28, 32768
    s_waitcnt vmcnt(56)
    v_mfma_f32_16x16x32_bf16 v[128:131], a[80:83], a[64:67], v[128:131]
    v_mfma_f32_16x16x32_bf16 v[132:135], a[84:87], a[64:67], v[132:135]
    v_mfma_f32_16x16x32_bf16 v[136:139], a[88:91], a[64:67], v[136:139]
    v_mfma_f32_16x16x32_bf16 v[140:143], a[92:95], a[64:67], v[140:143]
    v_mfma_f32_16x16x32_bf16 v[144:147], a[80:83], a[68:71], v[144:147]
    v_mfma_f32_16x16x32_bf16 v[148:151], a[84:87], a[68:71], v[148:151]
    v_mfma_f32_16x16x32_bf16 v[152:155], a[88:91], a[68:71], v[152:155]
    v_mfma_f32_16x16x32_bf16 v[156:159], a[92:95], a[68:71], v[156:159]
    v_mfma_f32_16x16x32_bf16 v[160:163], a[80:83], a[72:75], v[160:163]
    v_mfma_f32_16x16x32_bf16 v[164:167], a[84:87], a[72:75], v[164:167]
    v_mfma_f32_16x16x32_bf16 v[168:171], a[88:91], a[72:75], v[168:171]
    v_mfma_f32_16x16x32_bf16 v[172:175], a[92:95], a[72:75], v[172:175]
    v_mfma_f32_16x16x32_bf16 v[176:179], a[80:83], a[76:79], v[176:179]
    v_mfma_f32_16x16x32_bf16 v[180:183], a[84:87], a[76:79], v[180:183]
    v_mfma_f32_16x16x32_bf16 v[184:187], a[88:91], a[76:79], v[184:187]
    v_mfma_f32_16x16x32_bf16 v[188:191], a[92:95], a[76:79], v[188:191]
    buffer_load_dwordx4 a[64:67], v7, s[12:15], s24 offen
    buffer_load_dwordx4 a[68:71], v7, s[12:15], s25 offen
    buffer_load_dwordx4 a[72:75], v7, s[12:15], s26 offen
    buffer_load_dwordx4 a[76:79], v7, s[12:15], s27 offen
    buffer_load_dwordx4 a[80:83], v6, s[12:15], s28 offen offset:0
    buffer_load_dwordx4 a[84:87], v6, s[12:15], s28 offen offset:1024
    buffer_load_dwordx4 a[88:91], v6, s[12:15], s28 offen offset:2048
    buffer_load_dwordx4 a[92:95], v6, s[12:15], s28 offen offset:3072
    v_add_u32 v7, 1024, v7
    s_add_u32 s28, s28, 32768
    s_waitcnt vmcnt(56)
    v_mfma_f32_16x16x32_bf16 v[128:131], a[112:115], a[96:99], v[128:131]
    v_mfma_f32_16x16x32_bf16 v[132:135], a[116:119], a[96:99], v[132:135]
    v_mfma_f32_16x16x32_bf16 v[136:139], a[120:123], a[96:99], v[136:139]
    v_mfma_f32_16x16x32_bf16 v[140:143], a[124:127], a[96:99], v[140:143]
    v_mfma_f32_16x16x32_bf16 v[144:147], a[112:115], a[100:103], v[144:147]
    v_mfma_f32_16x16x32_bf16 v[148:151], a[116:119], a[100:103], v[148:151]
    v_mfma_f32_16x16x32_bf16 v[152:155], a[120:123], a[100:103], v[152:155]
    v_mfma_f32_16x16x32_bf16 v[156:159], a[124:127], a[100:103], v[156:159]
    v_mfma_f32_16x16x32_bf16 v[160:163], a[112:115], a[104:107], v[160:163]
    v_mfma_f32_16x16x32_bf16 v[164:167], a[116:119], a[104:107], v[164:167]
    v_mfma_f32_16x16x32_bf16 v[168:171], a[120:123], a[104:107], v[168:171]
    v_mfma_f32_16x16x32_bf16 v[172:175], a[124:127], a[104:107], v[172:175]
    v_mfma_f32_16x16x32_bf16 v[176:179], a[112:115], a[108:111], v[176:179]
    v_mfma_f32_16x16x32_bf16 v[180:183], a[116:119], a[108:111], v[180:183]
    v_mfma_f32_16x16x32_bf16 v[184:187], a[120:123], a[108:111], v[184:187]
    v_mfma_f32_16x16x32_bf16 v[188:191], a[124:127], a[108:111], v[188:191]
    buffer_load_dwordx4 a[96:99], v7, s[12:15], s24 offen
    buffer_load_dwordx4 a[100:103], v7, s[12:15], s25 offen
    buffer_load_dwordx4 a[104:107], v7, s[12:15], s26 offen
    buffer_load_dwordx4 a[108:111], v7, s[12:15], s27 offen
    buffer_load_dwordx4 a[112:115], v6, s[12:15], s28 offen offset:0
    buffer_load_dwordx4 a[116:119], v6, s[12:15], s28 offen offset:1024
    buffer_load_dwordx4 a[120:123], v6, s[12:15], s28 offen offset:2048
    buffer_load_dwordx4 a[124:127], v6, s[12:15], s28 offen offset:3072
    v_add_u32 v7, 1024, v7
    s_add_u32 s28, s28, 32768
    s_waitcnt vmcnt(56)
    v_mfma_f32_16x16x32_bf16 v[128:131], a[144:147], a[128:131], v[128:131]
    v_mfma_f32_16x16x32_bf16 v[132:135], a[148:151], a[128:131], v[132:135]
    v_mfma_f32_16x16x32_bf16 v[136:139], a[152:155], a[128:131], v[136:139]
    v_mfma_f32_16x16x32_bf16 v[140:143], a[156:159], a[128:131], v[140:143]
    v_mfma_f32_16x16x32_bf16 v[144:147], a[144:147], a[132:135], v[144:147]
    v_mfma_f32_16x16x32_bf16 v[148:151], a[148:151], a[132:135], v[148:151]
    v_mfma_f32_16x16x32_bf16 v[152:155], a[152:155], a[132:135], v[152:155]
    v_mfma_f32_16x16x32_bf16 v[156:159], a[156:159], a[132:135], v[156:159]
    v_mfma_f32_16x16x32_bf16 v[160:163], a[144:147], a[136:139], v[160:163]
    v_mfma_f32_16x16x32_bf16 v[164:167], a[148:151], a[136:139], v[164:167]
    v_mfma_f32_16x16x32_bf16 v[168:171], a[152:155], a[136:139], v[168:171]
    v_mfma_f32_16x16x32_bf16 v[172:175], a[156:159], a[136:139], v[172:175]
    v_mfma_f32_16x16x32_bf16 v[176:179], a[144:147], a[140:143], v[176:179]
    v_mfma_f32_16x16x32_bf16 v[180:183], a[148:151], a[140:143], v[180:183]
    v_mfma_f32_16x16x32_bf16 v[184:187], a[152:155], a[140:143], v[184:187]
    v_mfma_f32_16x16x32_bf16 v[188:191], a[156:159], a[140:143], v[188:191]
    buffer_load_dwordx4 a[128:131], v7, s[12:15], s24 offen
    buffer_load_dwordx4 a[132:135], v7, s[12:15], s25 offen
    buffer_load_dwordx4 a[136:139], v7, s[12:15], s26 offen
    buffer_load_dwordx4 a[140:143], v7, s[12:15], s27 offen
    buffer_load_dwordx4 a[144:147], v6, s[12:15], s28 offen offset:0
    buffer_load_dwordx4 a[148:151], v6, s[12:15], s28 offen offset:1024
    buffer_load_dwordx4 a[152:155], v6, s[12:15], s28 offen offset:2048
    buffer_load_dwordx4 a[156:159], v6, s[12:15], s28 offen offset:3072
    v_add_u32 v7, 1024, v7
    s_add_u32 s28, s28, 32768
    s_waitcnt vmcnt(56)
    v_mfma_f32_16x16x32_bf16 v[128:131], a[176:179], a[160:163], v[128:131]
    v_mfma_f32_16x16x32_bf16 v[132:135], a[180:183], a[160:163], v[132:135]
    v_mfma_f32_16x16x32_bf16 v[136:139], a[184:187], a[160:163], v[136:139]
    v_mfma_f32_16x16x32_bf16 v[140:143], a[188:191], a[160:163], v[140:143]
    v_mfma_f32_16x16x32_bf16 v[144:147], a[176:179], a[164:167], v[144:147]
    v_mfma_f32_16x16x32_bf16 v[148:151], a[180:183], a[164:167], v[148:151]
    v_mfma_f32_16x16x32_bf16 v[152:155], a[184:187], a[164:167], v[152:155]
    v_mfma_f32_16x16x32_bf16 v[156:159], a[188:191], a[164:167], v[156:159]
    v_mfma_f32_16x16x32_bf16 v[160:163], a[176:179], a[168:171], v[160:163]
    v_mfma_f32_16x16x32_bf16 v[164:167], a[180:183], a[168:171], v[164:167]
    v_mfma_f32_16x16x32_bf16 v[168:171], a[184:187], a[168:171], v[168:171]
    v_mfma_f32_16x16x32_bf16 v[172:175], a[188:191], a[168:171], v[172:175]
    v_mfma_f32_16x16x32_bf16 v[176:179], a[176:179], a[172:175], v[176:179]
    v_mfma_f32_16x16x32_bf16 v[180:183], a[180:183], a[172:175], v[180:183]
    v_mfma_f32_16x16x32_bf16 v[184:187], a[184:187], a[172:175], v[184:187]
    v_mfma_f32_16x16x32_bf16 v[188:191], a[188:191], a[172:175], v[188:191]
    buffer_load_dwordx4 a[160:163], v7, s[12:15], s24 offen
    buffer_load_dwordx4 a[164:167], v7, s[12:15], s25 offen
    buffer_load_dwordx4 a[168:171], v7, s[12:15], s26 offen
    buffer_load_dwordx4 a[172:175], v7, s[12:15], s27 offen
    buffer_load_dwordx4 a[176:179], v6, s[12:15], s28 offen offset:0
    buffer_load_dwordx4 a[180:183], v6, s[12:15], s28 offen offset:1024
    buffer_load_dwordx4 a[184:187], v6, s[12:15], s28 offen offset:2048
    buffer_load_dwordx4 a[188:191], v6, s[12:15], s28 offen offset:3072
    v_add_u32 v7, 1024, v7
    s_add_u32 s28, s28, 32768
    s_waitcnt vmcnt(56)
    v_mfma_f32_16x16x32_bf16 v[128:131], a[208:211], a[192:195], v[128:131]
    v_mfma_f32_16x16x32_bf16 v[132:135], a[212:215], a[192:195], v[132:135]
    v_mfma_f32_16x16x32_bf16 v[136:139], a[216:219], a[192:195], v[136:139]
    v_mfma_f32_16x16x32_bf16 v[140:143], a[220:223], a[192:195], v[140:143]
    v_mfma_f32_16x16x32_bf16 v[144:147], a[208:211], a[196:199], v[144:147]
    v_mfma_f32_16x16x32_bf16 v[148:151], a[212:215], a[196:199], v[148:151]
    v_mfma_f32_16x16x32_bf16 v[152:155], a[216:219], a[196:199], v[152:155]
    v_mfma_f32_16x16x32_bf16 v[156:159], a[220:223], a[196:199], v[156:159]
    v_mfma_f32_16x16x32_bf16 v[160:163], a[208:211], a[200:203], v[160:163]
    v_mfma_f32_16x16x32_bf16 v[164:167], a[212:215], a[200:203], v[164:167]
    v_mfma_f32_16x16x32_bf16 v[168:171], a[216:219], a[200:203], v[168:171]
    v_mfma_f32_16x16x32_bf16 v[172:175], a[220:223], a[200:203], v[172:175]
    v_mfma_f32_16x16x32_bf16 v[176:179], a[208:211], a[204:207], v[176:179]
    v_mfma_f32_16x16x32_bf16 v[180:183], a[212:215], a[204:207], v[180:183]
    v_mfma_f32_16x16x32_bf16 v[184:187], a[216:219], a[204:207], v[184:187]
    v_mfma_f32_16x16x32_bf16 v[188:191], a[220:223], a[204:207], v[188:191]
    buffer_load_dwordx4 a[192:195], v7, s[12:15], s24 offen
    buffer_load_dwordx4 a[196:199], v7, s[12:15], s25 offen
    buffer_load_dwordx4 a[200:203], v7, s[12:15], s26 offen
    buffer_load_dwordx4 a[204:207], v7, s[12:15], s27 offen
    buffer_load_dwordx4 a[208:211], v6, s[12:15], s28 offen offset:0
    buffer_load_dwordx4 a[212:215], v6, s[12:15], s28 offen offset:1024
    buffer_load_dwordx4 a[216:219], v6, s[12:15], s28 offen offset:2048
    buffer_load_dwordx4 a[220:223], v6, s[12:15], s28 offen offset:3072
    v_add_u32 v7, 1024, v7
    s_add_u32 s28, s28, 32768
    s_waitcnt vmcnt(56)
    v_mfma_f32_16x16x32_bf16 v[128:131], a[240:243], a[224:227], v[128:131]
    v_mfma_f32_16x16x32_bf16 v[132:135], a[244:247], a[224:227], v[132:135]
    v_mfma_f32_16x16x32_bf16 v[136:139], a[248:251], a[224:227], v[136:139]
    v_mfma_f32_16x16x32_bf16 v[140:143], a[252:255], a[224:227], v[140:143]
    v_mfma_f32_16x16x32_bf16 v[144:147], a[240:243], a[228:231], v[144:147]
    v_mfma_f32_16x16x32_bf16 v[148:151], a[244:247], a[228:231], v[148:151]
    v_mfma_f32_16x16x32_bf16 v[152:155], a[248:251], a[228:231], v[152:155]
    v_mfma_f32_16x16x32_bf16 v[156:159], a[252:255], a[228:231], v[156:159]
    v_mfma_f32_16x16x32_bf16 v[160:163], a[240:243], a[232:235], v[160:163]
    v_mfma_f32_16x16x32_bf16 v[164:167], a[244:247], a[232:235], v[164:167]
    v_mfma_f32_16x16x32_bf16 v[168:171], a[248:251], a[232:235], v[168:171]
    v_mfma_f32_16x16x32_bf16 v[172:175], a[252:255], a[232:235], v[172:175]
    v_mfma_f32_16x16x32_bf16 v[176:179], a[240:243], a[236:239], v[176:179]
    v_mfma_f32_16x16x32_bf16 v[180:183], a[244:247], a[236:239], v[180:183]
    v_mfma_f32_16x16x32_bf16 v[184:187], a[248:251], a[236:239], v[184:187]
    v_mfma_f32_16x16x32_bf16 v[188:191], a[252:255], a[236:239], v[188:191]
    buffer_load_dwordx4 a[224:227], v7, s[12:15], s24 offen
    buffer_load_dwordx4 a[228:231], v7, s[12:15], s25 offen
    buffer_load_dwordx4 a[232:235], v7, s[12:15], s26 offen
    buffer_load_dwordx4 a[236:239], v7, s[12:15], s27 offen
    buffer_load_dwordx4 a[240:243], v6, s[12:15], s28 offen offset:0
    buffer_load_dwordx4 a[244:247], v6, s[12:15], s28 offen offset:1024
    buffer_load_dwordx4 a[248:251], v6, s[12:15], s28 offen offset:2048
    buffer_load_dwordx4 a[252:255], v6, s[12:15], s28 offen offset:3072
    v_add_u32 v7, 1024, v7
    s_add_u32 s28, s28, 32768
    s_waitcnt vmcnt(56)
    v_mfma_f32_16x16x32_bf16 v[128:131], a[16:19], a[0:3], v[128:131]
    v_mfma_f32_16x16x32_bf16 v[132:135], a[20:23], a[0:3], v[132:135]
    v_mfma_f32_16x16x32_bf16 v[136:139], a[24:27], a[0:3], v[136:139]
    v_mfma_f32_16x16x32_bf16 v[140:143], a[28:31], a[0:3], v[140:143]
    v_mfma_f32_16x16x32_bf16 v[144:147], a[16:19], a[4:7], v[144:147]
    v_mfma_f32_16x16x32_bf16 v[148:151], a[20:23], a[4:7], v[148:151]
    v_mfma_f32_16x16x32_bf16 v[152:155], a[24:27], a[4:7], v[152:155]
    v_mfma_f32_16x16x32_bf16 v[156:159], a[28:31], a[4:7], v[156:159]
    v_mfma_f32_16x16x32_bf16 v[160:163], a[16:19], a[8:11], v[160:163]
    v_mfma_f32_16x16x32_bf16 v[164:167], a[20:23], a[8:11], v[164:167]
    v_mfma_f32_16x16x32_bf16 v[168:171], a[24:27], a[8:11], v[168:171]
    v_mfma_f32_16x16x32_bf16 v[172:175], a[28:31], a[8:11], v[172:175]
    v_mfma_f32_16x16x32_bf16 v[176:179], a[16:19], a[12:15], v[176:179]
    v_mfma_f32_16x16x32_bf16 v[180:183], a[20:23], a[12:15], v[180:183]
    v_mfma_f32_16x16x32_bf16 v[184:187], a[24:27], a[12:15], v[184:187]
    v_mfma_f32_16x16x32_bf16 v[188:191], a[28:31], a[12:15], v[188:191]
    buffer_load_dwordx4 a[0:3], v7, s[12:15], s24 offen
    buffer_load_dwordx4 a[4:7], v7, s[12:15], s25 offen
    buffer_load_dwordx4 a[8:11], v7, s[12:15], s26 offen
    buffer_load_dwordx4 a[12:15], v7, s[12:15], s27 offen
    buffer_load_dwordx4 a[16:19], v6, s[12:15], s28 offen offset:0
    buffer_load_dwordx4 a[20:23], v6, s[12:15], s28 offen offset:1024
    buffer_load_dwordx4 a[24:27], v6, s[12:15], s28 offen offset:2048
    buffer_load_dwordx4 a[28:31], v6, s[12:15], s28 offen offset:3072
    v_add_u32 v7, 1024, v7
    s_add_u32 s28, s28, 32768
    s_waitcnt vmcnt(56)
    v_mfma_f32_16x16x32_bf16 v[128:131], a[48:51], a[32:35], v[128:131]
    v_mfma_f32_16x16x32_bf16 v[132:135], a[52:55], a[32:35], v[132:135]
    v_mfma_f32_16x16x32_bf16 v[136:139], a[56:59], a[32:35], v[136:139]
    v_mfma_f32_16x16x32_bf16 v[140:143], a[60:63], a[32:35], v[140:143]
    v_mfma_f32_16x16x32_bf16 v[144:147], a[48:51], a[36:39], v[144:147]
    v_mfma_f32_16x16x32_bf16 v[148:151], a[52:55], a[36:39], v[148:151]
    v_mfma_f32_16x16x32_bf16 v[152:155], a[56:59], a[36:39], v[152:155]
    v_mfma_f32_16x16x32_bf16 v[156:159], a[60:63], a[36:39], v[156:159]
    v_mfma_f32_16x16x32_bf16 v[160:163], a[48:51], a[40:43], v[160:163]
    v_mfma_f32_16x16x32_bf16 v[164:167], a[52:55], a[40:43], v[164:167]
    v_mfma_f32_16x16x32_bf16 v[168:171], a[56:59], a[40:43], v[168:171]
    v_mfma_f32_16x16x32_bf16 v[172:175], a[60:63], a[40:43], v[172:175]
    v_mfma_f32_16x16x32_bf16 v[176:179], a[48:51], a[44:47], v[176:179]
    v_mfma_f32_16x16x32_bf16 v[180:183], a[52:55], a[44:47], v[180:183]
    v_mfma_f32_16x16x32_bf16 v[184:187], a[56:59], a[44:47], v[184:187]
    v_mfma_f32_16x16x32_bf16 v[188:191], a[60:63], a[44:47], v[188:191]
    buffer_load_dwordx4 a[32:35], v7, s[12:15], s24 offen
    buffer_load_dwordx4 a[36:39], v7, s[12:15], s25 offen
    buffer_load_dwordx4 a[40:43], v7, s[12:15], s26 offen
    buffer_load_dwordx4 a[44:47], v7, s[12:15], s27 offen
    buffer_load_dwordx4 a[48:51], v6, s[12:15], s28 offen offset:0
    buffer_load_dwordx4 a[52:55], v6, s[12:15], s28 offen offset:1024
    buffer_load_dwordx4 a[56:59], v6, s[12:15], s28 offen offset:2048
    buffer_load_dwordx4 a[60:63], v6, s[12:15], s28 offen offset:3072
    v_add_u32 v7, 1024, v7
    s_add_u32 s28, s28, 32768
    s_waitcnt vmcnt(56)
    v_mfma_f32_16x16x32_bf16 v[128:131], a[80:83], a[64:67], v[128:131]
    v_mfma_f32_16x16x32_bf16 v[132:135], a[84:87], a[64:67], v[132:135]
    v_mfma_f32_16x16x32_bf16 v[136:139], a[88:91], a[64:67], v[136:139]
    v_mfma_f32_16x16x32_bf16 v[140:143], a[92:95], a[64:67], v[140:143]
    v_mfma_f32_16x16x32_bf16 v[144:147], a[80:83], a[68:71], v[144:147]
    v_mfma_f32_16x16x32_bf16 v[148:151], a[84:87], a[68:71], v[148:151]
    v_mfma_f32_16x16x32_bf16 v[152:155], a[88:91], a[68:71], v[152:155]
    v_mfma_f32_16x16x32_bf16 v[156:159], a[92:95], a[68:71], v[156:159]
    v_mfma_f32_16x16x32_bf16 v[160:163], a[80:83], a[72:75], v[160:163]
    v_mfma_f32_16x16x32_bf16 v[164:167], a[84:87], a[72:75], v[164:167]
    v_mfma_f32_16x16x32_bf16 v[168:171], a[88:91], a[72:75], v[168:171]
    v_mfma_f32_16x16x32_bf16 v[172:175], a[92:95], a[72:75], v[172:175]
    v_mfma_f32_16x16x32_bf16 v[176:179], a[80:83], a[76:79], v[176:179]
    v_mfma_f32_16x16x32_bf16 v[180:183], a[84:87], a[76:79], v[180:183]
    v_mfma_f32_16x16x32_bf16 v[184:187], a[88:91], a[76:79], v[184:187]
    v_mfma_f32_16x16x32_bf16 v[188:191], a[92:95], a[76:79], v[188:191]
    buffer_load_dwordx4 a[64:67], v7, s[12:15], s24 offen
    buffer_load_dwordx4 a[68:71], v7, s[12:15], s25 offen
    buffer_load_dwordx4 a[72:75], v7, s[12:15], s26 offen
    buffer_load_dwordx4 a[76:79], v7, s[12:15], s27 offen
    buffer_load_dwordx4 a[80:83], v6, s[12:15], s28 offen offset:0
    buffer_load_dwordx4 a[84:87], v6, s[12:15], s28 offen offset:1024
    buffer_load_dwordx4 a[88:91], v6, s[12:15], s28 offen offset:2048
    buffer_load_dwordx4 a[92:95], v6, s[12:15], s28 offen offset:3072
    v_add_u32 v7, 1024, v7
    s_add_u32 s28, s28, 32768
    s_waitcnt vmcnt(56)
    v_mfma_f32_16x16x32_bf16 v[128:131], a[112:115], a[96:99], v[128:131]
    v_mfma_f32_16x16x32_bf16 v[132:135], a[116:119], a[96:99], v[132:135]
    v_mfma_f32_16x16x32_bf16 v[136:139], a[120:123], a[96:99], v[136:139]
    v_mfma_f32_16x16x32_bf16 v[140:143], a[124:127], a[96:99], v[140:143]
    v_mfma_f32_16x16x32_bf16 v[144:147], a[112:115], a[100:103], v[144:147]
    v_mfma_f32_16x16x32_bf16 v[148:151], a[116:119], a[100:103], v[148:151]
    v_mfma_f32_16x16x32_bf16 v[152:155], a[120:123], a[100:103], v[152:155]
    v_mfma_f32_16x16x32_bf16 v[156:159], a[124:127], a[100:103], v[156:159]
    v_mfma_f32_16x16x32_bf16 v[160:163], a[112:115], a[104:107], v[160:163]
    v_mfma_f32_16x16x32_bf16 v[164:167], a[116:119], a[104:107], v[164:167]
    v_mfma_f32_16x16x32_bf16 v[168:171], a[120:123], a[104:107], v[168:171]
    v_mfma_f32_16x16x32_bf16 v[172:175], a[124:127], a[104:107], v[172:175]
    v_mfma_f32_16x16x32_bf16 v[176:179], a[112:115], a[108:111], v[176:179]
    v_mfma_f32_16x16x32_bf16 v[180:183], a[116:119], a[108:111], v[180:183]
    v_mfma_f32_16x16x32_bf16 v[184:187], a[120:123], a[108:111], v[184:187]
    v_mfma_f32_16x16x32_bf16 v[188:191], a[124:127], a[108:111], v[188:191]
    buffer_load_dwordx4 a[96:99], v7, s[12:15], s24 offen
    buffer_load_dwordx4 a[100:103], v7, s[12:15], s25 offen
    buffer_load_dwordx4 a[104:107], v7, s[12:15], s26 offen
    buffer_load_dwordx4 a[108:111], v7, s[12:15], s27 offen
    buffer_load_dwordx4 a[112:115], v6, s[12:15], s28 offen offset:0
    buffer_load_dwordx4 a[116:119], v6, s[12:15], s28 offen offset:1024
    buffer_load_dwordx4 a[120:123], v6, s[12:15], s28 offen offset:2048
    buffer_load_dwordx4 a[124:127], v6, s[12:15], s28 offen offset:3072
    v_add_u32 v7, 1024, v7
    s_add_u32 s28, s28, 32768
    s_waitcnt vmcnt(56)
    v_mfma_f32_16x16x32_bf16 v[128:131], a[144:147], a[128:131], v[128:131]
    v_mfma_f32_16x16x32_bf16 v[132:135], a[148:151], a[128:131], v[132:135]
    v_mfma_f32_16x16x32_bf16 v[136:139], a[152:155], a[128:131], v[136:139]
    v_mfma_f32_16x16x32_bf16 v[140:143], a[156:159], a[128:131], v[140:143]
    v_mfma_f32_16x16x32_bf16 v[144:147], a[144:147], a[132:135], v[144:147]
    v_mfma_f32_16x16x32_bf16 v[148:151], a[148:151], a[132:135], v[148:151]
    v_mfma_f32_16x16x32_bf16 v[152:155], a[152:155], a[132:135], v[152:155]
    v_mfma_f32_16x16x32_bf16 v[156:159], a[156:159], a[132:135], v[156:159]
    v_mfma_f32_16x16x32_bf16 v[160:163], a[144:147], a[136:139], v[160:163]
    v_mfma_f32_16x16x32_bf16 v[164:167], a[148:151], a[136:139], v[164:167]
    v_mfma_f32_16x16x32_bf16 v[168:171], a[152:155], a[136:139], v[168:171]
    v_mfma_f32_16x16x32_bf16 v[172:175], a[156:159], a[136:139], v[172:175]
    v_mfma_f32_16x16x32_bf16 v[176:179], a[144:147], a[140:143], v[176:179]
    v_mfma_f32_16x16x32_bf16 v[180:183], a[148:151], a[140:143], v[180:183]
    v_mfma_f32_16x16x32_bf16 v[184:187], a[152:155], a[140:143], v[184:187]
    v_mfma_f32_16x16x32_bf16 v[188:191], a[156:159], a[140:143], v[188:191]
    buffer_load_dwordx4 a[128:131], v7, s[12:15], s24 offen
    buffer_load_dwordx4 a[132:135], v7, s[12:15], s25 offen
    buffer_load_dwordx4 a[136:139], v7, s[12:15], s26 offen
    buffer_load_dwordx4 a[140:143], v7, s[12:15], s27 offen
    buffer_load_dwordx4 a[144:147], v6, s[12:15], s28 offen offset:0
    buffer_load_dwordx4 a[148:151], v6, s[12:15], s28 offen offset:1024
    buffer_load_dwordx4 a[152:155], v6, s[12:15], s28 offen offset:2048
    buffer_load_dwordx4 a[156:159], v6, s[12:15], s28 offen offset:3072
    v_add_u32 v7, 1024, v7
    s_add_u32 s28, s28, 32768
    s_waitcnt vmcnt(56)
    v_mfma_f32_16x16x32_bf16 v[128:131], a[176:179], a[160:163], v[128:131]
    v_mfma_f32_16x16x32_bf16 v[132:135], a[180:183], a[160:163], v[132:135]
    v_mfma_f32_16x16x32_bf16 v[136:139], a[184:187], a[160:163], v[136:139]
    v_mfma_f32_16x16x32_bf16 v[140:143], a[188:191], a[160:163], v[140:143]
    v_mfma_f32_16x16x32_bf16 v[144:147], a[176:179], a[164:167], v[144:147]
    v_mfma_f32_16x16x32_bf16 v[148:151], a[180:183], a[164:167], v[148:151]
    v_mfma_f32_16x16x32_bf16 v[152:155], a[184:187], a[164:167], v[152:155]
    v_mfma_f32_16x16x32_bf16 v[156:159], a[188:191], a[164:167], v[156:159]
    v_mfma_f32_16x16x32_bf16 v[160:163], a[176:179], a[168:171], v[160:163]
    v_mfma_f32_16x16x32_bf16 v[164:167], a[180:183], a[168:171], v[164:167]
    v_mfma_f32_16x16x32_bf16 v[168:171], a[184:187], a[168:171], v[168:171]
    v_mfma_f32_16x16x32_bf16 v[172:175], a[188:191], a[168:171], v[172:175]
    v_mfma_f32_16x16x32_bf16 v[176:179], a[176:179], a[172:175], v[176:179]
    v_mfma_f32_16x16x32_bf16 v[180:183], a[180:183], a[172:175], v[180:183]
    v_mfma_f32_16x16x32_bf16 v[184:187], a[184:187], a[172:175], v[184:187]
    v_mfma_f32_16x16x32_bf16 v[188:191], a[188:191], a[172:175], v[188:191]
    buffer_load_dwordx4 a[160:163], v7, s[12:15], s24 offen
    buffer_load_dwordx4 a[164:167], v7, s[12:15], s25 offen
    buffer_load_dwordx4 a[168:171], v7, s[12:15], s26 offen
    buffer_load_dwordx4 a[172:175], v7, s[12:15], s27 offen
    buffer_load_dwordx4 a[176:179], v6, s[12:15], s28 offen offset:0
    buffer_load_dwordx4 a[180:183], v6, s[12:15], s28 offen offset:1024
    buffer_load_dwordx4 a[184:187], v6, s[12:15], s28 offen offset:2048
    buffer_load_dwordx4 a[188:191], v6, s[12:15], s28 offen offset:3072
    v_add_u32 v7, 1024, v7
    s_add_u32 s28, s28, 32768
    s_waitcnt vmcnt(56)
    v_mfma_f32_16x16x32_bf16 v[128:131], a[208:211], a[192:195], v[128:131]
    v_mfma_f32_16x16x32_bf16 v[132:135], a[212:215], a[192:195], v[132:135]
    v_mfma_f32_16x16x32_bf16 v[136:139], a[216:219], a[192:195], v[136:139]
    v_mfma_f32_16x16x32_bf16 v[140:143], a[220:223], a[192:195], v[140:143]
    v_mfma_f32_16x16x32_bf16 v[144:147], a[208:211], a[196:199], v[144:147]
    v_mfma_f32_16x16x32_bf16 v[148:151], a[212:215], a[196:199], v[148:151]
    v_mfma_f32_16x16x32_bf16 v[152:155], a[216:219], a[196:199], v[152:155]
    v_mfma_f32_16x16x32_bf16 v[156:159], a[220:223], a[196:199], v[156:159]
    v_mfma_f32_16x16x32_bf16 v[160:163], a[208:211], a[200:203], v[160:163]
    v_mfma_f32_16x16x32_bf16 v[164:167], a[212:215], a[200:203], v[164:167]
    v_mfma_f32_16x16x32_bf16 v[168:171], a[216:219], a[200:203], v[168:171]
    v_mfma_f32_16x16x32_bf16 v[172:175], a[220:223], a[200:203], v[172:175]
    v_mfma_f32_16x16x32_bf16 v[176:179], a[208:211], a[204:207], v[176:179]
    v_mfma_f32_16x16x32_bf16 v[180:183], a[212:215], a[204:207], v[180:183]
    v_mfma_f32_16x16x32_bf16 v[184:187], a[216:219], a[204:207], v[184:187]
    v_mfma_f32_16x16x32_bf16 v[188:191], a[220:223], a[204:207], v[188:191]
    buffer_load_dwordx4 a[192:195], v7, s[12:15], s24 offen
    buffer_load_dwordx4 a[196:199], v7, s[12:15], s25 offen
    buffer_load_dwordx4 a[200:203], v7, s[12:15], s26 offen
    buffer_load_dwordx4 a[204:207], v7, s[12:15], s27 offen
    buffer_load_dwordx4 a[208:211], v6, s[12:15], s28 offen offset:0
    buffer_load_dwordx4 a[212:215], v6, s[12:15], s28 offen offset:1024
    buffer_load_dwordx4 a[216:219], v6, s[12:15], s28 offen offset:2048
    buffer_load_dwordx4 a[220:223], v6, s[12:15], s28 offen offset:3072
    v_add_u32 v7, 1024, v7
    s_add_u32 s28, s28, 32768
    s_waitcnt vmcnt(56)
    v_mfma_f32_16x16x32_bf16 v[128:131], a[240:243], a[224:227], v[128:131]
    v_mfma_f32_16x16x32_bf16 v[132:135], a[244:247], a[224:227], v[132:135]
    v_mfma_f32_16x16x32_bf16 v[136:139], a[248:251], a[224:227], v[136:139]
    v_mfma_f32_16x16x32_bf16 v[140:143], a[252:255], a[224:227], v[140:143]
    v_mfma_f32_16x16x32_bf16 v[144:147], a[240:243], a[228:231], v[144:147]
    v_mfma_f32_16x16x32_bf16 v[148:151], a[244:247], a[228:231], v[148:151]
    v_mfma_f32_16x16x32_bf16 v[152:155], a[248:251], a[228:231], v[152:155]
    v_mfma_f32_16x16x32_bf16 v[156:159], a[252:255], a[228:231], v[156:159]
    v_mfma_f32_16x16x32_bf16 v[160:163], a[240:243], a[232:235], v[160:163]
    v_mfma_f32_16x16x32_bf16 v[164:167], a[244:247], a[232:235], v[164:167]
    v_mfma_f32_16x16x32_bf16 v[168:171], a[248:251], a[232:235], v[168:171]
    v_mfma_f32_16x16x32_bf16 v[172:175], a[252:255], a[232:235], v[172:175]
    v_mfma_f32_16x16x32_bf16 v[176:179], a[240:243], a[236:239], v[176:179]
    v_mfma_f32_16x16x32_bf16 v[180:183], a[244:247], a[236:239], v[180:183]
    v_mfma_f32_16x16x32_bf16 v[184:187], a[248:251], a[236:239], v[184:187]
    v_mfma_f32_16x16x32_bf16 v[188:191], a[252:255], a[236:239], v[188:191]
    buffer_load_dwordx4 a[224:227], v7, s[12:15], s24 offen
    buffer_load_dwordx4 a[228:231], v7, s[12:15], s25 offen
    buffer_load_dwordx4 a[232:235], v7, s[12:15], s26 offen
    buffer_load_dwordx4 a[236:239], v7, s[12:15], s27 offen
    buffer_load_dwordx4 a[240:243], v6, s[12:15], s28 offen offset:0
    buffer_load_dwordx4 a[244:247], v6, s[12:15], s28 offen offset:1024
    buffer_load_dwordx4 a[248:251], v6, s[12:15], s28 offen offset:2048
    buffer_load_dwordx4 a[252:255], v6, s[12:15], s28 offen offset:3072
    v_add_u32 v7, 1024, v7
    s_add_u32 s28, s28, 32768
    s_waitcnt vmcnt(56)
    v_mfma_f32_16x16x32_bf16 v[128:131], a[16:19], a[0:3], v[128:131]
    v_mfma_f32_16x16x32_bf16 v[132:135], a[20:23], a[0:3], v[132:135]
    v_mfma_f32_16x16x32_bf16 v[136:139], a[24:27], a[0:3], v[136:139]
    v_mfma_f32_16x16x32_bf16 v[140:143], a[28:31], a[0:3], v[140:143]
    v_mfma_f32_16x16x32_bf16 v[144:147], a[16:19], a[4:7], v[144:147]
    v_mfma_f32_16x16x32_bf16 v[148:151], a[20:23], a[4:7], v[148:151]
    v_mfma_f32_16x16x32_bf16 v[152:155], a[24:27], a[4:7], v[152:155]
    v_mfma_f32_16x16x32_bf16 v[156:159], a[28:31], a[4:7], v[156:159]
    v_mfma_f32_16x16x32_bf16 v[160:163], a[16:19], a[8:11], v[160:163]
    v_mfma_f32_16x16x32_bf16 v[164:167], a[20:23], a[8:11], v[164:167]
    v_mfma_f32_16x16x32_bf16 v[168:171], a[24:27], a[8:11], v[168:171]
    v_mfma_f32_16x16x32_bf16 v[172:175], a[28:31], a[8:11], v[172:175]
    v_mfma_f32_16x16x32_bf16 v[176:179], a[16:19], a[12:15], v[176:179]
    v_mfma_f32_16x16x32_bf16 v[180:183], a[20:23], a[12:15], v[180:183]
    v_mfma_f32_16x16x32_bf16 v[184:187], a[24:27], a[12:15], v[184:187]
    v_mfma_f32_16x16x32_bf16 v[188:191], a[28:31], a[12:15], v[188:191]
    s_waitcnt vmcnt(48)
    v_mfma_f32_16x16x32_bf16 v[128:131], a[48:51], a[32:35], v[128:131]
    v_mfma_f32_16x16x32_bf16 v[132:135], a[52:55], a[32:35], v[132:135]
    v_mfma_f32_16x16x32_bf16 v[136:139], a[56:59], a[32:35], v[136:139]
    v_mfma_f32_16x16x32_bf16 v[140:143], a[60:63], a[32:35], v[140:143]
    v_mfma_f32_16x16x32_bf16 v[144:147], a[48:51], a[36:39], v[144:147]
    v_mfma_f32_16x16x32_bf16 v[148:151], a[52:55], a[36:39], v[148:151]
    v_mfma_f32_16x16x32_bf16 v[152:155], a[56:59], a[36:39], v[152:155]
    v_mfma_f32_16x16x32_bf16 v[156:159], a[60:63], a[36:39], v[156:159]
    v_mfma_f32_16x16x32_bf16 v[160:163], a[48:51], a[40:43], v[160:163]
    v_mfma_f32_16x16x32_bf16 v[164:167], a[52:55], a[40:43], v[164:167]
    v_mfma_f32_16x16x32_bf16 v[168:171], a[56:59], a[40:43], v[168:171]
    v_mfma_f32_16x16x32_bf16 v[172:175], a[60:63], a[40:43], v[172:175]
    v_mfma_f32_16x16x32_bf16 v[176:179], a[48:51], a[44:47], v[176:179]
    v_mfma_f32_16x16x32_bf16 v[180:183], a[52:55], a[44:47], v[180:183]
    v_mfma_f32_16x16x32_bf16 v[184:187], a[56:59], a[44:47], v[184:187]
    v_mfma_f32_16x16x32_bf16 v[188:191], a[60:63], a[44:47], v[188:191]
    s_waitcnt vmcnt(40)
    v_mfma_f32_16x16x32_bf16 v[128:131], a[80:83], a[64:67], v[128:131]
    v_mfma_f32_16x16x32_bf16 v[132:135], a[84:87], a[64:67], v[132:135]
    v_mfma_f32_16x16x32_bf16 v[136:139], a[88:91], a[64:67], v[136:139]
    v_mfma_f32_16x16x32_bf16 v[140:143], a[92:95], a[64:67], v[140:143]
    v_mfma_f32_16x16x32_bf16 v[144:147], a[80:83], a[68:71], v[144:147]
    v_mfma_f32_16x16x32_bf16 v[148:151], a[84:87], a[68:71], v[148:151]
    v_mfma_f32_16x16x32_bf16 v[152:155], a[88:91], a[68:71], v[152:155]
    v_mfma_f32_16x16x32_bf16 v[156:159], a[92:95], a[68:71], v[156:159]
    v_mfma_f32_16x16x32_bf16 v[160:163], a[80:83], a[72:75], v[160:163]
    v_mfma_f32_16x16x32_bf16 v[164:167], a[84:87], a[72:75], v[164:167]
    v_mfma_f32_16x16x32_bf16 v[168:171], a[88:91], a[72:75], v[168:171]
    v_mfma_f32_16x16x32_bf16 v[172:175], a[92:95], a[72:75], v[172:175]
    v_mfma_f32_16x16x32_bf16 v[176:179], a[80:83], a[76:79], v[176:179]
    v_mfma_f32_16x16x32_bf16 v[180:183], a[84:87], a[76:79], v[180:183]
    v_mfma_f32_16x16x32_bf16 v[184:187], a[88:91], a[76:79], v[184:187]
    v_mfma_f32_16x16x32_bf16 v[188:191], a[92:95], a[76:79], v[188:191]
    s_waitcnt vmcnt(32)
    v_mfma_f32_16x16x32_bf16 v[128:131], a[112:115], a[96:99], v[128:131]
    v_mfma_f32_16x16x32_bf16 v[132:135], a[116:119], a[96:99], v[132:135]
    v_mfma_f32_16x16x32_bf16 v[136:139], a[120:123], a[96:99], v[136:139]
    v_mfma_f32_16x16x32_bf16 v[140:143], a[124:127], a[96:99], v[140:143]
    v_mfma_f32_16x16x32_bf16 v[144:147], a[112:115], a[100:103], v[144:147]
    v_mfma_f32_16x16x32_bf16 v[148:151], a[116:119], a[100:103], v[148:151]
    v_mfma_f32_16x16x32_bf16 v[152:155], a[120:123], a[100:103], v[152:155]
    v_mfma_f32_16x16x32_bf16 v[156:159], a[124:127], a[100:103], v[156:159]
    v_mfma_f32_16x16x32_bf16 v[160:163], a[112:115], a[104:107], v[160:163]
    v_mfma_f32_16x16x32_bf16 v[164:167], a[116:119], a[104:107], v[164:167]
    v_mfma_f32_16x16x32_bf16 v[168:171], a[120:123], a[104:107], v[168:171]
    v_mfma_f32_16x16x32_bf16 v[172:175], a[124:127], a[104:107], v[172:175]
    v_mfma_f32_16x16x32_bf16 v[176:179], a[112:115], a[108:111], v[176:179]
    v_mfma_f32_16x16x32_bf16 v[180:183], a[116:119], a[108:111], v[180:183]
    v_mfma_f32_16x16x32_bf16 v[184:187], a[120:123], a[108:111], v[184:187]
    v_mfma_f32_16x16x32_bf16 v[188:191], a[124:127], a[108:111], v[188:191]
    s_waitcnt vmcnt(24)
    v_mfma_f32_16x16x32_bf16 v[128:131], a[144:147], a[128:131], v[128:131]
    v_mfma_f32_16x16x32_bf16 v[132:135], a[148:151], a[128:131], v[132:135]
    v_mfma_f32_16x16x32_bf16 v[136:139], a[152:155], a[128:131], v[136:139]
    v_mfma_f32_16x16x32_bf16 v[140:143], a[156:159], a[128:131], v[140:143]
    v_mfma_f32_16x16x32_bf16 v[144:147], a[144:147], a[132:135], v[144:147]
    v_mfma_f32_16x16x32_bf16 v[148:151], a[148:151], a[132:135], v[148:151]
    v_mfma_f32_16x16x32_bf16 v[152:155], a[152:155], a[132:135], v[152:155]
    v_mfma_f32_16x16x32_bf16 v[156:159], a[156:159], a[132:135], v[156:159]
    v_mfma_f32_16x16x32_bf16 v[160:163], a[144:147], a[136:139], v[160:163]
    v_mfma_f32_16x16x32_bf16 v[164:167], a[148:151], a[136:139], v[164:167]
    v_mfma_f32_16x16x32_bf16 v[168:171], a[152:155], a[136:139], v[168:171]
    v_mfma_f32_16x16x32_bf16 v[172:175], a[156:159], a[136:139], v[172:175]
    v_mfma_f32_16x16x32_bf16 v[176:179], a[144:147], a[140:143], v[176:179]
    v_mfma_f32_16x16x32_bf16 v[180:183], a[148:151], a[140:143], v[180:183]
    v_mfma_f32_16x16x32_bf16 v[184:187], a[152:155], a[140:143], v[184:187]
    v_mfma_f32_16x16x32_bf16 v[188:191], a[156:159], a[140:143], v[188:191]
    s_waitcnt vmcnt(16)
    v_mfma_f32_16x16x32_bf16 v[128:131], a[176:179], a[160:163], v[128:131]
    v_mfma_f32_16x16x32_bf16 v[132:135], a[180:183], a[160:163], v[132:135]
    v_mfma_f32_16x16x32_bf16 v[136:139], a[184:187], a[160:163], v[136:139]
    v_mfma_f32_16x16x32_bf16 v[140:143], a[188:191], a[160:163], v[140:143]
    v_mfma_f32_16x16x32_bf16 v[144:147], a[176:179], a[164:167], v[144:147]
    v_mfma_f32_16x16x32_bf16 v[148:151], a[180:183], a[164:167], v[148:151]
    v_mfma_f32_16x16x32_bf16 v[152:155], a[184:187], a[164:167], v[152:155]
    v_mfma_f32_16x16x32_bf16 v[156:159], a[188:191], a[164:167], v[156:159]
    v_mfma_f32_16x16x32_bf16 v[160:163], a[176:179], a[168:171], v[160:163]
    v_mfma_f32_16x16x32_bf16 v[164:167], a[180:183], a[168:171], v[164:167]
    v_mfma_f32_16x16x32_bf16 v[168:171], a[184:187], a[168:171], v[168:171]
    v_mfma_f32_16x16x32_bf16 v[172:175], a[188:191], a[168:171], v[172:175]
    v_mfma_f32_16x16x32_bf16 v[176:179], a[176:179], a[172:175], v[176:179]
    v_mfma_f32_16x16x32_bf16 v[180:183], a[180:183], a[172:175], v[180:183]
    v_mfma_f32_16x16x32_bf16 v[184:187], a[184:187], a[172:175], v[184:187]
    v_mfma_f32_16x16x32_bf16 v[188:191], a[188:191], a[172:175], v[188:191]
    s_waitcnt vmcnt(8)
    v_mfma_f32_16x16x32_bf16 v[128:131], a[208:211], a[192:195], v[128:131]
    v_mfma_f32_16x16x32_bf16 v[132:135], a[212:215], a[192:195], v[132:135]
    v_mfma_f32_16x16x32_bf16 v[136:139], a[216:219], a[192:195], v[136:139]
    v_mfma_f32_16x16x32_bf16 v[140:143], a[220:223], a[192:195], v[140:143]
    v_mfma_f32_16x16x32_bf16 v[144:147], a[208:211], a[196:199], v[144:147]
    v_mfma_f32_16x16x32_bf16 v[148:151], a[212:215], a[196:199], v[148:151]
    v_mfma_f32_16x16x32_bf16 v[152:155], a[216:219], a[196:199], v[152:155]
    v_mfma_f32_16x16x32_bf16 v[156:159], a[220:223], a[196:199], v[156:159]
    v_mfma_f32_16x16x32_bf16 v[160:163], a[208:211], a[200:203], v[160:163]
    v_mfma_f32_16x16x32_bf16 v[164:167], a[212:215], a[200:203], v[164:167]
    v_mfma_f32_16x16x32_bf16 v[168:171], a[216:219], a[200:203], v[168:171]
    v_mfma_f32_16x16x32_bf16 v[172:175], a[220:223], a[200:203], v[172:175]
    v_mfma_f32_16x16x32_bf16 v[176:179], a[208:211], a[204:207], v[176:179]
    v_mfma_f32_16x16x32_bf16 v[180:183], a[212:215], a[204:207], v[180:183]
    v_mfma_f32_16x16x32_bf16 v[184:187], a[216:219], a[204:207], v[184:187]
    v_mfma_f32_16x16x32_bf16 v[188:191], a[220:223], a[204:207], v[188:191]
    s_waitcnt vmcnt(0)
    v_mfma_f32_16x16x32_bf16 v[128:131], a[240:243], a[224:227], v[128:131]
    v_mfma_f32_16x16x32_bf16 v[132:135], a[244:247], a[224:227], v[132:135]
    v_mfma_f32_16x16x32_bf16 v[136:139], a[248:251], a[224:227], v[136:139]
    v_mfma_f32_16x16x32_bf16 v[140:143], a[252:255], a[224:227], v[140:143]
    v_mfma_f32_16x16x32_bf16 v[144:147], a[240:243], a[228:231], v[144:147]
    v_mfma_f32_16x16x32_bf16 v[148:151], a[244:247], a[228:231], v[148:151]
    v_mfma_f32_16x16x32_bf16 v[152:155], a[248:251], a[228:231], v[152:155]
    v_mfma_f32_16x16x32_bf16 v[156:159], a[252:255], a[228:231], v[156:159]
    v_mfma_f32_16x16x32_bf16 v[160:163], a[240:243], a[232:235], v[160:163]
    v_mfma_f32_16x16x32_bf16 v[164:167], a[244:247], a[232:235], v[164:167]
    v_mfma_f32_16x16x32_bf16 v[168:171], a[248:251], a[232:235], v[168:171]
    v_mfma_f32_16x16x32_bf16 v[172:175], a[252:255], a[232:235], v[172:175]
    v_mfma_f32_16x16x32_bf16 v[176:179], a[240:243], a[236:239], v[176:179]
    v_mfma_f32_16x16x32_bf16 v[180:183], a[244:247], a[236:239], v[180:183]
    v_mfma_f32_16x16x32_bf16 v[184:187], a[248:251], a[236:239], v[184:187]
    v_mfma_f32_16x16x32_bf16 v[188:191], a[252:255], a[236:239], v[188:191]
    s_nop 7
    s_lshl_b32 s21, s3, 14
    v_add_u32 v8, s21, v6
    ds_write_b128 v8, v[128:131] offset:0
    ds_write_b128 v8, v[132:135] offset:1024
    ds_write_b128 v8, v[136:139] offset:2048
    ds_write_b128 v8, v[140:143] offset:3072
    ds_write_b128 v8, v[144:147] offset:4096
    ds_write_b128 v8, v[148:151] offset:5120
    ds_write_b128 v8, v[152:155] offset:6144
    ds_write_b128 v8, v[156:159] offset:7168
    ds_write_b128 v8, v[160:163] offset:8192
    ds_write_b128 v8, v[164:167] offset:9216
    ds_write_b128 v8, v[168:171] offset:10240
    ds_write_b128 v8, v[172:175] offset:11264
    ds_write_b128 v8, v[176:179] offset:12288
    ds_write_b128 v8, v[180:183] offset:13312
    ds_write_b128 v8, v[184:187] offset:14336
    ds_write_b128 v8, v[188:191] offset:15360
    s_waitcnt vmcnt(0) lgkmcnt(0)
    s_barrier
    s_lshl_b32 s21, s3, 12
    v_add_u32 v8, s21, v6
    ds_read_b128 v[32:35], v8 offset:0
    ds_read_b128 v[36:39], v8 offset:1024
    ds_read_b128 v[40:43], v8 offset:2048
    ds_read_b128 v[44:47], v8 offset:3072
    ds_read_b128 v[48:51], v8 offset:16384
    ds_read_b128 v[52:55], v8 offset:17408
    ds_read_b128 v[56:59], v8 offset:18432
    ds_read_b128 v[60:63], v8 offset:19456
    ds_read_b128 v[64:67], v8 offset:32768
    ds_read_b128 v[68:71], v8 offset:33792
    ds_read_b128 v[72:75], v8 offset:34816
    ds_read_b128 v[76:79], v8 offset:35840
    ds_read_b128 v[80:83], v8 offset:49152
    ds_read_b128 v[84:87], v8 offset:50176
    ds_read_b128 v[88:91], v8 offset:51200
    ds_read_b128 v[92:95], v8 offset:52224
    s_waitcnt lgkmcnt(0)
    v_add_f32 v32, v32, v48
    v_add_f32 v32, v32, v64
    v_add_f32 v32, v32, v80
    v_add_f32 v33, v33, v49
    v_add_f32 v33, v33, v65
    v_add_f32 v33, v33, v81
    v_add_f32 v34, v34, v50
    v_add_f32 v34, v34, v66
    v_add_f32 v34, v34, v82
    v_add_f32 v35, v35, v51
    v_add_f32 v35, v35, v67
    v_add_f32 v35, v35, v83
    v_add_f32 v36, v36, v52
    v_add_f32 v36, v36, v68
    v_add_f32 v36, v36, v84
    v_add_f32 v37, v37, v53
    v_add_f32 v37, v37, v69
    v_add_f32 v37, v37, v85
    v_add_f32 v38, v38, v54
    v_add_f32 v38, v38, v70
    v_add_f32 v38, v38, v86
    v_add_f32 v39, v39, v55
    v_add_f32 v39, v39, v71
    v_add_f32 v39, v39, v87
    v_add_f32 v40, v40, v56
    v_add_f32 v40, v40, v72
    v_add_f32 v40, v40, v88
    v_add_f32 v41, v41, v57
    v_add_f32 v41, v41, v73
    v_add_f32 v41, v41, v89
    v_add_f32 v42, v42, v58
    v_add_f32 v42, v42, v74
    v_add_f32 v42, v42, v90
    v_add_f32 v43, v43, v59
    v_add_f32 v43, v43, v75
    v_add_f32 v43, v43, v91
    v_add_f32 v44, v44, v60
    v_add_f32 v44, v44, v76
    v_add_f32 v44, v44, v92
    v_add_f32 v45, v45, v61
    v_add_f32 v45, v45, v77
    v_add_f32 v45, v45, v93
    v_add_f32 v46, v46, v62
    v_add_f32 v46, v46, v78
    v_add_f32 v46, v46, v94
    v_add_f32 v47, v47, v63
    v_add_f32 v47, v47, v79
    v_add_f32 v47, v47, v95
    s_lshl_b32 s21, s6, 6
    s_lshl_b32 s22, s3, 4
    s_add_u32 s21, s21, s22
    s_lshl_b32 s21, s21, 10
    s_lshl_b32 s22, s7, 7
    s_add_u32 s21, s21, s22
    v_lshlrev_b32 v9, 10, v3
    v_lshl_add_u32 v9, v4, 3, v9
    s_add_u32 s21, s21, 134217728
    v_cvt_pk_bf16_f32 v48, v32, v33
    v_cvt_pk_bf16_f32 v49, v34, v35
    buffer_store_dwordx2 v[48:49], v9, s[12:15], s21 offen offset:0
    v_cvt_pk_bf16_f32 v50, v36, v37
    v_cvt_pk_bf16_f32 v51, v38, v39
    buffer_store_dwordx2 v[50:51], v9, s[12:15], s21 offen offset:32
    v_cvt_pk_bf16_f32 v52, v40, v41
    v_cvt_pk_bf16_f32 v53, v42, v43
    buffer_store_dwordx2 v[52:53], v9, s[12:15], s21 offen offset:64
    v_cvt_pk_bf16_f32 v54, v44, v45
    v_cvt_pk_bf16_f32 v55, v46, v47
    buffer_store_dwordx2 v[54:55], v9, s[12:15], s21 offen offset:96
oproj_kernel_end:
    s_endpgm
.globl ln2_kernel
.p2align 8
.type ln2_kernel,@function
ln2_kernel:
    s_cmp_ge_u32 s2, 128
    s_cbranch_scc1 ln2_end
    s_load_dwordx2 s[4:5], s[0:1], 128
    s_load_dwordx2 s[6:7], s[0:1], 0
    v_lshrrev_b32 v1, 6, v0
    v_and_b32 v2, 63, v0
    s_nop 0
    v_readfirstlane_b32 s3, v1
    s_waitcnt lgkmcnt(0)
    s_mov_b32 s12, s4
    s_mov_b32 s13, s5
    s_and_b32 s13, s13, 0xffff
    s_mov_b32 s14, 268435455
    s_mov_b32 s15, 0x00020000
    s_mov_b32 s16, s6
    s_mov_b32 s17, s7
    s_and_b32 s17, s17, 0xffff
    s_mov_b32 s18, 2097152
    s_mov_b32 s19, 0x00020000
    v_lshlrev_b32 v5, 5, v2
    s_mov_b32 s20, 4096
    buffer_load_dwordx4 v[40:43], v5, s[12:15], s20 offen
    buffer_load_dwordx4 v[44:47], v5, s[12:15], s20 offen offset:16
    s_mov_b32 s20, 6144
    buffer_load_dwordx4 v[48:51], v5, s[12:15], s20 offen
    buffer_load_dwordx4 v[52:55], v5, s[12:15], s20 offen offset:16
    s_mov_b32 s20, 8192
    buffer_load_dwordx4 v[56:59], v5, s[12:15], s20 offen
    buffer_load_dwordx4 v[60:63], v5, s[12:15], s20 offen offset:16
    s_lshl_b32 s24, s2, 2
    s_add_u32 s24, s24, s3
    s_lshl_b32 s24, s24, 12
    s_add_u32 s25, s24, 134217728
    s_add_u32 s26, s24, 136314880
    s_lshr_b32 s27, s24, 14
    s_lshl_b32 s27, s27, 14
    s_bfe_u32 s28, s24, 0x4000a
    s_lshl_b32 s28, s28, 4
    s_add_u32 s27, s27, s28
    s_add_u32 s27, s27, 138412032
    v_lshrrev_b32 v6, 2, v2
    v_lshlrev_b32 v6, 10, v6
    v_and_b32 v7, 3, v2
    v_lshl_add_u32 v6, v7, 8, v6
    s_lshl_b32 s29, s3, 6
    v_add_u32 v6, s29, v6
    v_lshlrev_b32 v3, 4, v2
    buffer_load_dwordx4 v[64:67], v3, s[16:19], s24 offen offset:0
    buffer_load_dwordx4 v[68:71], v3, s[12:15], s25 offen offset:0
    buffer_load_dwordx4 v[72:75], v3, s[16:19], s24 offen offset:1024
    buffer_load_dwordx4 v[76:79], v3, s[12:15], s25 offen offset:1024
    buffer_load_dwordx4 v[80:83], v3, s[16:19], s24 offen offset:2048
    buffer_load_dwordx4 v[84:87], v3, s[12:15], s25 offen offset:2048
    buffer_load_dwordx4 v[88:91], v3, s[16:19], s24 offen offset:3072
    buffer_load_dwordx4 v[92:95], v3, s[12:15], s25 offen offset:3072
    s_waitcnt vmcnt(8)
    v_add_f32 v56, 1.0, v56
    v_add_f32 v57, 1.0, v57
    v_cvt_pk_bf16_f32 v12, v56, v57
    v_lshlrev_b32 v56, 16, v12
    v_and_b32 v57, 0xffff0000, v12
    v_add_f32 v58, 1.0, v58
    v_add_f32 v59, 1.0, v59
    v_cvt_pk_bf16_f32 v12, v58, v59
    v_lshlrev_b32 v58, 16, v12
    v_and_b32 v59, 0xffff0000, v12
    v_add_f32 v60, 1.0, v60
    v_add_f32 v61, 1.0, v61
    v_cvt_pk_bf16_f32 v12, v60, v61
    v_lshlrev_b32 v60, 16, v12
    v_and_b32 v61, 0xffff0000, v12
    v_add_f32 v62, 1.0, v62
    v_add_f32 v63, 1.0, v63
    v_cvt_pk_bf16_f32 v12, v62, v63
    v_lshlrev_b32 v62, 16, v12
    v_and_b32 v63, 0xffff0000, v12
    s_waitcnt vmcnt(6)
    v_lshlrev_b32 v16, 16, v64
    v_and_b32 v17, 0xffff0000, v64
    v_lshlrev_b32 v18, 16, v65
    v_and_b32 v19, 0xffff0000, v65
    v_lshlrev_b32 v20, 16, v66
    v_and_b32 v21, 0xffff0000, v66
    v_lshlrev_b32 v22, 16, v67
    v_and_b32 v23, 0xffff0000, v67
    v_lshlrev_b32 v24, 16, v68
    v_and_b32 v25, 0xffff0000, v68
    v_lshlrev_b32 v26, 16, v69
    v_and_b32 v27, 0xffff0000, v69
    v_lshlrev_b32 v28, 16, v70
    v_and_b32 v29, 0xffff0000, v70
    v_lshlrev_b32 v30, 16, v71
    v_and_b32 v31, 0xffff0000, v71
    v_mul_f32 v24, v24, v40
    v_mul_f32 v25, v25, v41
    v_cvt_pk_bf16_f32 v12, v24, v25
    v_lshlrev_b32 v24, 16, v12
    v_and_b32 v25, 0xffff0000, v12
    v_add_f32 v16, v16, v24
    v_add_f32 v17, v17, v25
    v_cvt_pk_bf16_f32 v12, v16, v17
    v_lshlrev_b32 v16, 16, v12
    v_and_b32 v17, 0xffff0000, v12
    v_mul_f32 v26, v26, v42
    v_mul_f32 v27, v27, v43
    v_cvt_pk_bf16_f32 v12, v26, v27
    v_lshlrev_b32 v26, 16, v12
    v_and_b32 v27, 0xffff0000, v12
    v_add_f32 v18, v18, v26
    v_add_f32 v19, v19, v27
    v_cvt_pk_bf16_f32 v12, v18, v19
    v_lshlrev_b32 v18, 16, v12
    v_and_b32 v19, 0xffff0000, v12
    v_mul_f32 v28, v28, v44
    v_mul_f32 v29, v29, v45
    v_cvt_pk_bf16_f32 v12, v28, v29
    v_lshlrev_b32 v28, 16, v12
    v_and_b32 v29, 0xffff0000, v12
    v_add_f32 v20, v20, v28
    v_add_f32 v21, v21, v29
    v_cvt_pk_bf16_f32 v12, v20, v21
    v_lshlrev_b32 v20, 16, v12
    v_and_b32 v21, 0xffff0000, v12
    v_mul_f32 v30, v30, v46
    v_mul_f32 v31, v31, v47
    v_cvt_pk_bf16_f32 v12, v30, v31
    v_lshlrev_b32 v30, 16, v12
    v_and_b32 v31, 0xffff0000, v12
    v_add_f32 v22, v22, v30
    v_add_f32 v23, v23, v31
    v_cvt_pk_bf16_f32 v12, v22, v23
    v_lshlrev_b32 v22, 16, v12
    v_and_b32 v23, 0xffff0000, v12
    v_cvt_pk_bf16_f32 v96, v16, v17
    v_cvt_pk_bf16_f32 v97, v18, v19
    v_cvt_pk_bf16_f32 v98, v20, v21
    v_cvt_pk_bf16_f32 v99, v22, v23
    buffer_store_dwordx4 v[96:99], v3, s[12:15], s26 offen offset:0
    v_add_f32 v32, v16, v17
    v_add_f32 v32, v32, v18
    v_add_f32 v32, v32, v19
    v_add_f32 v32, v32, v20
    v_add_f32 v32, v32, v21
    v_add_f32 v32, v32, v22
    v_add_f32 v32, v32, v23
    s_nop 1
    v_add_f32_dpp v32, v32, v32 quad_perm:[1,0,3,2] row_mask:0xf bank_mask:0xf
    s_nop 1
    v_add_f32_dpp v32, v32, v32 quad_perm:[2,3,0,1] row_mask:0xf bank_mask:0xf
    s_nop 1
    v_add_f32_dpp v32, v32, v32 row_half_mirror row_mask:0xf bank_mask:0xf
    s_nop 1
    v_add_f32_dpp v32, v32, v32 row_mirror row_mask:0xf bank_mask:0xf
    v_mov_b32 v33, v32
    v_mov_b32 v34, v32
    s_nop 1
    v_permlane16_swap_b32 v33, v34
    s_nop 1
    v_add_f32 v32, v33, v34
    v_mov_b32 v33, v32
    v_mov_b32 v34, v32
    s_nop 1
    v_permlane32_swap_b32 v33, v34
    s_nop 1
    v_add_f32 v32, v33, v34
    v_mul_f32 v35, 0x3b000000, v32
    v_sub_f32 v33, v16, v35
    v_mul_f32 v32, v33, v33
    v_sub_f32 v33, v17, v35
    v_fmac_f32 v32, v33, v33
    v_sub_f32 v33, v18, v35
    v_fmac_f32 v32, v33, v33
    v_sub_f32 v33, v19, v35
    v_fmac_f32 v32, v33, v33
    v_sub_f32 v33, v20, v35
    v_fmac_f32 v32, v33, v33
    v_sub_f32 v33, v21, v35
    v_fmac_f32 v32, v33, v33
    v_sub_f32 v33, v22, v35
    v_fmac_f32 v32, v33, v33
    v_sub_f32 v33, v23, v35
    v_fmac_f32 v32, v33, v33
    s_nop 1
    v_add_f32_dpp v32, v32, v32 quad_perm:[1,0,3,2] row_mask:0xf bank_mask:0xf
    s_nop 1
    v_add_f32_dpp v32, v32, v32 quad_perm:[2,3,0,1] row_mask:0xf bank_mask:0xf
    s_nop 1
    v_add_f32_dpp v32, v32, v32 row_half_mirror row_mask:0xf bank_mask:0xf
    s_nop 1
    v_add_f32_dpp v32, v32, v32 row_mirror row_mask:0xf bank_mask:0xf
    v_mov_b32 v33, v32
    v_mov_b32 v34, v32
    s_nop 1
    v_permlane16_swap_b32 v33, v34
    s_nop 1
    v_add_f32 v32, v33, v34
    v_mov_b32 v33, v32
    v_mov_b32 v34, v32
    s_nop 1
    v_permlane32_swap_b32 v33, v34
    s_nop 1
    v_add_f32 v32, v33, v34
    v_mul_f32 v36, 0x3b000000, v32
    v_cvt_pk_bf16_f32 v33, v35, v36
    v_lshlrev_b32 v35, 16, v33
    v_and_b32 v36, 0xffff0000, v33
    v_add_f32 v37, 0x3727c5ac, v36
    v_cvt_pk_bf16_f32 v33, v37, v37
    v_lshlrev_b32 v37, 16, v33
    v_sqrt_f32 v37, v37
    s_nop 0
    v_cvt_pk_bf16_f32 v33, v37, v37
    v_lshlrev_b32 v37, 16, v33
    v_rcp_f32 v37, v37
    v_sub_f32 v16, v16, v35
    v_sub_f32 v17, v17, v35
    v_cvt_pk_bf16_f32 v33, v16, v17
    v_lshlrev_b32 v16, 16, v33
    v_and_b32 v17, 0xffff0000, v33
    v_mul_f32 v16, v16, v37
    v_mul_f32 v17, v17, v37
    v_cvt_pk_bf16_f32 v33, v16, v17
    v_lshlrev_b32 v16, 16, v33
    v_and_b32 v17, 0xffff0000, v33
    v_sub_f32 v18, v18, v35
    v_sub_f32 v19, v19, v35
    v_cvt_pk_bf16_f32 v33, v18, v19
    v_lshlrev_b32 v18, 16, v33
    v_and_b32 v19, 0xffff0000, v33
    v_mul_f32 v18, v18, v37
    v_mul_f32 v19, v19, v37
    v_cvt_pk_bf16_f32 v33, v18, v19
    v_lshlrev_b32 v18, 16, v33
    v_and_b32 v19, 0xffff0000, v33
    v_sub_f32 v20, v20, v35
    v_sub_f32 v21, v21, v35
    v_cvt_pk_bf16_f32 v33, v20, v21
    v_lshlrev_b32 v20, 16, v33
    v_and_b32 v21, 0xffff0000, v33
    v_mul_f32 v20, v20, v37
    v_mul_f32 v21, v21, v37
    v_cvt_pk_bf16_f32 v33, v20, v21
    v_lshlrev_b32 v20, 16, v33
    v_and_b32 v21, 0xffff0000, v33
    v_sub_f32 v22, v22, v35
    v_sub_f32 v23, v23, v35
    v_cvt_pk_bf16_f32 v33, v22, v23
    v_lshlrev_b32 v22, 16, v33
    v_and_b32 v23, 0xffff0000, v33
    v_mul_f32 v22, v22, v37
    v_mul_f32 v23, v23, v37
    v_cvt_pk_bf16_f32 v33, v22, v23
    v_lshlrev_b32 v22, 16, v33
    v_and_b32 v23, 0xffff0000, v33
    v_mul_f32 v16, v16, v56
    v_mul_f32 v17, v17, v57
    v_cvt_pk_bf16_f32 v12, v16, v17
    v_lshlrev_b32 v16, 16, v12
    v_and_b32 v17, 0xffff0000, v12
    v_add_f32 v16, v16, v48
    v_add_f32 v17, v17, v49
    v_cvt_pk_bf16_f32 v12, v16, v17
    v_lshlrev_b32 v16, 16, v12
    v_and_b32 v17, 0xffff0000, v12
    v_mul_f32 v18, v18, v58
    v_mul_f32 v19, v19, v59
    v_cvt_pk_bf16_f32 v12, v18, v19
    v_lshlrev_b32 v18, 16, v12
    v_and_b32 v19, 0xffff0000, v12
    v_add_f32 v18, v18, v50
    v_add_f32 v19, v19, v51
    v_cvt_pk_bf16_f32 v12, v18, v19
    v_lshlrev_b32 v18, 16, v12
    v_and_b32 v19, 0xffff0000, v12
    v_mul_f32 v20, v20, v60
    v_mul_f32 v21, v21, v61
    v_cvt_pk_bf16_f32 v12, v20, v21
    v_lshlrev_b32 v20, 16, v12
    v_and_b32 v21, 0xffff0000, v12
    v_add_f32 v20, v20, v52
    v_add_f32 v21, v21, v53
    v_cvt_pk_bf16_f32 v12, v20, v21
    v_lshlrev_b32 v20, 16, v12
    v_and_b32 v21, 0xffff0000, v12
    v_mul_f32 v22, v22, v62
    v_mul_f32 v23, v23, v63
    v_cvt_pk_bf16_f32 v12, v22, v23
    v_lshlrev_b32 v22, 16, v12
    v_and_b32 v23, 0xffff0000, v12
    v_add_f32 v22, v22, v54
    v_add_f32 v23, v23, v55
    v_cvt_pk_bf16_f32 v12, v22, v23
    v_lshlrev_b32 v22, 16, v12
    v_and_b32 v23, 0xffff0000, v12
    v_add_f32 v32, v16, v17
    v_add_f32 v32, v32, v18
    v_add_f32 v32, v32, v19
    v_add_f32 v32, v32, v20
    v_add_f32 v32, v32, v21
    v_add_f32 v32, v32, v22
    v_add_f32 v32, v32, v23
    s_nop 1
    v_add_f32_dpp v32, v32, v32 quad_perm:[1,0,3,2] row_mask:0xf bank_mask:0xf
    s_nop 1
    v_add_f32_dpp v32, v32, v32 quad_perm:[2,3,0,1] row_mask:0xf bank_mask:0xf
    s_nop 1
    v_add_f32_dpp v32, v32, v32 row_half_mirror row_mask:0xf bank_mask:0xf
    s_nop 1
    v_add_f32_dpp v32, v32, v32 row_mirror row_mask:0xf bank_mask:0xf
    v_mov_b32 v33, v32
    v_mov_b32 v34, v32
    s_nop 1
    v_permlane16_swap_b32 v33, v34
    s_nop 1
    v_add_f32 v32, v33, v34
    v_mov_b32 v33, v32
    v_mov_b32 v34, v32
    s_nop 1
    v_permlane32_swap_b32 v33, v34
    s_nop 1
    v_add_f32 v32, v33, v34
    v_mul_f32 v35, 0x3b000000, v32
    v_sub_f32 v33, v16, v35
    v_mul_f32 v32, v33, v33
    v_sub_f32 v33, v17, v35
    v_fmac_f32 v32, v33, v33
    v_sub_f32 v33, v18, v35
    v_fmac_f32 v32, v33, v33
    v_sub_f32 v33, v19, v35
    v_fmac_f32 v32, v33, v33
    v_sub_f32 v33, v20, v35
    v_fmac_f32 v32, v33, v33
    v_sub_f32 v33, v21, v35
    v_fmac_f32 v32, v33, v33
    v_sub_f32 v33, v22, v35
    v_fmac_f32 v32, v33, v33
    v_sub_f32 v33, v23, v35
    v_fmac_f32 v32, v33, v33
    s_nop 1
    v_add_f32_dpp v32, v32, v32 quad_perm:[1,0,3,2] row_mask:0xf bank_mask:0xf
    s_nop 1
    v_add_f32_dpp v32, v32, v32 quad_perm:[2,3,0,1] row_mask:0xf bank_mask:0xf
    s_nop 1
    v_add_f32_dpp v32, v32, v32 row_half_mirror row_mask:0xf bank_mask:0xf
    s_nop 1
    v_add_f32_dpp v32, v32, v32 row_mirror row_mask:0xf bank_mask:0xf
    v_mov_b32 v33, v32
    v_mov_b32 v34, v32
    s_nop 1
    v_permlane16_swap_b32 v33, v34
    s_nop 1
    v_add_f32 v32, v33, v34
    v_mov_b32 v33, v32
    v_mov_b32 v34, v32
    s_nop 1
    v_permlane32_swap_b32 v33, v34
    s_nop 1
    v_add_f32 v32, v33, v34
    v_mul_f32 v36, 0x3b000000, v32
    v_cvt_pk_bf16_f32 v33, v35, v36
    v_lshlrev_b32 v35, 16, v33
    v_and_b32 v36, 0xffff0000, v33
    v_add_f32 v37, 0x3727c5ac, v36
    v_cvt_pk_bf16_f32 v33, v37, v37
    v_lshlrev_b32 v37, 16, v33
    v_sqrt_f32 v37, v37
    s_nop 0
    v_cvt_pk_bf16_f32 v33, v37, v37
    v_lshlrev_b32 v37, 16, v33
    v_rcp_f32 v37, v37
    v_sub_f32 v16, v16, v35
    v_sub_f32 v17, v17, v35
    v_cvt_pk_bf16_f32 v33, v16, v17
    v_lshlrev_b32 v16, 16, v33
    v_and_b32 v17, 0xffff0000, v33
    v_mul_f32 v16, v16, v37
    v_mul_f32 v17, v17, v37
    v_cvt_pk_bf16_f32 v33, v16, v17
    v_lshlrev_b32 v16, 16, v33
    v_and_b32 v17, 0xffff0000, v33
    v_sub_f32 v18, v18, v35
    v_sub_f32 v19, v19, v35
    v_cvt_pk_bf16_f32 v33, v18, v19
    v_lshlrev_b32 v18, 16, v33
    v_and_b32 v19, 0xffff0000, v33
    v_mul_f32 v18, v18, v37
    v_mul_f32 v19, v19, v37
    v_cvt_pk_bf16_f32 v33, v18, v19
    v_lshlrev_b32 v18, 16, v33
    v_and_b32 v19, 0xffff0000, v33
    v_sub_f32 v20, v20, v35
    v_sub_f32 v21, v21, v35
    v_cvt_pk_bf16_f32 v33, v20, v21
    v_lshlrev_b32 v20, 16, v33
    v_and_b32 v21, 0xffff0000, v33
    v_mul_f32 v20, v20, v37
    v_mul_f32 v21, v21, v37
    v_cvt_pk_bf16_f32 v33, v20, v21
    v_lshlrev_b32 v20, 16, v33
    v_and_b32 v21, 0xffff0000, v33
    v_sub_f32 v22, v22, v35
    v_sub_f32 v23, v23, v35
    v_cvt_pk_bf16_f32 v33, v22, v23
    v_lshlrev_b32 v22, 16, v33
    v_and_b32 v23, 0xffff0000, v33
    v_mul_f32 v22, v22, v37
    v_mul_f32 v23, v23, v37
    v_cvt_pk_bf16_f32 v33, v22, v23
    v_lshlrev_b32 v22, 16, v33
    v_and_b32 v23, 0xffff0000, v33
    v_cvt_pk_bf16_f32 v100, v16, v17
    v_cvt_pk_bf16_f32 v101, v18, v19
    v_cvt_pk_bf16_f32 v102, v20, v21
    v_cvt_pk_bf16_f32 v103, v22, v23
    ds_write_b128 v6, v[100:103] offset:0
    s_waitcnt vmcnt(5)
    v_lshlrev_b32 v16, 16, v72
    v_and_b32 v17, 0xffff0000, v72
    v_lshlrev_b32 v18, 16, v73
    v_and_b32 v19, 0xffff0000, v73
    v_lshlrev_b32 v20, 16, v74
    v_and_b32 v21, 0xffff0000, v74
    v_lshlrev_b32 v22, 16, v75
    v_and_b32 v23, 0xffff0000, v75
    v_lshlrev_b32 v24, 16, v76
    v_and_b32 v25, 0xffff0000, v76
    v_lshlrev_b32 v26, 16, v77
    v_and_b32 v27, 0xffff0000, v77
    v_lshlrev_b32 v28, 16, v78
    v_and_b32 v29, 0xffff0000, v78
    v_lshlrev_b32 v30, 16, v79
    v_and_b32 v31, 0xffff0000, v79
    v_mul_f32 v24, v24, v40
    v_mul_f32 v25, v25, v41
    v_cvt_pk_bf16_f32 v12, v24, v25
    v_lshlrev_b32 v24, 16, v12
    v_and_b32 v25, 0xffff0000, v12
    v_add_f32 v16, v16, v24
    v_add_f32 v17, v17, v25
    v_cvt_pk_bf16_f32 v12, v16, v17
    v_lshlrev_b32 v16, 16, v12
    v_and_b32 v17, 0xffff0000, v12
    v_mul_f32 v26, v26, v42
    v_mul_f32 v27, v27, v43
    v_cvt_pk_bf16_f32 v12, v26, v27
    v_lshlrev_b32 v26, 16, v12
    v_and_b32 v27, 0xffff0000, v12
    v_add_f32 v18, v18, v26
    v_add_f32 v19, v19, v27
    v_cvt_pk_bf16_f32 v12, v18, v19
    v_lshlrev_b32 v18, 16, v12
    v_and_b32 v19, 0xffff0000, v12
    v_mul_f32 v28, v28, v44
    v_mul_f32 v29, v29, v45
    v_cvt_pk_bf16_f32 v12, v28, v29
    v_lshlrev_b32 v28, 16, v12
    v_and_b32 v29, 0xffff0000, v12
    v_add_f32 v20, v20, v28
    v_add_f32 v21, v21, v29
    v_cvt_pk_bf16_f32 v12, v20, v21
    v_lshlrev_b32 v20, 16, v12
    v_and_b32 v21, 0xffff0000, v12
    v_mul_f32 v30, v30, v46
    v_mul_f32 v31, v31, v47
    v_cvt_pk_bf16_f32 v12, v30, v31
    v_lshlrev_b32 v30, 16, v12
    v_and_b32 v31, 0xffff0000, v12
    v_add_f32 v22, v22, v30
    v_add_f32 v23, v23, v31
    v_cvt_pk_bf16_f32 v12, v22, v23
    v_lshlrev_b32 v22, 16, v12
    v_and_b32 v23, 0xffff0000, v12
    v_cvt_pk_bf16_f32 v104, v16, v17
    v_cvt_pk_bf16_f32 v105, v18, v19
    v_cvt_pk_bf16_f32 v106, v20, v21
    v_cvt_pk_bf16_f32 v107, v22, v23
    buffer_store_dwordx4 v[104:107], v3, s[12:15], s26 offen offset:1024
    v_add_f32 v32, v16, v17
    v_add_f32 v32, v32, v18
    v_add_f32 v32, v32, v19
    v_add_f32 v32, v32, v20
    v_add_f32 v32, v32, v21
    v_add_f32 v32, v32, v22
    v_add_f32 v32, v32, v23
    s_nop 1
    v_add_f32_dpp v32, v32, v32 quad_perm:[1,0,3,2] row_mask:0xf bank_mask:0xf
    s_nop 1
    v_add_f32_dpp v32, v32, v32 quad_perm:[2,3,0,1] row_mask:0xf bank_mask:0xf
    s_nop 1
    v_add_f32_dpp v32, v32, v32 row_half_mirror row_mask:0xf bank_mask:0xf
    s_nop 1
    v_add_f32_dpp v32, v32, v32 row_mirror row_mask:0xf bank_mask:0xf
    v_mov_b32 v33, v32
    v_mov_b32 v34, v32
    s_nop 1
    v_permlane16_swap_b32 v33, v34
    s_nop 1
    v_add_f32 v32, v33, v34
    v_mov_b32 v33, v32
    v_mov_b32 v34, v32
    s_nop 1
    v_permlane32_swap_b32 v33, v34
    s_nop 1
    v_add_f32 v32, v33, v34
    v_mul_f32 v35, 0x3b000000, v32
    v_sub_f32 v33, v16, v35
    v_mul_f32 v32, v33, v33
    v_sub_f32 v33, v17, v35
    v_fmac_f32 v32, v33, v33
    v_sub_f32 v33, v18, v35
    v_fmac_f32 v32, v33, v33
    v_sub_f32 v33, v19, v35
    v_fmac_f32 v32, v33, v33
    v_sub_f32 v33, v20, v35
    v_fmac_f32 v32, v33, v33
    v_sub_f32 v33, v21, v35
    v_fmac_f32 v32, v33, v33
    v_sub_f32 v33, v22, v35
    v_fmac_f32 v32, v33, v33
    v_sub_f32 v33, v23, v35
    v_fmac_f32 v32, v33, v33
    s_nop 1
    v_add_f32_dpp v32, v32, v32 quad_perm:[1,0,3,2] row_mask:0xf bank_mask:0xf
    s_nop 1
    v_add_f32_dpp v32, v32, v32 quad_perm:[2,3,0,1] row_mask:0xf bank_mask:0xf
    s_nop 1
    v_add_f32_dpp v32, v32, v32 row_half_mirror row_mask:0xf bank_mask:0xf
    s_nop 1
    v_add_f32_dpp v32, v32, v32 row_mirror row_mask:0xf bank_mask:0xf
    v_mov_b32 v33, v32
    v_mov_b32 v34, v32
    s_nop 1
    v_permlane16_swap_b32 v33, v34
    s_nop 1
    v_add_f32 v32, v33, v34
    v_mov_b32 v33, v32
    v_mov_b32 v34, v32
    s_nop 1
    v_permlane32_swap_b32 v33, v34
    s_nop 1
    v_add_f32 v32, v33, v34
    v_mul_f32 v36, 0x3b000000, v32
    v_cvt_pk_bf16_f32 v33, v35, v36
    v_lshlrev_b32 v35, 16, v33
    v_and_b32 v36, 0xffff0000, v33
    v_add_f32 v37, 0x3727c5ac, v36
    v_cvt_pk_bf16_f32 v33, v37, v37
    v_lshlrev_b32 v37, 16, v33
    v_sqrt_f32 v37, v37
    s_nop 0
    v_cvt_pk_bf16_f32 v33, v37, v37
    v_lshlrev_b32 v37, 16, v33
    v_rcp_f32 v37, v37
    v_sub_f32 v16, v16, v35
    v_sub_f32 v17, v17, v35
    v_cvt_pk_bf16_f32 v33, v16, v17
    v_lshlrev_b32 v16, 16, v33
    v_and_b32 v17, 0xffff0000, v33
    v_mul_f32 v16, v16, v37
    v_mul_f32 v17, v17, v37
    v_cvt_pk_bf16_f32 v33, v16, v17
    v_lshlrev_b32 v16, 16, v33
    v_and_b32 v17, 0xffff0000, v33
    v_sub_f32 v18, v18, v35
    v_sub_f32 v19, v19, v35
    v_cvt_pk_bf16_f32 v33, v18, v19
    v_lshlrev_b32 v18, 16, v33
    v_and_b32 v19, 0xffff0000, v33
    v_mul_f32 v18, v18, v37
    v_mul_f32 v19, v19, v37
    v_cvt_pk_bf16_f32 v33, v18, v19
    v_lshlrev_b32 v18, 16, v33
    v_and_b32 v19, 0xffff0000, v33
    v_sub_f32 v20, v20, v35
    v_sub_f32 v21, v21, v35
    v_cvt_pk_bf16_f32 v33, v20, v21
    v_lshlrev_b32 v20, 16, v33
    v_and_b32 v21, 0xffff0000, v33
    v_mul_f32 v20, v20, v37
    v_mul_f32 v21, v21, v37
    v_cvt_pk_bf16_f32 v33, v20, v21
    v_lshlrev_b32 v20, 16, v33
    v_and_b32 v21, 0xffff0000, v33
    v_sub_f32 v22, v22, v35
    v_sub_f32 v23, v23, v35
    v_cvt_pk_bf16_f32 v33, v22, v23
    v_lshlrev_b32 v22, 16, v33
    v_and_b32 v23, 0xffff0000, v33
    v_mul_f32 v22, v22, v37
    v_mul_f32 v23, v23, v37
    v_cvt_pk_bf16_f32 v33, v22, v23
    v_lshlrev_b32 v22, 16, v33
    v_and_b32 v23, 0xffff0000, v33
    v_mul_f32 v16, v16, v56
    v_mul_f32 v17, v17, v57
    v_cvt_pk_bf16_f32 v12, v16, v17
    v_lshlrev_b32 v16, 16, v12
    v_and_b32 v17, 0xffff0000, v12
    v_add_f32 v16, v16, v48
    v_add_f32 v17, v17, v49
    v_cvt_pk_bf16_f32 v12, v16, v17
    v_lshlrev_b32 v16, 16, v12
    v_and_b32 v17, 0xffff0000, v12
    v_mul_f32 v18, v18, v58
    v_mul_f32 v19, v19, v59
    v_cvt_pk_bf16_f32 v12, v18, v19
    v_lshlrev_b32 v18, 16, v12
    v_and_b32 v19, 0xffff0000, v12
    v_add_f32 v18, v18, v50
    v_add_f32 v19, v19, v51
    v_cvt_pk_bf16_f32 v12, v18, v19
    v_lshlrev_b32 v18, 16, v12
    v_and_b32 v19, 0xffff0000, v12
    v_mul_f32 v20, v20, v60
    v_mul_f32 v21, v21, v61
    v_cvt_pk_bf16_f32 v12, v20, v21
    v_lshlrev_b32 v20, 16, v12
    v_and_b32 v21, 0xffff0000, v12
    v_add_f32 v20, v20, v52
    v_add_f32 v21, v21, v53
    v_cvt_pk_bf16_f32 v12, v20, v21
    v_lshlrev_b32 v20, 16, v12
    v_and_b32 v21, 0xffff0000, v12
    v_mul_f32 v22, v22, v62
    v_mul_f32 v23, v23, v63
    v_cvt_pk_bf16_f32 v12, v22, v23
    v_lshlrev_b32 v22, 16, v12
    v_and_b32 v23, 0xffff0000, v12
    v_add_f32 v22, v22, v54
    v_add_f32 v23, v23, v55
    v_cvt_pk_bf16_f32 v12, v22, v23
    v_lshlrev_b32 v22, 16, v12
    v_and_b32 v23, 0xffff0000, v12
    v_add_f32 v32, v16, v17
    v_add_f32 v32, v32, v18
    v_add_f32 v32, v32, v19
    v_add_f32 v32, v32, v20
    v_add_f32 v32, v32, v21
    v_add_f32 v32, v32, v22
    v_add_f32 v32, v32, v23
    s_nop 1
    v_add_f32_dpp v32, v32, v32 quad_perm:[1,0,3,2] row_mask:0xf bank_mask:0xf
    s_nop 1
    v_add_f32_dpp v32, v32, v32 quad_perm:[2,3,0,1] row_mask:0xf bank_mask:0xf
    s_nop 1
    v_add_f32_dpp v32, v32, v32 row_half_mirror row_mask:0xf bank_mask:0xf
    s_nop 1
    v_add_f32_dpp v32, v32, v32 row_mirror row_mask:0xf bank_mask:0xf
    v_mov_b32 v33, v32
    v_mov_b32 v34, v32
    s_nop 1
    v_permlane16_swap_b32 v33, v34
    s_nop 1
    v_add_f32 v32, v33, v34
    v_mov_b32 v33, v32
    v_mov_b32 v34, v32
    s_nop 1
    v_permlane32_swap_b32 v33, v34
    s_nop 1
    v_add_f32 v32, v33, v34
    v_mul_f32 v35, 0x3b000000, v32
    v_sub_f32 v33, v16, v35
    v_mul_f32 v32, v33, v33
    v_sub_f32 v33, v17, v35
    v_fmac_f32 v32, v33, v33
    v_sub_f32 v33, v18, v35
    v_fmac_f32 v32, v33, v33
    v_sub_f32 v33, v19, v35
    v_fmac_f32 v32, v33, v33
    v_sub_f32 v33, v20, v35
    v_fmac_f32 v32, v33, v33
    v_sub_f32 v33, v21, v35
    v_fmac_f32 v32, v33, v33
    v_sub_f32 v33, v22, v35
    v_fmac_f32 v32, v33, v33
    v_sub_f32 v33, v23, v35
    v_fmac_f32 v32, v33, v33
    s_nop 1
    v_add_f32_dpp v32, v32, v32 quad_perm:[1,0,3,2] row_mask:0xf bank_mask:0xf
    s_nop 1
    v_add_f32_dpp v32, v32, v32 quad_perm:[2,3,0,1] row_mask:0xf bank_mask:0xf
    s_nop 1
    v_add_f32_dpp v32, v32, v32 row_half_mirror row_mask:0xf bank_mask:0xf
    s_nop 1
    v_add_f32_dpp v32, v32, v32 row_mirror row_mask:0xf bank_mask:0xf
    v_mov_b32 v33, v32
    v_mov_b32 v34, v32
    s_nop 1
    v_permlane16_swap_b32 v33, v34
    s_nop 1
    v_add_f32 v32, v33, v34
    v_mov_b32 v33, v32
    v_mov_b32 v34, v32
    s_nop 1
    v_permlane32_swap_b32 v33, v34
    s_nop 1
    v_add_f32 v32, v33, v34
    v_mul_f32 v36, 0x3b000000, v32
    v_cvt_pk_bf16_f32 v33, v35, v36
    v_lshlrev_b32 v35, 16, v33
    v_and_b32 v36, 0xffff0000, v33
    v_add_f32 v37, 0x3727c5ac, v36
    v_cvt_pk_bf16_f32 v33, v37, v37
    v_lshlrev_b32 v37, 16, v33
    v_sqrt_f32 v37, v37
    s_nop 0
    v_cvt_pk_bf16_f32 v33, v37, v37
    v_lshlrev_b32 v37, 16, v33
    v_rcp_f32 v37, v37
    v_sub_f32 v16, v16, v35
    v_sub_f32 v17, v17, v35
    v_cvt_pk_bf16_f32 v33, v16, v17
    v_lshlrev_b32 v16, 16, v33
    v_and_b32 v17, 0xffff0000, v33
    v_mul_f32 v16, v16, v37
    v_mul_f32 v17, v17, v37
    v_cvt_pk_bf16_f32 v33, v16, v17
    v_lshlrev_b32 v16, 16, v33
    v_and_b32 v17, 0xffff0000, v33
    v_sub_f32 v18, v18, v35
    v_sub_f32 v19, v19, v35
    v_cvt_pk_bf16_f32 v33, v18, v19
    v_lshlrev_b32 v18, 16, v33
    v_and_b32 v19, 0xffff0000, v33
    v_mul_f32 v18, v18, v37
    v_mul_f32 v19, v19, v37
    v_cvt_pk_bf16_f32 v33, v18, v19
    v_lshlrev_b32 v18, 16, v33
    v_and_b32 v19, 0xffff0000, v33
    v_sub_f32 v20, v20, v35
    v_sub_f32 v21, v21, v35
    v_cvt_pk_bf16_f32 v33, v20, v21
    v_lshlrev_b32 v20, 16, v33
    v_and_b32 v21, 0xffff0000, v33
    v_mul_f32 v20, v20, v37
    v_mul_f32 v21, v21, v37
    v_cvt_pk_bf16_f32 v33, v20, v21
    v_lshlrev_b32 v20, 16, v33
    v_and_b32 v21, 0xffff0000, v33
    v_sub_f32 v22, v22, v35
    v_sub_f32 v23, v23, v35
    v_cvt_pk_bf16_f32 v33, v22, v23
    v_lshlrev_b32 v22, 16, v33
    v_and_b32 v23, 0xffff0000, v33
    v_mul_f32 v22, v22, v37
    v_mul_f32 v23, v23, v37
    v_cvt_pk_bf16_f32 v33, v22, v23
    v_lshlrev_b32 v22, 16, v33
    v_and_b32 v23, 0xffff0000, v33
    v_cvt_pk_bf16_f32 v108, v16, v17
    v_cvt_pk_bf16_f32 v109, v18, v19
    v_cvt_pk_bf16_f32 v110, v20, v21
    v_cvt_pk_bf16_f32 v111, v22, v23
    ds_write_b128 v6, v[108:111] offset:16
    s_waitcnt vmcnt(4)
    v_lshlrev_b32 v16, 16, v80
    v_and_b32 v17, 0xffff0000, v80
    v_lshlrev_b32 v18, 16, v81
    v_and_b32 v19, 0xffff0000, v81
    v_lshlrev_b32 v20, 16, v82
    v_and_b32 v21, 0xffff0000, v82
    v_lshlrev_b32 v22, 16, v83
    v_and_b32 v23, 0xffff0000, v83
    v_lshlrev_b32 v24, 16, v84
    v_and_b32 v25, 0xffff0000, v84
    v_lshlrev_b32 v26, 16, v85
    v_and_b32 v27, 0xffff0000, v85
    v_lshlrev_b32 v28, 16, v86
    v_and_b32 v29, 0xffff0000, v86
    v_lshlrev_b32 v30, 16, v87
    v_and_b32 v31, 0xffff0000, v87
    v_mul_f32 v24, v24, v40
    v_mul_f32 v25, v25, v41
    v_cvt_pk_bf16_f32 v12, v24, v25
    v_lshlrev_b32 v24, 16, v12
    v_and_b32 v25, 0xffff0000, v12
    v_add_f32 v16, v16, v24
    v_add_f32 v17, v17, v25
    v_cvt_pk_bf16_f32 v12, v16, v17
    v_lshlrev_b32 v16, 16, v12
    v_and_b32 v17, 0xffff0000, v12
    v_mul_f32 v26, v26, v42
    v_mul_f32 v27, v27, v43
    v_cvt_pk_bf16_f32 v12, v26, v27
    v_lshlrev_b32 v26, 16, v12
    v_and_b32 v27, 0xffff0000, v12
    v_add_f32 v18, v18, v26
    v_add_f32 v19, v19, v27
    v_cvt_pk_bf16_f32 v12, v18, v19
    v_lshlrev_b32 v18, 16, v12
    v_and_b32 v19, 0xffff0000, v12
    v_mul_f32 v28, v28, v44
    v_mul_f32 v29, v29, v45
    v_cvt_pk_bf16_f32 v12, v28, v29
    v_lshlrev_b32 v28, 16, v12
    v_and_b32 v29, 0xffff0000, v12
    v_add_f32 v20, v20, v28
    v_add_f32 v21, v21, v29
    v_cvt_pk_bf16_f32 v12, v20, v21
    v_lshlrev_b32 v20, 16, v12
    v_and_b32 v21, 0xffff0000, v12
    v_mul_f32 v30, v30, v46
    v_mul_f32 v31, v31, v47
    v_cvt_pk_bf16_f32 v12, v30, v31
    v_lshlrev_b32 v30, 16, v12
    v_and_b32 v31, 0xffff0000, v12
    v_add_f32 v22, v22, v30
    v_add_f32 v23, v23, v31
    v_cvt_pk_bf16_f32 v12, v22, v23
    v_lshlrev_b32 v22, 16, v12
    v_and_b32 v23, 0xffff0000, v12
    v_cvt_pk_bf16_f32 v112, v16, v17
    v_cvt_pk_bf16_f32 v113, v18, v19
    v_cvt_pk_bf16_f32 v114, v20, v21
    v_cvt_pk_bf16_f32 v115, v22, v23
    buffer_store_dwordx4 v[112:115], v3, s[12:15], s26 offen offset:2048
    v_add_f32 v32, v16, v17
    v_add_f32 v32, v32, v18
    v_add_f32 v32, v32, v19
    v_add_f32 v32, v32, v20
    v_add_f32 v32, v32, v21
    v_add_f32 v32, v32, v22
    v_add_f32 v32, v32, v23
    s_nop 1
    v_add_f32_dpp v32, v32, v32 quad_perm:[1,0,3,2] row_mask:0xf bank_mask:0xf
    s_nop 1
    v_add_f32_dpp v32, v32, v32 quad_perm:[2,3,0,1] row_mask:0xf bank_mask:0xf
    s_nop 1
    v_add_f32_dpp v32, v32, v32 row_half_mirror row_mask:0xf bank_mask:0xf
    s_nop 1
    v_add_f32_dpp v32, v32, v32 row_mirror row_mask:0xf bank_mask:0xf
    v_mov_b32 v33, v32
    v_mov_b32 v34, v32
    s_nop 1
    v_permlane16_swap_b32 v33, v34
    s_nop 1
    v_add_f32 v32, v33, v34
    v_mov_b32 v33, v32
    v_mov_b32 v34, v32
    s_nop 1
    v_permlane32_swap_b32 v33, v34
    s_nop 1
    v_add_f32 v32, v33, v34
    v_mul_f32 v35, 0x3b000000, v32
    v_sub_f32 v33, v16, v35
    v_mul_f32 v32, v33, v33
    v_sub_f32 v33, v17, v35
    v_fmac_f32 v32, v33, v33
    v_sub_f32 v33, v18, v35
    v_fmac_f32 v32, v33, v33
    v_sub_f32 v33, v19, v35
    v_fmac_f32 v32, v33, v33
    v_sub_f32 v33, v20, v35
    v_fmac_f32 v32, v33, v33
    v_sub_f32 v33, v21, v35
    v_fmac_f32 v32, v33, v33
    v_sub_f32 v33, v22, v35
    v_fmac_f32 v32, v33, v33
    v_sub_f32 v33, v23, v35
    v_fmac_f32 v32, v33, v33
    s_nop 1
    v_add_f32_dpp v32, v32, v32 quad_perm:[1,0,3,2] row_mask:0xf bank_mask:0xf
    s_nop 1
    v_add_f32_dpp v32, v32, v32 quad_perm:[2,3,0,1] row_mask:0xf bank_mask:0xf
    s_nop 1
    v_add_f32_dpp v32, v32, v32 row_half_mirror row_mask:0xf bank_mask:0xf
    s_nop 1
    v_add_f32_dpp v32, v32, v32 row_mirror row_mask:0xf bank_mask:0xf
    v_mov_b32 v33, v32
    v_mov_b32 v34, v32
    s_nop 1
    v_permlane16_swap_b32 v33, v34
    s_nop 1
    v_add_f32 v32, v33, v34
    v_mov_b32 v33, v32
    v_mov_b32 v34, v32
    s_nop 1
    v_permlane32_swap_b32 v33, v34
    s_nop 1
    v_add_f32 v32, v33, v34
    v_mul_f32 v36, 0x3b000000, v32
    v_cvt_pk_bf16_f32 v33, v35, v36
    v_lshlrev_b32 v35, 16, v33
    v_and_b32 v36, 0xffff0000, v33
    v_add_f32 v37, 0x3727c5ac, v36
    v_cvt_pk_bf16_f32 v33, v37, v37
    v_lshlrev_b32 v37, 16, v33
    v_sqrt_f32 v37, v37
    s_nop 0
    v_cvt_pk_bf16_f32 v33, v37, v37
    v_lshlrev_b32 v37, 16, v33
    v_rcp_f32 v37, v37
    v_sub_f32 v16, v16, v35
    v_sub_f32 v17, v17, v35
    v_cvt_pk_bf16_f32 v33, v16, v17
    v_lshlrev_b32 v16, 16, v33
    v_and_b32 v17, 0xffff0000, v33
    v_mul_f32 v16, v16, v37
    v_mul_f32 v17, v17, v37
    v_cvt_pk_bf16_f32 v33, v16, v17
    v_lshlrev_b32 v16, 16, v33
    v_and_b32 v17, 0xffff0000, v33
    v_sub_f32 v18, v18, v35
    v_sub_f32 v19, v19, v35
    v_cvt_pk_bf16_f32 v33, v18, v19
    v_lshlrev_b32 v18, 16, v33
    v_and_b32 v19, 0xffff0000, v33
    v_mul_f32 v18, v18, v37
    v_mul_f32 v19, v19, v37
    v_cvt_pk_bf16_f32 v33, v18, v19
    v_lshlrev_b32 v18, 16, v33
    v_and_b32 v19, 0xffff0000, v33
    v_sub_f32 v20, v20, v35
    v_sub_f32 v21, v21, v35
    v_cvt_pk_bf16_f32 v33, v20, v21
    v_lshlrev_b32 v20, 16, v33
    v_and_b32 v21, 0xffff0000, v33
    v_mul_f32 v20, v20, v37
    v_mul_f32 v21, v21, v37
    v_cvt_pk_bf16_f32 v33, v20, v21
    v_lshlrev_b32 v20, 16, v33
    v_and_b32 v21, 0xffff0000, v33
    v_sub_f32 v22, v22, v35
    v_sub_f32 v23, v23, v35
    v_cvt_pk_bf16_f32 v33, v22, v23
    v_lshlrev_b32 v22, 16, v33
    v_and_b32 v23, 0xffff0000, v33
    v_mul_f32 v22, v22, v37
    v_mul_f32 v23, v23, v37
    v_cvt_pk_bf16_f32 v33, v22, v23
    v_lshlrev_b32 v22, 16, v33
    v_and_b32 v23, 0xffff0000, v33
    v_mul_f32 v16, v16, v56
    v_mul_f32 v17, v17, v57
    v_cvt_pk_bf16_f32 v12, v16, v17
    v_lshlrev_b32 v16, 16, v12
    v_and_b32 v17, 0xffff0000, v12
    v_add_f32 v16, v16, v48
    v_add_f32 v17, v17, v49
    v_cvt_pk_bf16_f32 v12, v16, v17
    v_lshlrev_b32 v16, 16, v12
    v_and_b32 v17, 0xffff0000, v12
    v_mul_f32 v18, v18, v58
    v_mul_f32 v19, v19, v59
    v_cvt_pk_bf16_f32 v12, v18, v19
    v_lshlrev_b32 v18, 16, v12
    v_and_b32 v19, 0xffff0000, v12
    v_add_f32 v18, v18, v50
    v_add_f32 v19, v19, v51
    v_cvt_pk_bf16_f32 v12, v18, v19
    v_lshlrev_b32 v18, 16, v12
    v_and_b32 v19, 0xffff0000, v12
    v_mul_f32 v20, v20, v60
    v_mul_f32 v21, v21, v61
    v_cvt_pk_bf16_f32 v12, v20, v21
    v_lshlrev_b32 v20, 16, v12
    v_and_b32 v21, 0xffff0000, v12
    v_add_f32 v20, v20, v52
    v_add_f32 v21, v21, v53
    v_cvt_pk_bf16_f32 v12, v20, v21
    v_lshlrev_b32 v20, 16, v12
    v_and_b32 v21, 0xffff0000, v12
    v_mul_f32 v22, v22, v62
    v_mul_f32 v23, v23, v63
    v_cvt_pk_bf16_f32 v12, v22, v23
    v_lshlrev_b32 v22, 16, v12
    v_and_b32 v23, 0xffff0000, v12
    v_add_f32 v22, v22, v54
    v_add_f32 v23, v23, v55
    v_cvt_pk_bf16_f32 v12, v22, v23
    v_lshlrev_b32 v22, 16, v12
    v_and_b32 v23, 0xffff0000, v12
    v_add_f32 v32, v16, v17
    v_add_f32 v32, v32, v18
    v_add_f32 v32, v32, v19
    v_add_f32 v32, v32, v20
    v_add_f32 v32, v32, v21
    v_add_f32 v32, v32, v22
    v_add_f32 v32, v32, v23
    s_nop 1
    v_add_f32_dpp v32, v32, v32 quad_perm:[1,0,3,2] row_mask:0xf bank_mask:0xf
    s_nop 1
    v_add_f32_dpp v32, v32, v32 quad_perm:[2,3,0,1] row_mask:0xf bank_mask:0xf
    s_nop 1
    v_add_f32_dpp v32, v32, v32 row_half_mirror row_mask:0xf bank_mask:0xf
    s_nop 1
    v_add_f32_dpp v32, v32, v32 row_mirror row_mask:0xf bank_mask:0xf
    v_mov_b32 v33, v32
    v_mov_b32 v34, v32
    s_nop 1
    v_permlane16_swap_b32 v33, v34
    s_nop 1
    v_add_f32 v32, v33, v34
    v_mov_b32 v33, v32
    v_mov_b32 v34, v32
    s_nop 1
    v_permlane32_swap_b32 v33, v34
    s_nop 1
    v_add_f32 v32, v33, v34
    v_mul_f32 v35, 0x3b000000, v32
    v_sub_f32 v33, v16, v35
    v_mul_f32 v32, v33, v33
    v_sub_f32 v33, v17, v35
    v_fmac_f32 v32, v33, v33
    v_sub_f32 v33, v18, v35
    v_fmac_f32 v32, v33, v33
    v_sub_f32 v33, v19, v35
    v_fmac_f32 v32, v33, v33
    v_sub_f32 v33, v20, v35
    v_fmac_f32 v32, v33, v33
    v_sub_f32 v33, v21, v35
    v_fmac_f32 v32, v33, v33
    v_sub_f32 v33, v22, v35
    v_fmac_f32 v32, v33, v33
    v_sub_f32 v33, v23, v35
    v_fmac_f32 v32, v33, v33
    s_nop 1
    v_add_f32_dpp v32, v32, v32 quad_perm:[1,0,3,2] row_mask:0xf bank_mask:0xf
    s_nop 1
    v_add_f32_dpp v32, v32, v32 quad_perm:[2,3,0,1] row_mask:0xf bank_mask:0xf
    s_nop 1
    v_add_f32_dpp v32, v32, v32 row_half_mirror row_mask:0xf bank_mask:0xf
    s_nop 1
    v_add_f32_dpp v32, v32, v32 row_mirror row_mask:0xf bank_mask:0xf
    v_mov_b32 v33, v32
    v_mov_b32 v34, v32
    s_nop 1
    v_permlane16_swap_b32 v33, v34
    s_nop 1
    v_add_f32 v32, v33, v34
    v_mov_b32 v33, v32
    v_mov_b32 v34, v32
    s_nop 1
    v_permlane32_swap_b32 v33, v34
    s_nop 1
    v_add_f32 v32, v33, v34
    v_mul_f32 v36, 0x3b000000, v32
    v_cvt_pk_bf16_f32 v33, v35, v36
    v_lshlrev_b32 v35, 16, v33
    v_and_b32 v36, 0xffff0000, v33
    v_add_f32 v37, 0x3727c5ac, v36
    v_cvt_pk_bf16_f32 v33, v37, v37
    v_lshlrev_b32 v37, 16, v33
    v_sqrt_f32 v37, v37
    s_nop 0
    v_cvt_pk_bf16_f32 v33, v37, v37
    v_lshlrev_b32 v37, 16, v33
    v_rcp_f32 v37, v37
    v_sub_f32 v16, v16, v35
    v_sub_f32 v17, v17, v35
    v_cvt_pk_bf16_f32 v33, v16, v17
    v_lshlrev_b32 v16, 16, v33
    v_and_b32 v17, 0xffff0000, v33
    v_mul_f32 v16, v16, v37
    v_mul_f32 v17, v17, v37
    v_cvt_pk_bf16_f32 v33, v16, v17
    v_lshlrev_b32 v16, 16, v33
    v_and_b32 v17, 0xffff0000, v33
    v_sub_f32 v18, v18, v35
    v_sub_f32 v19, v19, v35
    v_cvt_pk_bf16_f32 v33, v18, v19
    v_lshlrev_b32 v18, 16, v33
    v_and_b32 v19, 0xffff0000, v33
    v_mul_f32 v18, v18, v37
    v_mul_f32 v19, v19, v37
    v_cvt_pk_bf16_f32 v33, v18, v19
    v_lshlrev_b32 v18, 16, v33
    v_and_b32 v19, 0xffff0000, v33
    v_sub_f32 v20, v20, v35
    v_sub_f32 v21, v21, v35
    v_cvt_pk_bf16_f32 v33, v20, v21
    v_lshlrev_b32 v20, 16, v33
    v_and_b32 v21, 0xffff0000, v33
    v_mul_f32 v20, v20, v37
    v_mul_f32 v21, v21, v37
    v_cvt_pk_bf16_f32 v33, v20, v21
    v_lshlrev_b32 v20, 16, v33
    v_and_b32 v21, 0xffff0000, v33
    v_sub_f32 v22, v22, v35
    v_sub_f32 v23, v23, v35
    v_cvt_pk_bf16_f32 v33, v22, v23
    v_lshlrev_b32 v22, 16, v33
    v_and_b32 v23, 0xffff0000, v33
    v_mul_f32 v22, v22, v37
    v_mul_f32 v23, v23, v37
    v_cvt_pk_bf16_f32 v33, v22, v23
    v_lshlrev_b32 v22, 16, v33
    v_and_b32 v23, 0xffff0000, v33
    v_cvt_pk_bf16_f32 v116, v16, v17
    v_cvt_pk_bf16_f32 v117, v18, v19
    v_cvt_pk_bf16_f32 v118, v20, v21
    v_cvt_pk_bf16_f32 v119, v22, v23
    ds_write_b128 v6, v[116:119] offset:32
    s_waitcnt vmcnt(3)
    v_lshlrev_b32 v16, 16, v88
    v_and_b32 v17, 0xffff0000, v88
    v_lshlrev_b32 v18, 16, v89
    v_and_b32 v19, 0xffff0000, v89
    v_lshlrev_b32 v20, 16, v90
    v_and_b32 v21, 0xffff0000, v90
    v_lshlrev_b32 v22, 16, v91
    v_and_b32 v23, 0xffff0000, v91
    v_lshlrev_b32 v24, 16, v92
    v_and_b32 v25, 0xffff0000, v92
    v_lshlrev_b32 v26, 16, v93
    v_and_b32 v27, 0xffff0000, v93
    v_lshlrev_b32 v28, 16, v94
    v_and_b32 v29, 0xffff0000, v94
    v_lshlrev_b32 v30, 16, v95
    v_and_b32 v31, 0xffff0000, v95
    v_mul_f32 v24, v24, v40
    v_mul_f32 v25, v25, v41
    v_cvt_pk_bf16_f32 v12, v24, v25
    v_lshlrev_b32 v24, 16, v12
    v_and_b32 v25, 0xffff0000, v12
    v_add_f32 v16, v16, v24
    v_add_f32 v17, v17, v25
    v_cvt_pk_bf16_f32 v12, v16, v17
    v_lshlrev_b32 v16, 16, v12
    v_and_b32 v17, 0xffff0000, v12
    v_mul_f32 v26, v26, v42
    v_mul_f32 v27, v27, v43
    v_cvt_pk_bf16_f32 v12, v26, v27
    v_lshlrev_b32 v26, 16, v12
    v_and_b32 v27, 0xffff0000, v12
    v_add_f32 v18, v18, v26
    v_add_f32 v19, v19, v27
    v_cvt_pk_bf16_f32 v12, v18, v19
    v_lshlrev_b32 v18, 16, v12
    v_and_b32 v19, 0xffff0000, v12
    v_mul_f32 v28, v28, v44
    v_mul_f32 v29, v29, v45
    v_cvt_pk_bf16_f32 v12, v28, v29
    v_lshlrev_b32 v28, 16, v12
    v_and_b32 v29, 0xffff0000, v12
    v_add_f32 v20, v20, v28
    v_add_f32 v21, v21, v29
    v_cvt_pk_bf16_f32 v12, v20, v21
    v_lshlrev_b32 v20, 16, v12
    v_and_b32 v21, 0xffff0000, v12
    v_mul_f32 v30, v30, v46
    v_mul_f32 v31, v31, v47
    v_cvt_pk_bf16_f32 v12, v30, v31
    v_lshlrev_b32 v30, 16, v12
    v_and_b32 v31, 0xffff0000, v12
    v_add_f32 v22, v22, v30
    v_add_f32 v23, v23, v31
    v_cvt_pk_bf16_f32 v12, v22, v23
    v_lshlrev_b32 v22, 16, v12
    v_and_b32 v23, 0xffff0000, v12
    v_cvt_pk_bf16_f32 v120, v16, v17
    v_cvt_pk_bf16_f32 v121, v18, v19
    v_cvt_pk_bf16_f32 v122, v20, v21
    v_cvt_pk_bf16_f32 v123, v22, v23
    buffer_store_dwordx4 v[120:123], v3, s[12:15], s26 offen offset:3072
    v_add_f32 v32, v16, v17
    v_add_f32 v32, v32, v18
    v_add_f32 v32, v32, v19
    v_add_f32 v32, v32, v20
    v_add_f32 v32, v32, v21
    v_add_f32 v32, v32, v22
    v_add_f32 v32, v32, v23
    s_nop 1
    v_add_f32_dpp v32, v32, v32 quad_perm:[1,0,3,2] row_mask:0xf bank_mask:0xf
    s_nop 1
    v_add_f32_dpp v32, v32, v32 quad_perm:[2,3,0,1] row_mask:0xf bank_mask:0xf
    s_nop 1
    v_add_f32_dpp v32, v32, v32 row_half_mirror row_mask:0xf bank_mask:0xf
    s_nop 1
    v_add_f32_dpp v32, v32, v32 row_mirror row_mask:0xf bank_mask:0xf
    v_mov_b32 v33, v32
    v_mov_b32 v34, v32
    s_nop 1
    v_permlane16_swap_b32 v33, v34
    s_nop 1
    v_add_f32 v32, v33, v34
    v_mov_b32 v33, v32
    v_mov_b32 v34, v32
    s_nop 1
    v_permlane32_swap_b32 v33, v34
    s_nop 1
    v_add_f32 v32, v33, v34
    v_mul_f32 v35, 0x3b000000, v32
    v_sub_f32 v33, v16, v35
    v_mul_f32 v32, v33, v33
    v_sub_f32 v33, v17, v35
    v_fmac_f32 v32, v33, v33
    v_sub_f32 v33, v18, v35
    v_fmac_f32 v32, v33, v33
    v_sub_f32 v33, v19, v35
    v_fmac_f32 v32, v33, v33
    v_sub_f32 v33, v20, v35
    v_fmac_f32 v32, v33, v33
    v_sub_f32 v33, v21, v35
    v_fmac_f32 v32, v33, v33
    v_sub_f32 v33, v22, v35
    v_fmac_f32 v32, v33, v33
    v_sub_f32 v33, v23, v35
    v_fmac_f32 v32, v33, v33
    s_nop 1
    v_add_f32_dpp v32, v32, v32 quad_perm:[1,0,3,2] row_mask:0xf bank_mask:0xf
    s_nop 1
    v_add_f32_dpp v32, v32, v32 quad_perm:[2,3,0,1] row_mask:0xf bank_mask:0xf
    s_nop 1
    v_add_f32_dpp v32, v32, v32 row_half_mirror row_mask:0xf bank_mask:0xf
    s_nop 1
    v_add_f32_dpp v32, v32, v32 row_mirror row_mask:0xf bank_mask:0xf
    v_mov_b32 v33, v32
    v_mov_b32 v34, v32
    s_nop 1
    v_permlane16_swap_b32 v33, v34
    s_nop 1
    v_add_f32 v32, v33, v34
    v_mov_b32 v33, v32
    v_mov_b32 v34, v32
    s_nop 1
    v_permlane32_swap_b32 v33, v34
    s_nop 1
    v_add_f32 v32, v33, v34
    v_mul_f32 v36, 0x3b000000, v32
    v_cvt_pk_bf16_f32 v33, v35, v36
    v_lshlrev_b32 v35, 16, v33
    v_and_b32 v36, 0xffff0000, v33
    v_add_f32 v37, 0x3727c5ac, v36
    v_cvt_pk_bf16_f32 v33, v37, v37
    v_lshlrev_b32 v37, 16, v33
    v_sqrt_f32 v37, v37
    s_nop 0
    v_cvt_pk_bf16_f32 v33, v37, v37
    v_lshlrev_b32 v37, 16, v33
    v_rcp_f32 v37, v37
    v_sub_f32 v16, v16, v35
    v_sub_f32 v17, v17, v35
    v_cvt_pk_bf16_f32 v33, v16, v17
    v_lshlrev_b32 v16, 16, v33
    v_and_b32 v17, 0xffff0000, v33
    v_mul_f32 v16, v16, v37
    v_mul_f32 v17, v17, v37
    v_cvt_pk_bf16_f32 v33, v16, v17
    v_lshlrev_b32 v16, 16, v33
    v_and_b32 v17, 0xffff0000, v33
    v_sub_f32 v18, v18, v35
    v_sub_f32 v19, v19, v35
    v_cvt_pk_bf16_f32 v33, v18, v19
    v_lshlrev_b32 v18, 16, v33
    v_and_b32 v19, 0xffff0000, v33
    v_mul_f32 v18, v18, v37
    v_mul_f32 v19, v19, v37
    v_cvt_pk_bf16_f32 v33, v18, v19
    v_lshlrev_b32 v18, 16, v33
    v_and_b32 v19, 0xffff0000, v33
    v_sub_f32 v20, v20, v35
    v_sub_f32 v21, v21, v35
    v_cvt_pk_bf16_f32 v33, v20, v21
    v_lshlrev_b32 v20, 16, v33
    v_and_b32 v21, 0xffff0000, v33
    v_mul_f32 v20, v20, v37
    v_mul_f32 v21, v21, v37
    v_cvt_pk_bf16_f32 v33, v20, v21
    v_lshlrev_b32 v20, 16, v33
    v_and_b32 v21, 0xffff0000, v33
    v_sub_f32 v22, v22, v35
    v_sub_f32 v23, v23, v35
    v_cvt_pk_bf16_f32 v33, v22, v23
    v_lshlrev_b32 v22, 16, v33
    v_and_b32 v23, 0xffff0000, v33
    v_mul_f32 v22, v22, v37
    v_mul_f32 v23, v23, v37
    v_cvt_pk_bf16_f32 v33, v22, v23
    v_lshlrev_b32 v22, 16, v33
    v_and_b32 v23, 0xffff0000, v33
    v_mul_f32 v16, v16, v56
    v_mul_f32 v17, v17, v57
    v_cvt_pk_bf16_f32 v12, v16, v17
    v_lshlrev_b32 v16, 16, v12
    v_and_b32 v17, 0xffff0000, v12
    v_add_f32 v16, v16, v48
    v_add_f32 v17, v17, v49
    v_cvt_pk_bf16_f32 v12, v16, v17
    v_lshlrev_b32 v16, 16, v12
    v_and_b32 v17, 0xffff0000, v12
    v_mul_f32 v18, v18, v58
    v_mul_f32 v19, v19, v59
    v_cvt_pk_bf16_f32 v12, v18, v19
    v_lshlrev_b32 v18, 16, v12
    v_and_b32 v19, 0xffff0000, v12
    v_add_f32 v18, v18, v50
    v_add_f32 v19, v19, v51
    v_cvt_pk_bf16_f32 v12, v18, v19
    v_lshlrev_b32 v18, 16, v12
    v_and_b32 v19, 0xffff0000, v12
    v_mul_f32 v20, v20, v60
    v_mul_f32 v21, v21, v61
    v_cvt_pk_bf16_f32 v12, v20, v21
    v_lshlrev_b32 v20, 16, v12
    v_and_b32 v21, 0xffff0000, v12
    v_add_f32 v20, v20, v52
    v_add_f32 v21, v21, v53
    v_cvt_pk_bf16_f32 v12, v20, v21
    v_lshlrev_b32 v20, 16, v12
    v_and_b32 v21, 0xffff0000, v12
    v_mul_f32 v22, v22, v62
    v_mul_f32 v23, v23, v63
    v_cvt_pk_bf16_f32 v12, v22, v23
    v_lshlrev_b32 v22, 16, v12
    v_and_b32 v23, 0xffff0000, v12
    v_add_f32 v22, v22, v54
    v_add_f32 v23, v23, v55
    v_cvt_pk_bf16_f32 v12, v22, v23
    v_lshlrev_b32 v22, 16, v12
    v_and_b32 v23, 0xffff0000, v12
    v_add_f32 v32, v16, v17
    v_add_f32 v32, v32, v18
    v_add_f32 v32, v32, v19
    v_add_f32 v32, v32, v20
    v_add_f32 v32, v32, v21
    v_add_f32 v32, v32, v22
    v_add_f32 v32, v32, v23
    s_nop 1
    v_add_f32_dpp v32, v32, v32 quad_perm:[1,0,3,2] row_mask:0xf bank_mask:0xf
    s_nop 1
    v_add_f32_dpp v32, v32, v32 quad_perm:[2,3,0,1] row_mask:0xf bank_mask:0xf
    s_nop 1
    v_add_f32_dpp v32, v32, v32 row_half_mirror row_mask:0xf bank_mask:0xf
    s_nop 1
    v_add_f32_dpp v32, v32, v32 row_mirror row_mask:0xf bank_mask:0xf
    v_mov_b32 v33, v32
    v_mov_b32 v34, v32
    s_nop 1
    v_permlane16_swap_b32 v33, v34
    s_nop 1
    v_add_f32 v32, v33, v34
    v_mov_b32 v33, v32
    v_mov_b32 v34, v32
    s_nop 1
    v_permlane32_swap_b32 v33, v34
    s_nop 1
    v_add_f32 v32, v33, v34
    v_mul_f32 v35, 0x3b000000, v32
    v_sub_f32 v33, v16, v35
    v_mul_f32 v32, v33, v33
    v_sub_f32 v33, v17, v35
    v_fmac_f32 v32, v33, v33
    v_sub_f32 v33, v18, v35
    v_fmac_f32 v32, v33, v33
    v_sub_f32 v33, v19, v35
    v_fmac_f32 v32, v33, v33
    v_sub_f32 v33, v20, v35
    v_fmac_f32 v32, v33, v33
    v_sub_f32 v33, v21, v35
    v_fmac_f32 v32, v33, v33
    v_sub_f32 v33, v22, v35
    v_fmac_f32 v32, v33, v33
    v_sub_f32 v33, v23, v35
    v_fmac_f32 v32, v33, v33
    s_nop 1
    v_add_f32_dpp v32, v32, v32 quad_perm:[1,0,3,2] row_mask:0xf bank_mask:0xf
    s_nop 1
    v_add_f32_dpp v32, v32, v32 quad_perm:[2,3,0,1] row_mask:0xf bank_mask:0xf
    s_nop 1
    v_add_f32_dpp v32, v32, v32 row_half_mirror row_mask:0xf bank_mask:0xf
    s_nop 1
    v_add_f32_dpp v32, v32, v32 row_mirror row_mask:0xf bank_mask:0xf
    v_mov_b32 v33, v32
    v_mov_b32 v34, v32
    s_nop 1
    v_permlane16_swap_b32 v33, v34
    s_nop 1
    v_add_f32 v32, v33, v34
    v_mov_b32 v33, v32
    v_mov_b32 v34, v32
    s_nop 1
    v_permlane32_swap_b32 v33, v34
    s_nop 1
    v_add_f32 v32, v33, v34
    v_mul_f32 v36, 0x3b000000, v32
    v_cvt_pk_bf16_f32 v33, v35, v36
    v_lshlrev_b32 v35, 16, v33
    v_and_b32 v36, 0xffff0000, v33
    v_add_f32 v37, 0x3727c5ac, v36
    v_cvt_pk_bf16_f32 v33, v37, v37
    v_lshlrev_b32 v37, 16, v33
    v_sqrt_f32 v37, v37
    s_nop 0
    v_cvt_pk_bf16_f32 v33, v37, v37
    v_lshlrev_b32 v37, 16, v33
    v_rcp_f32 v37, v37
    v_sub_f32 v16, v16, v35
    v_sub_f32 v17, v17, v35
    v_cvt_pk_bf16_f32 v33, v16, v17
    v_lshlrev_b32 v16, 16, v33
    v_and_b32 v17, 0xffff0000, v33
    v_mul_f32 v16, v16, v37
    v_mul_f32 v17, v17, v37
    v_cvt_pk_bf16_f32 v33, v16, v17
    v_lshlrev_b32 v16, 16, v33
    v_and_b32 v17, 0xffff0000, v33
    v_sub_f32 v18, v18, v35
    v_sub_f32 v19, v19, v35
    v_cvt_pk_bf16_f32 v33, v18, v19
    v_lshlrev_b32 v18, 16, v33
    v_and_b32 v19, 0xffff0000, v33
    v_mul_f32 v18, v18, v37
    v_mul_f32 v19, v19, v37
    v_cvt_pk_bf16_f32 v33, v18, v19
    v_lshlrev_b32 v18, 16, v33
    v_and_b32 v19, 0xffff0000, v33
    v_sub_f32 v20, v20, v35
    v_sub_f32 v21, v21, v35
    v_cvt_pk_bf16_f32 v33, v20, v21
    v_lshlrev_b32 v20, 16, v33
    v_and_b32 v21, 0xffff0000, v33
    v_mul_f32 v20, v20, v37
    v_mul_f32 v21, v21, v37
    v_cvt_pk_bf16_f32 v33, v20, v21
    v_lshlrev_b32 v20, 16, v33
    v_and_b32 v21, 0xffff0000, v33
    v_sub_f32 v22, v22, v35
    v_sub_f32 v23, v23, v35
    v_cvt_pk_bf16_f32 v33, v22, v23
    v_lshlrev_b32 v22, 16, v33
    v_and_b32 v23, 0xffff0000, v33
    v_mul_f32 v22, v22, v37
    v_mul_f32 v23, v23, v37
    v_cvt_pk_bf16_f32 v33, v22, v23
    v_lshlrev_b32 v22, 16, v33
    v_and_b32 v23, 0xffff0000, v33
    v_cvt_pk_bf16_f32 v124, v16, v17
    v_cvt_pk_bf16_f32 v125, v18, v19
    v_cvt_pk_bf16_f32 v126, v20, v21
    v_cvt_pk_bf16_f32 v127, v22, v23
    ds_write_b128 v6, v[124:127] offset:48
    s_waitcnt lgkmcnt(0)
    s_barrier
    s_lshl_b32 s29, s3, 12
    v_add_u32 v6, s29, v3
    ds_read_b128 v[64:67], v6 offset:0
    ds_read_b128 v[68:71], v6 offset:1024
    ds_read_b128 v[72:75], v6 offset:2048
    ds_read_b128 v[76:79], v6 offset:3072
    s_lshl_b32 s27, s2, 14
    s_add_u32 s27, s27, s29
    s_add_u32 s27, s27, 138412032
    s_waitcnt lgkmcnt(0)
    buffer_store_dwordx4 v[64:67], v3, s[12:15], s27 offen offset:0
    buffer_store_dwordx4 v[68:71], v3, s[12:15], s27 offen offset:1024
    buffer_store_dwordx4 v[72:75], v3, s[12:15], s27 offen offset:2048
    buffer_store_dwordx4 v[76:79], v3, s[12:15], s27 offen offset:3072
ln2_end:
    s_endpgm
.globl mlp1_kernel
.p2align 8
.type mlp1_kernel,@function
mlp1_kernel:
    s_cmp_ge_u32 s2, 224
    s_cbranch_scc1 mlp1_end
    s_load_dwordx2 s[4:5], s[0:1], 128
    s_load_dwordx2 s[10:11], s[0:1], 72
    v_lshrrev_b32 v1, 6, v0
    v_and_b32 v2, 63, v0
    s_nop 0
    v_readfirstlane_b32 s3, v1
    s_and_b32 s6, s2, 15
    s_lshr_b32 s7, s2, 4
    s_waitcnt lgkmcnt(0)
    s_mov_b32 s12, s4
    s_mov_b32 s13, s5
    s_and_b32 s13, s13, 0xffff
    s_mov_b32 s14, 268435455
    s_mov_b32 s15, 0x00020000
    s_mov_b32 s36, s10
    s_mov_b32 s37, s11
    s_and_b32 s37, s37, 0xffff
    s_mov_b32 s38, 3584
    s_mov_b32 s39, 0x00020000
    v_and_b32 v3, 15, v2
    v_lshrrev_b32 v4, 4, v2
    v_lshlrev_b32 v6, 4, v2
    v_lshlrev_b32 v5, 10, v3
    v_lshl_add_u32 v5, v4, 4, v5
    s_lshl_b32 s24, s6, 17
    s_lshl_b32 s25, s3, 15
    s_add_u32 s24, s24, s25
    s_add_u32 s24, s24, 138412032
    v_add_u32 v7, s25, v6
    buffer_load_dwordx4 v[64:67], v6, s[12:15], s24 offen offset:0
    buffer_load_dwordx4 v[68:71], v6, s[12:15], s24 offen offset:1024
    buffer_load_dwordx4 v[72:75], v6, s[12:15], s24 offen offset:2048
    buffer_load_dwordx4 v[76:79], v6, s[12:15], s24 offen offset:3072
    s_add_u32 s24, s24, 4096
    buffer_load_dwordx4 v[80:83], v6, s[12:15], s24 offen offset:0
    buffer_load_dwordx4 v[84:87], v6, s[12:15], s24 offen offset:1024
    buffer_load_dwordx4 v[88:91], v6, s[12:15], s24 offen offset:2048
    buffer_load_dwordx4 v[92:95], v6, s[12:15], s24 offen offset:3072
    s_add_u32 s24, s24, 4096
    buffer_load_dwordx4 v[96:99], v6, s[12:15], s24 offen offset:0
    buffer_load_dwordx4 v[100:103], v6, s[12:15], s24 offen offset:1024
    buffer_load_dwordx4 v[104:107], v6, s[12:15], s24 offen offset:2048
    buffer_load_dwordx4 v[108:111], v6, s[12:15], s24 offen offset:3072
    s_add_u32 s24, s24, 4096
    buffer_load_dwordx4 v[112:115], v6, s[12:15], s24 offen offset:0
    buffer_load_dwordx4 v[116:119], v6, s[12:15], s24 offen offset:1024
    buffer_load_dwordx4 v[120:123], v6, s[12:15], s24 offen offset:2048
    buffer_load_dwordx4 v[124:127], v6, s[12:15], s24 offen offset:3072
    s_add_u32 s24, s24, 4096
    buffer_load_dwordx4 v[128:131], v6, s[12:15], s24 offen offset:0
    buffer_load_dwordx4 v[132:135], v6, s[12:15], s24 offen offset:1024
    buffer_load_dwordx4 v[136:139], v6, s[12:15], s24 offen offset:2048
    buffer_load_dwordx4 v[140:143], v6, s[12:15], s24 offen offset:3072
    s_add_u32 s24, s24, 4096
    buffer_load_dwordx4 v[144:147], v6, s[12:15], s24 offen offset:0
    buffer_load_dwordx4 v[148:151], v6, s[12:15], s24 offen offset:1024
    buffer_load_dwordx4 v[152:155], v6, s[12:15], s24 offen offset:2048
    buffer_load_dwordx4 v[156:159], v6, s[12:15], s24 offen offset:3072
    s_add_u32 s24, s24, 4096
    buffer_load_dwordx4 v[160:163], v6, s[12:15], s24 offen offset:0
    buffer_load_dwordx4 v[164:167], v6, s[12:15], s24 offen offset:1024
    buffer_load_dwordx4 v[168:171], v6, s[12:15], s24 offen offset:2048
    buffer_load_dwordx4 v[172:175], v6, s[12:15], s24 offen offset:3072
    s_add_u32 s24, s24, 4096
    buffer_load_dwordx4 v[176:179], v6, s[12:15], s24 offen offset:0
    buffer_load_dwordx4 v[180:183], v6, s[12:15], s24 offen offset:1024
    buffer_load_dwordx4 v[184:187], v6, s[12:15], s24 offen offset:2048
    buffer_load_dwordx4 v[188:191], v6, s[12:15], s24 offen offset:3072
    s_add_u32 s24, s24, 4096
    s_lshl_b32 s26, s7, 2
    s_add_u32 s26, s26, s3
    s_lshl_b32 s28, s26, 15
    s_add_u32 s28, s28, 20971520
    s_add_u32 s29, s28, 16384
    buffer_load_dwordx4 a[0:3], v6, s[12:15], s28 offen offset:0
    buffer_load_dwordx4 a[4:7], v6, s[12:15], s29 offen offset:0
    buffer_load_dwordx4 a[8:11], v6, s[12:15], s28 offen offset:1024
    buffer_load_dwordx4 a[12:15], v6, s[12:15], s29 offen offset:1024
    buffer_load_dwordx4 a[16:19], v6, s[12:15], s28 offen offset:2048
    buffer_load_dwordx4 a[20:23], v6, s[12:15], s29 offen offset:2048
    buffer_load_dwordx4 a[24:27], v6, s[12:15], s28 offen offset:3072
    buffer_load_dwordx4 a[28:31], v6, s[12:15], s29 offen offset:3072
    s_add_u32 s28, s28, 4096
    s_add_u32 s29, s29, 4096
    buffer_load_dwordx4 a[32:35], v6, s[12:15], s28 offen offset:0
    buffer_load_dwordx4 a[36:39], v6, s[12:15], s29 offen offset:0
    buffer_load_dwordx4 a[40:43], v6, s[12:15], s28 offen offset:1024
    buffer_load_dwordx4 a[44:47], v6, s[12:15], s29 offen offset:1024
    buffer_load_dwordx4 a[48:51], v6, s[12:15], s28 offen offset:2048
    buffer_load_dwordx4 a[52:55], v6, s[12:15], s29 offen offset:2048
    buffer_load_dwordx4 a[56:59], v6, s[12:15], s28 offen offset:3072
    buffer_load_dwordx4 a[60:63], v6, s[12:15], s29 offen offset:3072
    s_add_u32 s28, s28, 4096
    s_add_u32 s29, s29, 4096
    buffer_load_dwordx4 a[64:67], v6, s[12:15], s28 offen offset:0
    buffer_load_dwordx4 a[68:71], v6, s[12:15], s29 offen offset:0
    buffer_load_dwordx4 a[72:75], v6, s[12:15], s28 offen offset:1024
    buffer_load_dwordx4 a[76:79], v6, s[12:15], s29 offen offset:1024
    buffer_load_dwordx4 a[80:83], v6, s[12:15], s28 offen offset:2048
    buffer_load_dwordx4 a[84:87], v6, s[12:15], s29 offen offset:2048
    buffer_load_dwordx4 a[88:91], v6, s[12:15], s28 offen offset:3072
    buffer_load_dwordx4 a[92:95], v6, s[12:15], s29 offen offset:3072
    s_add_u32 s28, s28, 4096
    s_add_u32 s29, s29, 4096
    buffer_load_dwordx4 a[96:99], v6, s[12:15], s28 offen offset:0
    buffer_load_dwordx4 a[100:103], v6, s[12:15], s29 offen offset:0
    buffer_load_dwordx4 a[104:107], v6, s[12:15], s28 offen offset:1024
    buffer_load_dwordx4 a[108:111], v6, s[12:15], s29 offen offset:1024
    buffer_load_dwordx4 a[112:115], v6, s[12:15], s28 offen offset:2048
    buffer_load_dwordx4 a[116:119], v6, s[12:15], s29 offen offset:2048
    buffer_load_dwordx4 a[120:123], v6, s[12:15], s28 offen offset:3072
    buffer_load_dwordx4 a[124:127], v6, s[12:15], s29 offen offset:3072
    s_add_u32 s28, s28, 4096
    s_add_u32 s29, s29, 4096
    s_lshl_b32 s24, s26, 6
    v_lshlrev_b32 v10, 3, v4
    buffer_load_dwordx2 v[12:13], v10, s[36:39], s24 offen
    buffer_load_dwordx2 v[14:15], v10, s[36:39], s24 offen offset:32
    s_waitcnt vmcnt(63)
    ds_write_b128 v7, v[64:67] offset:0
    s_waitcnt vmcnt(63)
    ds_write_b128 v7, v[68:71] offset:1024
    s_waitcnt vmcnt(63)
    ds_write_b128 v7, v[72:75] offset:2048
    s_waitcnt vmcnt(62)
    ds_write_b128 v7, v[76:79] offset:3072
    s_waitcnt vmcnt(61)
    ds_write_b128 v7, v[80:83] offset:4096
    s_waitcnt vmcnt(60)
    ds_write_b128 v7, v[84:87] offset:5120
    s_waitcnt vmcnt(59)
    ds_write_b128 v7, v[88:91] offset:6144
    s_waitcnt vmcnt(58)
    ds_write_b128 v7, v[92:95] offset:7168
    s_waitcnt vmcnt(57)
    ds_write_b128 v7, v[96:99] offset:8192
    s_waitcnt vmcnt(56)
    ds_write_b128 v7, v[100:103] offset:9216
    s_waitcnt vmcnt(55)
    ds_write_b128 v7, v[104:107] offset:10240
    s_waitcnt vmcnt(54)
    ds_write_b128 v7, v[108:111] offset:11264
    s_waitcnt vmcnt(53)
    ds_write_b128 v7, v[112:115] offset:12288
    s_waitcnt vmcnt(52)
    ds_write_b128 v7, v[116:119] offset:13312
    s_waitcnt vmcnt(51)
    ds_write_b128 v7, v[120:123] offset:14336
    s_waitcnt vmcnt(50)
    ds_write_b128 v7, v[124:127] offset:15360
    s_waitcnt vmcnt(49)
    ds_write_b128 v7, v[128:131] offset:16384
    s_waitcnt vmcnt(48)
    ds_write_b128 v7, v[132:135] offset:17408
    s_waitcnt vmcnt(47)
    ds_write_b128 v7, v[136:139] offset:18432
    s_waitcnt vmcnt(46)
    ds_write_b128 v7, v[140:143] offset:19456
    s_waitcnt vmcnt(45)
    ds_write_b128 v7, v[144:147] offset:20480
    s_waitcnt vmcnt(44)
    ds_write_b128 v7, v[148:151] offset:21504
    s_waitcnt vmcnt(43)
    ds_write_b128 v7, v[152:155] offset:22528
    s_waitcnt vmcnt(42)
    ds_write_b128 v7, v[156:159] offset:23552
    s_waitcnt vmcnt(41)
    ds_write_b128 v7, v[160:163] offset:24576
    s_waitcnt vmcnt(40)
    ds_write_b128 v7, v[164:167] offset:25600
    s_waitcnt vmcnt(39)
    ds_write_b128 v7, v[168:171] offset:26624
    s_waitcnt vmcnt(38)
    ds_write_b128 v7, v[172:175] offset:27648
    s_waitcnt vmcnt(37)
    ds_write_b128 v7, v[176:179] offset:28672
    s_waitcnt vmcnt(36)
    ds_write_b128 v7, v[180:183] offset:29696
    s_waitcnt vmcnt(35)
    ds_write_b128 v7, v[184:187] offset:30720
    s_waitcnt vmcnt(34)
    ds_write_b128 v7, v[188:191] offset:31744
    s_waitcnt lgkmcnt(0)
    s_barrier
    v_add_u32 v9, 0x10000, v6
    ds_read_b128 v[64:67], v6 offset:0
    ds_read_b128 v[68:71], v6 offset:16384
    ds_read_b128 v[72:75], v6 offset:32768
    ds_read_b128 v[76:79], v6 offset:49152
    ds_read_b128 v[80:83], v9 offset:0
    ds_read_b128 v[84:87], v9 offset:16384
    ds_read_b128 v[88:91], v9 offset:32768
    ds_read_b128 v[92:95], v9 offset:49152
    ds_read_b128 v[96:99], v6 offset:1024
    ds_read_b128 v[100:103], v6 offset:17408
    ds_read_b128 v[104:107], v6 offset:33792
    ds_read_b128 v[108:111], v6 offset:50176
    ds_read_b128 v[112:115], v9 offset:1024
    ds_read_b128 v[116:119], v9 offset:17408
    ds_read_b128 v[120:123], v9 offset:33792
    ds_read_b128 v[124:127], v9 offset:50176
    s_waitcnt vmcnt(32) lgkmcnt(8)
    v_mfma_f32_16x16x32_bf16 v[128:131], a[0:3], v[64:67], 0
    v_mfma_f32_16x16x32_bf16 v[132:135], a[4:7], v[64:67], 0
    v_mfma_f32_16x16x32_bf16 v[136:139], a[0:3], v[68:71], 0
    v_mfma_f32_16x16x32_bf16 v[140:143], a[4:7], v[68:71], 0
    v_mfma_f32_16x16x32_bf16 v[144:147], a[0:3], v[72:75], 0
    v_mfma_f32_16x16x32_bf16 v[148:151], a[4:7], v[72:75], 0
    v_mfma_f32_16x16x32_bf16 v[152:155], a[0:3], v[76:79], 0
    v_mfma_f32_16x16x32_bf16 v[156:159], a[4:7], v[76:79], 0
    v_mfma_f32_16x16x32_bf16 v[160:163], a[0:3], v[80:83], 0
    v_mfma_f32_16x16x32_bf16 v[164:167], a[4:7], v[80:83], 0
    v_mfma_f32_16x16x32_bf16 v[168:171], a[0:3], v[84:87], 0
    v_mfma_f32_16x16x32_bf16 v[172:175], a[4:7], v[84:87], 0
    v_mfma_f32_16x16x32_bf16 v[176:179], a[0:3], v[88:91], 0
    v_mfma_f32_16x16x32_bf16 v[180:183], a[4:7], v[88:91], 0
    v_mfma_f32_16x16x32_bf16 v[184:187], a[0:3], v[92:95], 0
    v_mfma_f32_16x16x32_bf16 v[188:191], a[4:7], v[92:95], 0
    ds_read_b128 v[64:67], v6 offset:2048
    ds_read_b128 v[68:71], v6 offset:18432
    ds_read_b128 v[72:75], v6 offset:34816
    ds_read_b128 v[76:79], v6 offset:51200
    ds_read_b128 v[80:83], v9 offset:2048
    ds_read_b128 v[84:87], v9 offset:18432
    ds_read_b128 v[88:91], v9 offset:34816
    ds_read_b128 v[92:95], v9 offset:51200
    s_waitcnt vmcnt(30) lgkmcnt(8)
    v_mfma_f32_16x16x32_bf16 v[128:131], a[8:11], v[96:99], v[128:131]
    v_mfma_f32_16x16x32_bf16 v[132:135], a[12:15], v[96:99], v[132:135]
    v_mfma_f32_16x16x32_bf16 v[136:139], a[8:11], v[100:103], v[136:139]
    v_mfma_f32_16x16x32_bf16 v[140:143], a[12:15], v[100:103], v[140:143]
    v_mfma_f32_16x16x32_bf16 v[144:147], a[8:11], v[104:107], v[144:147]
    v_mfma_f32_16x16x32_bf16 v[148:151], a[12:15], v[104:107], v[148:151]
    v_mfma_f32_16x16x32_bf16 v[152:155], a[8:11], v[108:111], v[152:155]
    v_mfma_f32_16x16x32_bf16 v[156:159], a[12:15], v[108:111], v[156:159]
    v_mfma_f32_16x16x32_bf16 v[160:163], a[8:11], v[112:115], v[160:163]
    v_mfma_f32_16x16x32_bf16 v[164:167], a[12:15], v[112:115], v[164:167]
    v_mfma_f32_16x16x32_bf16 v[168:171], a[8:11], v[116:119], v[168:171]
    v_mfma_f32_16x16x32_bf16 v[172:175], a[12:15], v[116:119], v[172:175]
    v_mfma_f32_16x16x32_bf16 v[176:179], a[8:11], v[120:123], v[176:179]
    v_mfma_f32_16x16x32_bf16 v[180:183], a[12:15], v[120:123], v[180:183]
    v_mfma_f32_16x16x32_bf16 v[184:187], a[8:11], v[124:127], v[184:187]
    v_mfma_f32_16x16x32_bf16 v[188:191], a[12:15], v[124:127], v[188:191]
    ds_read_b128 v[96:99], v6 offset:3072
    ds_read_b128 v[100:103], v6 offset:19456
    ds_read_b128 v[104:107], v6 offset:35840
    ds_read_b128 v[108:111], v6 offset:52224
    ds_read_b128 v[112:115], v9 offset:3072
    ds_read_b128 v[116:119], v9 offset:19456
    ds_read_b128 v[120:123], v9 offset:35840
    ds_read_b128 v[124:127], v9 offset:52224
    s_waitcnt vmcnt(28) lgkmcnt(8)
    v_mfma_f32_16x16x32_bf16 v[128:131], a[16:19], v[64:67], v[128:131]
    v_mfma_f32_16x16x32_bf16 v[132:135], a[20:23], v[64:67], v[132:135]
    v_mfma_f32_16x16x32_bf16 v[136:139], a[16:19], v[68:71], v[136:139]
    v_mfma_f32_16x16x32_bf16 v[140:143], a[20:23], v[68:71], v[140:143]
    v_mfma_f32_16x16x32_bf16 v[144:147], a[16:19], v[72:75], v[144:147]
    v_mfma_f32_16x16x32_bf16 v[148:151], a[20:23], v[72:75], v[148:151]
    v_mfma_f32_16x16x32_bf16 v[152:155], a[16:19], v[76:79], v[152:155]
    v_mfma_f32_16x16x32_bf16 v[156:159], a[20:23], v[76:79], v[156:159]
    v_mfma_f32_16x16x32_bf16 v[160:163], a[16:19], v[80:83], v[160:163]
    v_mfma_f32_16x16x32_bf16 v[164:167], a[20:23], v[80:83], v[164:167]
    v_mfma_f32_16x16x32_bf16 v[168:171], a[16:19], v[84:87], v[168:171]
    v_mfma_f32_16x16x32_bf16 v[172:175], a[20:23], v[84:87], v[172:175]
    v_mfma_f32_16x16x32_bf16 v[176:179], a[16:19], v[88:91], v[176:179]
    v_mfma_f32_16x16x32_bf16 v[180:183], a[20:23], v[88:91], v[180:183]
    v_mfma_f32_16x16x32_bf16 v[184:187], a[16:19], v[92:95], v[184:187]
    v_mfma_f32_16x16x32_bf16 v[188:191], a[20:23], v[92:95], v[188:191]
    ds_read_b128 v[64:67], v6 offset:4096
    ds_read_b128 v[68:71], v6 offset:20480
    ds_read_b128 v[72:75], v6 offset:36864
    ds_read_b128 v[76:79], v6 offset:53248
    ds_read_b128 v[80:83], v9 offset:4096
    ds_read_b128 v[84:87], v9 offset:20480
    ds_read_b128 v[88:91], v9 offset:36864
    ds_read_b128 v[92:95], v9 offset:53248
    s_waitcnt vmcnt(26) lgkmcnt(8)
    v_mfma_f32_16x16x32_bf16 v[128:131], a[24:27], v[96:99], v[128:131]
    v_mfma_f32_16x16x32_bf16 v[132:135], a[28:31], v[96:99], v[132:135]
    v_mfma_f32_16x16x32_bf16 v[136:139], a[24:27], v[100:103], v[136:139]
    v_mfma_f32_16x16x32_bf16 v[140:143], a[28:31], v[100:103], v[140:143]
    v_mfma_f32_16x16x32_bf16 v[144:147], a[24:27], v[104:107], v[144:147]
    v_mfma_f32_16x16x32_bf16 v[148:151], a[28:31], v[104:107], v[148:151]
    v_mfma_f32_16x16x32_bf16 v[152:155], a[24:27], v[108:111], v[152:155]
    v_mfma_f32_16x16x32_bf16 v[156:159], a[28:31], v[108:111], v[156:159]
    v_mfma_f32_16x16x32_bf16 v[160:163], a[24:27], v[112:115], v[160:163]
    v_mfma_f32_16x16x32_bf16 v[164:167], a[28:31], v[112:115], v[164:167]
    v_mfma_f32_16x16x32_bf16 v[168:171], a[24:27], v[116:119], v[168:171]
    v_mfma_f32_16x16x32_bf16 v[172:175], a[28:31], v[116:119], v[172:175]
    v_mfma_f32_16x16x32_bf16 v[176:179], a[24:27], v[120:123], v[176:179]
    v_mfma_f32_16x16x32_bf16 v[180:183], a[28:31], v[120:123], v[180:183]
    v_mfma_f32_16x16x32_bf16 v[184:187], a[24:27], v[124:127], v[184:187]
    v_mfma_f32_16x16x32_bf16 v[188:191], a[28:31], v[124:127], v[188:191]
    ds_read_b128 v[96:99], v6 offset:5120
    ds_read_b128 v[100:103], v6 offset:21504
    ds_read_b128 v[104:107], v6 offset:37888
    ds_read_b128 v[108:111], v6 offset:54272
    ds_read_b128 v[112:115], v9 offset:5120
    ds_read_b128 v[116:119], v9 offset:21504
    ds_read_b128 v[120:123], v9 offset:37888
    ds_read_b128 v[124:127], v9 offset:54272
    s_waitcnt vmcnt(24) lgkmcnt(8)
    v_mfma_f32_16x16x32_bf16 v[128:131], a[32:35], v[64:67], v[128:131]
    v_mfma_f32_16x16x32_bf16 v[132:135], a[36:39], v[64:67], v[132:135]
    v_mfma_f32_16x16x32_bf16 v[136:139], a[32:35], v[68:71], v[136:139]
    v_mfma_f32_16x16x32_bf16 v[140:143], a[36:39], v[68:71], v[140:143]
    v_mfma_f32_16x16x32_bf16 v[144:147], a[32:35], v[72:75], v[144:147]
    v_mfma_f32_16x16x32_bf16 v[148:151], a[36:39], v[72:75], v[148:151]
    v_mfma_f32_16x16x32_bf16 v[152:155], a[32:35], v[76:79], v[152:155]
    v_mfma_f32_16x16x32_bf16 v[156:159], a[36:39], v[76:79], v[156:159]
    v_mfma_f32_16x16x32_bf16 v[160:163], a[32:35], v[80:83], v[160:163]
    v_mfma_f32_16x16x32_bf16 v[164:167], a[36:39], v[80:83], v[164:167]
    v_mfma_f32_16x16x32_bf16 v[168:171], a[32:35], v[84:87], v[168:171]
    v_mfma_f32_16x16x32_bf16 v[172:175], a[36:39], v[84:87], v[172:175]
    v_mfma_f32_16x16x32_bf16 v[176:179], a[32:35], v[88:91], v[176:179]
    v_mfma_f32_16x16x32_bf16 v[180:183], a[36:39], v[88:91], v[180:183]
    v_mfma_f32_16x16x32_bf16 v[184:187], a[32:35], v[92:95], v[184:187]
    v_mfma_f32_16x16x32_bf16 v[188:191], a[36:39], v[92:95], v[188:191]
    ds_read_b128 v[64:67], v6 offset:6144
    ds_read_b128 v[68:71], v6 offset:22528
    ds_read_b128 v[72:75], v6 offset:38912
    ds_read_b128 v[76:79], v6 offset:55296
    ds_read_b128 v[80:83], v9 offset:6144
    ds_read_b128 v[84:87], v9 offset:22528
    ds_read_b128 v[88:91], v9 offset:38912
    ds_read_b128 v[92:95], v9 offset:55296
    s_waitcnt vmcnt(22) lgkmcnt(8)
    v_mfma_f32_16x16x32_bf16 v[128:131], a[40:43], v[96:99], v[128:131]
    v_mfma_f32_16x16x32_bf16 v[132:135], a[44:47], v[96:99], v[132:135]
    v_mfma_f32_16x16x32_bf16 v[136:139], a[40:43], v[100:103], v[136:139]
    v_mfma_f32_16x16x32_bf16 v[140:143], a[44:47], v[100:103], v[140:143]
    v_mfma_f32_16x16x32_bf16 v[144:147], a[40:43], v[104:107], v[144:147]
    v_mfma_f32_16x16x32_bf16 v[148:151], a[44:47], v[104:107], v[148:151]
    v_mfma_f32_16x16x32_bf16 v[152:155], a[40:43], v[108:111], v[152:155]
    v_mfma_f32_16x16x32_bf16 v[156:159], a[44:47], v[108:111], v[156:159]
    v_mfma_f32_16x16x32_bf16 v[160:163], a[40:43], v[112:115], v[160:163]
    v_mfma_f32_16x16x32_bf16 v[164:167], a[44:47], v[112:115], v[164:167]
    v_mfma_f32_16x16x32_bf16 v[168:171], a[40:43], v[116:119], v[168:171]
    v_mfma_f32_16x16x32_bf16 v[172:175], a[44:47], v[116:119], v[172:175]
    v_mfma_f32_16x16x32_bf16 v[176:179], a[40:43], v[120:123], v[176:179]
    v_mfma_f32_16x16x32_bf16 v[180:183], a[44:47], v[120:123], v[180:183]
    v_mfma_f32_16x16x32_bf16 v[184:187], a[40:43], v[124:127], v[184:187]
    v_mfma_f32_16x16x32_bf16 v[188:191], a[44:47], v[124:127], v[188:191]
    ds_read_b128 v[96:99], v6 offset:7168
    ds_read_b128 v[100:103], v6 offset:23552
    ds_read_b128 v[104:107], v6 offset:39936
    ds_read_b128 v[108:111], v6 offset:56320
    ds_read_b128 v[112:115], v9 offset:7168
    ds_read_b128 v[116:119], v9 offset:23552
    ds_read_b128 v[120:123], v9 offset:39936
    ds_read_b128 v[124:127], v9 offset:56320
    s_waitcnt vmcnt(20) lgkmcnt(8)
    v_mfma_f32_16x16x32_bf16 v[128:131], a[48:51], v[64:67], v[128:131]
    v_mfma_f32_16x16x32_bf16 v[132:135], a[52:55], v[64:67], v[132:135]
    v_mfma_f32_16x16x32_bf16 v[136:139], a[48:51], v[68:71], v[136:139]
    v_mfma_f32_16x16x32_bf16 v[140:143], a[52:55], v[68:71], v[140:143]
    v_mfma_f32_16x16x32_bf16 v[144:147], a[48:51], v[72:75], v[144:147]
    v_mfma_f32_16x16x32_bf16 v[148:151], a[52:55], v[72:75], v[148:151]
    v_mfma_f32_16x16x32_bf16 v[152:155], a[48:51], v[76:79], v[152:155]
    v_mfma_f32_16x16x32_bf16 v[156:159], a[52:55], v[76:79], v[156:159]
    v_mfma_f32_16x16x32_bf16 v[160:163], a[48:51], v[80:83], v[160:163]
    v_mfma_f32_16x16x32_bf16 v[164:167], a[52:55], v[80:83], v[164:167]
    v_mfma_f32_16x16x32_bf16 v[168:171], a[48:51], v[84:87], v[168:171]
    v_mfma_f32_16x16x32_bf16 v[172:175], a[52:55], v[84:87], v[172:175]
    v_mfma_f32_16x16x32_bf16 v[176:179], a[48:51], v[88:91], v[176:179]
    v_mfma_f32_16x16x32_bf16 v[180:183], a[52:55], v[88:91], v[180:183]
    v_mfma_f32_16x16x32_bf16 v[184:187], a[48:51], v[92:95], v[184:187]
    v_mfma_f32_16x16x32_bf16 v[188:191], a[52:55], v[92:95], v[188:191]
    ds_read_b128 v[64:67], v6 offset:8192
    ds_read_b128 v[68:71], v6 offset:24576
    ds_read_b128 v[72:75], v6 offset:40960
    ds_read_b128 v[76:79], v6 offset:57344
    ds_read_b128 v[80:83], v9 offset:8192
    ds_read_b128 v[84:87], v9 offset:24576
    ds_read_b128 v[88:91], v9 offset:40960
    ds_read_b128 v[92:95], v9 offset:57344
    s_waitcnt vmcnt(18) lgkmcnt(8)
    v_mfma_f32_16x16x32_bf16 v[128:131], a[56:59], v[96:99], v[128:131]
    v_mfma_f32_16x16x32_bf16 v[132:135], a[60:63], v[96:99], v[132:135]
    v_mfma_f32_16x16x32_bf16 v[136:139], a[56:59], v[100:103], v[136:139]
    v_mfma_f32_16x16x32_bf16 v[140:143], a[60:63], v[100:103], v[140:143]
    v_mfma_f32_16x16x32_bf16 v[144:147], a[56:59], v[104:107], v[144:147]
    v_mfma_f32_16x16x32_bf16 v[148:151], a[60:63], v[104:107], v[148:151]
    v_mfma_f32_16x16x32_bf16 v[152:155], a[56:59], v[108:111], v[152:155]
    v_mfma_f32_16x16x32_bf16 v[156:159], a[60:63], v[108:111], v[156:159]
    v_mfma_f32_16x16x32_bf16 v[160:163], a[56:59], v[112:115], v[160:163]
    v_mfma_f32_16x16x32_bf16 v[164:167], a[60:63], v[112:115], v[164:167]
    v_mfma_f32_16x16x32_bf16 v[168:171], a[56:59], v[116:119], v[168:171]
    v_mfma_f32_16x16x32_bf16 v[172:175], a[60:63], v[116:119], v[172:175]
    v_mfma_f32_16x16x32_bf16 v[176:179], a[56:59], v[120:123], v[176:179]
    v_mfma_f32_16x16x32_bf16 v[180:183], a[60:63], v[120:123], v[180:183]
    v_mfma_f32_16x16x32_bf16 v[184:187], a[56:59], v[124:127], v[184:187]
    v_mfma_f32_16x16x32_bf16 v[188:191], a[60:63], v[124:127], v[188:191]
    ds_read_b128 v[96:99], v6 offset:9216
    ds_read_b128 v[100:103], v6 offset:25600
    ds_read_b128 v[104:107], v6 offset:41984
    ds_read_b128 v[108:111], v6 offset:58368
    ds_read_b128 v[112:115], v9 offset:9216
    ds_read_b128 v[116:119], v9 offset:25600
    ds_read_b128 v[120:123], v9 offset:41984
    ds_read_b128 v[124:127], v9 offset:58368
    s_waitcnt vmcnt(16) lgkmcnt(8)
    v_mfma_f32_16x16x32_bf16 v[128:131], a[64:67], v[64:67], v[128:131]
    v_mfma_f32_16x16x32_bf16 v[132:135], a[68:71], v[64:67], v[132:135]
    v_mfma_f32_16x16x32_bf16 v[136:139], a[64:67], v[68:71], v[136:139]
    v_mfma_f32_16x16x32_bf16 v[140:143], a[68:71], v[68:71], v[140:143]
    v_mfma_f32_16x16x32_bf16 v[144:147], a[64:67], v[72:75], v[144:147]
    v_mfma_f32_16x16x32_bf16 v[148:151], a[68:71], v[72:75], v[148:151]
    v_mfma_f32_16x16x32_bf16 v[152:155], a[64:67], v[76:79], v[152:155]
    v_mfma_f32_16x16x32_bf16 v[156:159], a[68:71], v[76:79], v[156:159]
    v_mfma_f32_16x16x32_bf16 v[160:163], a[64:67], v[80:83], v[160:163]
    v_mfma_f32_16x16x32_bf16 v[164:167], a[68:71], v[80:83], v[164:167]
    v_mfma_f32_16x16x32_bf16 v[168:171], a[64:67], v[84:87], v[168:171]
    v_mfma_f32_16x16x32_bf16 v[172:175], a[68:71], v[84:87], v[172:175]
    v_mfma_f32_16x16x32_bf16 v[176:179], a[64:67], v[88:91], v[176:179]
    v_mfma_f32_16x16x32_bf16 v[180:183], a[68:71], v[88:91], v[180:183]
    v_mfma_f32_16x16x32_bf16 v[184:187], a[64:67], v[92:95], v[184:187]
    v_mfma_f32_16x16x32_bf16 v[188:191], a[68:71], v[92:95], v[188:191]
    ds_read_b128 v[64:67], v6 offset:10240
    ds_read_b128 v[68:71], v6 offset:26624
    ds_read_b128 v[72:75], v6 offset:43008
    ds_read_b128 v[76:79], v6 offset:59392
    ds_read_b128 v[80:83], v9 offset:10240
    ds_read_b128 v[84:87], v9 offset:26624
    ds_read_b128 v[88:91], v9 offset:43008
    ds_read_b128 v[92:95], v9 offset:59392
    s_waitcnt vmcnt(14) lgkmcnt(8)
    v_mfma_f32_16x16x32_bf16 v[128:131], a[72:75], v[96:99], v[128:131]
    v_mfma_f32_16x16x32_bf16 v[132:135], a[76:79], v[96:99], v[132:135]
    v_mfma_f32_16x16x32_bf16 v[136:139], a[72:75], v[100:103], v[136:139]
    v_mfma_f32_16x16x32_bf16 v[140:143], a[76:79], v[100:103], v[140:143]
    v_mfma_f32_16x16x32_bf16 v[144:147], a[72:75], v[104:107], v[144:147]
    v_mfma_f32_16x16x32_bf16 v[148:151], a[76:79], v[104:107], v[148:151]
    v_mfma_f32_16x16x32_bf16 v[152:155], a[72:75], v[108:111], v[152:155]
    v_mfma_f32_16x16x32_bf16 v[156:159], a[76:79], v[108:111], v[156:159]
    v_mfma_f32_16x16x32_bf16 v[160:163], a[72:75], v[112:115], v[160:163]
    v_mfma_f32_16x16x32_bf16 v[164:167], a[76:79], v[112:115], v[164:167]
    v_mfma_f32_16x16x32_bf16 v[168:171], a[72:75], v[116:119], v[168:171]
    v_mfma_f32_16x16x32_bf16 v[172:175], a[76:79], v[116:119], v[172:175]
    v_mfma_f32_16x16x32_bf16 v[176:179], a[72:75], v[120:123], v[176:179]
    v_mfma_f32_16x16x32_bf16 v[180:183], a[76:79], v[120:123], v[180:183]
    v_mfma_f32_16x16x32_bf16 v[184:187], a[72:75], v[124:127], v[184:187]
    v_mfma_f32_16x16x32_bf16 v[188:191], a[76:79], v[124:127], v[188:191]
    ds_read_b128 v[96:99], v6 offset:11264
    ds_read_b128 v[100:103], v6 offset:27648
    ds_read_b128 v[104:107], v6 offset:44032
    ds_read_b128 v[108:111], v6 offset:60416
    ds_read_b128 v[112:115], v9 offset:11264
    ds_read_b128 v[116:119], v9 offset:27648
    ds_read_b128 v[120:123], v9 offset:44032
    ds_read_b128 v[124:127], v9 offset:60416
    s_waitcnt vmcnt(12) lgkmcnt(8)
    v_mfma_f32_16x16x32_bf16 v[128:131], a[80:83], v[64:67], v[128:131]
    v_mfma_f32_16x16x32_bf16 v[132:135], a[84:87], v[64:67], v[132:135]
    v_mfma_f32_16x16x32_bf16 v[136:139], a[80:83], v[68:71], v[136:139]
    v_mfma_f32_16x16x32_bf16 v[140:143], a[84:87], v[68:71], v[140:143]
    v_mfma_f32_16x16x32_bf16 v[144:147], a[80:83], v[72:75], v[144:147]
    v_mfma_f32_16x16x32_bf16 v[148:151], a[84:87], v[72:75], v[148:151]
    v_mfma_f32_16x16x32_bf16 v[152:155], a[80:83], v[76:79], v[152:155]
    v_mfma_f32_16x16x32_bf16 v[156:159], a[84:87], v[76:79], v[156:159]
    v_mfma_f32_16x16x32_bf16 v[160:163], a[80:83], v[80:83], v[160:163]
    v_mfma_f32_16x16x32_bf16 v[164:167], a[84:87], v[80:83], v[164:167]
    v_mfma_f32_16x16x32_bf16 v[168:171], a[80:83], v[84:87], v[168:171]
    v_mfma_f32_16x16x32_bf16 v[172:175], a[84:87], v[84:87], v[172:175]
    v_mfma_f32_16x16x32_bf16 v[176:179], a[80:83], v[88:91], v[176:179]
    v_mfma_f32_16x16x32_bf16 v[180:183], a[84:87], v[88:91], v[180:183]
    v_mfma_f32_16x16x32_bf16 v[184:187], a[80:83], v[92:95], v[184:187]
    v_mfma_f32_16x16x32_bf16 v[188:191], a[84:87], v[92:95], v[188:191]
    ds_read_b128 v[64:67], v6 offset:12288
    ds_read_b128 v[68:71], v6 offset:28672
    ds_read_b128 v[72:75], v6 offset:45056
    ds_read_b128 v[76:79], v6 offset:61440
    ds_read_b128 v[80:83], v9 offset:12288
    ds_read_b128 v[84:87], v9 offset:28672
    ds_read_b128 v[88:91], v9 offset:45056
    ds_read_b128 v[92:95], v9 offset:61440
    s_waitcnt vmcnt(10) lgkmcnt(8)
    v_mfma_f32_16x16x32_bf16 v[128:131], a[88:91], v[96:99], v[128:131]
    v_mfma_f32_16x16x32_bf16 v[132:135], a[92:95], v[96:99], v[132:135]
    v_mfma_f32_16x16x32_bf16 v[136:139], a[88:91], v[100:103], v[136:139]
    v_mfma_f32_16x16x32_bf16 v[140:143], a[92:95], v[100:103], v[140:143]
    v_mfma_f32_16x16x32_bf16 v[144:147], a[88:91], v[104:107], v[144:147]
    v_mfma_f32_16x16x32_bf16 v[148:151], a[92:95], v[104:107], v[148:151]
    v_mfma_f32_16x16x32_bf16 v[152:155], a[88:91], v[108:111], v[152:155]
    v_mfma_f32_16x16x32_bf16 v[156:159], a[92:95], v[108:111], v[156:159]
    v_mfma_f32_16x16x32_bf16 v[160:163], a[88:91], v[112:115], v[160:163]
    v_mfma_f32_16x16x32_bf16 v[164:167], a[92:95], v[112:115], v[164:167]
    v_mfma_f32_16x16x32_bf16 v[168:171], a[88:91], v[116:119], v[168:171]
    v_mfma_f32_16x16x32_bf16 v[172:175], a[92:95], v[116:119], v[172:175]
    v_mfma_f32_16x16x32_bf16 v[176:179], a[88:91], v[120:123], v[176:179]
    v_mfma_f32_16x16x32_bf16 v[180:183], a[92:95], v[120:123], v[180:183]
    v_mfma_f32_16x16x32_bf16 v[184:187], a[88:91], v[124:127], v[184:187]
    v_mfma_f32_16x16x32_bf16 v[188:191], a[92:95], v[124:127], v[188:191]
    ds_read_b128 v[96:99], v6 offset:13312
    ds_read_b128 v[100:103], v6 offset:29696
    ds_read_b128 v[104:107], v6 offset:46080
    ds_read_b128 v[108:111], v6 offset:62464
    ds_read_b128 v[112:115], v9 offset:13312
    ds_read_b128 v[116:119], v9 offset:29696
    ds_read_b128 v[120:123], v9 offset:46080
    ds_read_b128 v[124:127], v9 offset:62464
    s_waitcnt vmcnt(8) lgkmcnt(8)
    v_mfma_f32_16x16x32_bf16 v[128:131], a[96:99], v[64:67], v[128:131]
    v_mfma_f32_16x16x32_bf16 v[132:135], a[100:103], v[64:67], v[132:135]
    v_mfma_f32_16x16x32_bf16 v[136:139], a[96:99], v[68:71], v[136:139]
    v_mfma_f32_16x16x32_bf16 v[140:143], a[100:103], v[68:71], v[140:143]
    v_mfma_f32_16x16x32_bf16 v[144:147], a[96:99], v[72:75], v[144:147]
    v_mfma_f32_16x16x32_bf16 v[148:151], a[100:103], v[72:75], v[148:151]
    v_mfma_f32_16x16x32_bf16 v[152:155], a[96:99], v[76:79], v[152:155]
    v_mfma_f32_16x16x32_bf16 v[156:159], a[100:103], v[76:79], v[156:159]
    v_mfma_f32_16x16x32_bf16 v[160:163], a[96:99], v[80:83], v[160:163]
    v_mfma_f32_16x16x32_bf16 v[164:167], a[100:103], v[80:83], v[164:167]
    v_mfma_f32_16x16x32_bf16 v[168:171], a[96:99], v[84:87], v[168:171]
    v_mfma_f32_16x16x32_bf16 v[172:175], a[100:103], v[84:87], v[172:175]
    v_mfma_f32_16x16x32_bf16 v[176:179], a[96:99], v[88:91], v[176:179]
    v_mfma_f32_16x16x32_bf16 v[180:183], a[100:103], v[88:91], v[180:183]
    v_mfma_f32_16x16x32_bf16 v[184:187], a[96:99], v[92:95], v[184:187]
    v_mfma_f32_16x16x32_bf16 v[188:191], a[100:103], v[92:95], v[188:191]
    ds_read_b128 v[64:67], v6 offset:14336
    ds_read_b128 v[68:71], v6 offset:30720
    ds_read_b128 v[72:75], v6 offset:47104
    ds_read_b128 v[76:79], v6 offset:63488
    ds_read_b128 v[80:83], v9 offset:14336
    ds_read_b128 v[84:87], v9 offset:30720
    ds_read_b128 v[88:91], v9 offset:47104
    ds_read_b128 v[92:95], v9 offset:63488
    s_waitcnt vmcnt(6) lgkmcnt(8)
    v_mfma_f32_16x16x32_bf16 v[128:131], a[104:107], v[96:99], v[128:131]
    v_mfma_f32_16x16x32_bf16 v[132:135], a[108:111], v[96:99], v[132:135]
    v_mfma_f32_16x16x32_bf16 v[136:139], a[104:107], v[100:103], v[136:139]
    v_mfma_f32_16x16x32_bf16 v[140:143], a[108:111], v[100:103], v[140:143]
    v_mfma_f32_16x16x32_bf16 v[144:147], a[104:107], v[104:107], v[144:147]
    v_mfma_f32_16x16x32_bf16 v[148:151], a[108:111], v[104:107], v[148:151]
    v_mfma_f32_16x16x32_bf16 v[152:155], a[104:107], v[108:111], v[152:155]
    v_mfma_f32_16x16x32_bf16 v[156:159], a[108:111], v[108:111], v[156:159]
    v_mfma_f32_16x16x32_bf16 v[160:163], a[104:107], v[112:115], v[160:163]
    v_mfma_f32_16x16x32_bf16 v[164:167], a[108:111], v[112:115], v[164:167]
    v_mfma_f32_16x16x32_bf16 v[168:171], a[104:107], v[116:119], v[168:171]
    v_mfma_f32_16x16x32_bf16 v[172:175], a[108:111], v[116:119], v[172:175]
    v_mfma_f32_16x16x32_bf16 v[176:179], a[104:107], v[120:123], v[176:179]
    v_mfma_f32_16x16x32_bf16 v[180:183], a[108:111], v[120:123], v[180:183]
    v_mfma_f32_16x16x32_bf16 v[184:187], a[104:107], v[124:127], v[184:187]
    v_mfma_f32_16x16x32_bf16 v[188:191], a[108:111], v[124:127], v[188:191]
    ds_read_b128 v[96:99], v6 offset:15360
    ds_read_b128 v[100:103], v6 offset:31744
    ds_read_b128 v[104:107], v6 offset:48128
    ds_read_b128 v[108:111], v6 offset:64512
    ds_read_b128 v[112:115], v9 offset:15360
    ds_read_b128 v[116:119], v9 offset:31744
    ds_read_b128 v[120:123], v9 offset:48128
    ds_read_b128 v[124:127], v9 offset:64512
    s_waitcnt vmcnt(4) lgkmcnt(8)
    v_mfma_f32_16x16x32_bf16 v[128:131], a[112:115], v[64:67], v[128:131]
    v_mfma_f32_16x16x32_bf16 v[132:135], a[116:119], v[64:67], v[132:135]
    v_mfma_f32_16x16x32_bf16 v[136:139], a[112:115], v[68:71], v[136:139]
    v_mfma_f32_16x16x32_bf16 v[140:143], a[116:119], v[68:71], v[140:143]
    v_mfma_f32_16x16x32_bf16 v[144:147], a[112:115], v[72:75], v[144:147]
    v_mfma_f32_16x16x32_bf16 v[148:151], a[116:119], v[72:75], v[148:151]
    v_mfma_f32_16x16x32_bf16 v[152:155], a[112:115], v[76:79], v[152:155]
    v_mfma_f32_16x16x32_bf16 v[156:159], a[116:119], v[76:79], v[156:159]
    v_mfma_f32_16x16x32_bf16 v[160:163], a[112:115], v[80:83], v[160:163]
    v_mfma_f32_16x16x32_bf16 v[164:167], a[116:119], v[80:83], v[164:167]
    v_mfma_f32_16x16x32_bf16 v[168:171], a[112:115], v[84:87], v[168:171]
    v_mfma_f32_16x16x32_bf16 v[172:175], a[116:119], v[84:87], v[172:175]
    v_mfma_f32_16x16x32_bf16 v[176:179], a[112:115], v[88:91], v[176:179]
    v_mfma_f32_16x16x32_bf16 v[180:183], a[116:119], v[88:91], v[180:183]
    v_mfma_f32_16x16x32_bf16 v[184:187], a[112:115], v[92:95], v[184:187]
    v_mfma_f32_16x16x32_bf16 v[188:191], a[116:119], v[92:95], v[188:191]
    s_waitcnt vmcnt(0) lgkmcnt(0)
    v_mfma_f32_16x16x32_bf16 v[128:131], a[120:123], v[96:99], v[128:131]
    v_mfma_f32_16x16x32_bf16 v[132:135], a[124:127], v[96:99], v[132:135]
    v_mfma_f32_16x16x32_bf16 v[136:139], a[120:123], v[100:103], v[136:139]
    v_mfma_f32_16x16x32_bf16 v[140:143], a[124:127], v[100:103], v[140:143]
    v_mfma_f32_16x16x32_bf16 v[144:147], a[120:123], v[104:107], v[144:147]
    v_mfma_f32_16x16x32_bf16 v[148:151], a[124:127], v[104:107], v[148:151]
    v_mfma_f32_16x16x32_bf16 v[152:155], a[120:123], v[108:111], v[152:155]
    v_mfma_f32_16x16x32_bf16 v[156:159], a[124:127], v[108:111], v[156:159]
    v_mfma_f32_16x16x32_bf16 v[160:163], a[120:123], v[112:115], v[160:163]
    v_mfma_f32_16x16x32_bf16 v[164:167], a[124:127], v[112:115], v[164:167]
    v_mfma_f32_16x16x32_bf16 v[168:171], a[120:123], v[116:119], v[168:171]
    v_mfma_f32_16x16x32_bf16 v[172:175], a[124:127], v[116:119], v[172:175]
    v_mfma_f32_16x16x32_bf16 v[176:179], a[120:123], v[120:123], v[176:179]
    v_mfma_f32_16x16x32_bf16 v[180:183], a[124:127], v[120:123], v[180:183]
    v_mfma_f32_16x16x32_bf16 v[184:187], a[120:123], v[124:127], v[184:187]
    v_mfma_f32_16x16x32_bf16 v[188:191], a[124:127], v[124:127], v[188:191]
    v_lshlrev_b32 v16, 16, v12
    v_and_b32 v17, 0xffff0000, v12
    v_lshlrev_b32 v18, 16, v13
    v_and_b32 v19, 0xffff0000, v13
    v_lshlrev_b32 v20, 16, v14
    v_and_b32 v21, 0xffff0000, v14
    v_lshlrev_b32 v22, 16, v15
    v_and_b32 v23, 0xffff0000, v15
    v_mov_b32 v10, v6
    s_mul_i32 s25, s6, 458752
    s_lshl_b32 s20, s26, 10
    s_add_u32 s25, s25, s20
    s_add_u32 s25, s25, 142606336
    s_mov_b32 s31, 0x3d372713
    s_mov_b32 s32, 0xc038aa3b
    s_mov_b32 s33, 0x3f4c422a
    v_cvt_pk_bf16_f32 v24, v128, v129
    v_lshlrev_b32 v128, 16, v24
    v_and_b32 v129, 0xffff0000, v24
    v_add_f32 v128, v128, v16
    v_add_f32 v129, v129, v17
    v_cvt_pk_bf16_f32 v24, v128, v129
    v_lshlrev_b32 v128, 16, v24
    v_and_b32 v129, 0xffff0000, v24
    v_mul_f32 v25, v128, v128
    v_mul_f32 v25, v25, v128
    v_fma_f32 v25, v25, s31, v128
    v_mul_f32 v25, s33, v25
    v_mul_f32 v25, s32, v25
    v_exp_f32 v25, v25
    v_mul_f32 v26, v129, v129
    v_mul_f32 v26, v26, v129
    v_fma_f32 v26, v26, s31, v129
    v_mul_f32 v26, s33, v26
    v_mul_f32 v26, s32, v26
    v_exp_f32 v26, v26
    v_add_f32 v25, 1.0, v25
    v_rcp_f32 v25, v25
    v_add_f32 v26, 1.0, v26
    v_rcp_f32 v26, v26
    v_mul_f32 v128, v128, v25
    v_mul_f32 v129, v129, v26
    v_cvt_pk_bf16_f32 v32, v128, v129
    v_cvt_pk_bf16_f32 v24, v130, v131
    v_lshlrev_b32 v130, 16, v24
    v_and_b32 v131, 0xffff0000, v24
    v_add_f32 v130, v130, v18
    v_add_f32 v131, v131, v19
    v_cvt_pk_bf16_f32 v24, v130, v131
    v_lshlrev_b32 v130, 16, v24
    v_and_b32 v131, 0xffff0000, v24
    v_mul_f32 v25, v130, v130
    v_mul_f32 v25, v25, v130
    v_fma_f32 v25, v25, s31, v130
    v_mul_f32 v25, s33, v25
    v_mul_f32 v25, s32, v25
    v_exp_f32 v25, v25
    v_mul_f32 v26, v131, v131
    v_mul_f32 v26, v26, v131
    v_fma_f32 v26, v26, s31, v131
    v_mul_f32 v26, s33, v26
    v_mul_f32 v26, s32, v26
    v_exp_f32 v26, v26
    v_add_f32 v25, 1.0, v25
    v_rcp_f32 v25, v25
    v_add_f32 v26, 1.0, v26
    v_rcp_f32 v26, v26
    v_mul_f32 v130, v130, v25
    v_mul_f32 v131, v131, v26
    v_cvt_pk_bf16_f32 v33, v130, v131
    v_cvt_pk_bf16_f32 v24, v132, v133
    v_lshlrev_b32 v132, 16, v24
    v_and_b32 v133, 0xffff0000, v24
    v_add_f32 v132, v132, v20
    v_add_f32 v133, v133, v21
    v_cvt_pk_bf16_f32 v24, v132, v133
    v_lshlrev_b32 v132, 16, v24
    v_and_b32 v133, 0xffff0000, v24
    v_mul_f32 v25, v132, v132
    v_mul_f32 v25, v25, v132
    v_fma_f32 v25, v25, s31, v132
    v_mul_f32 v25, s33, v25
    v_mul_f32 v25, s32, v25
    v_exp_f32 v25, v25
    v_mul_f32 v26, v133, v133
    v_mul_f32 v26, v26, v133
    v_fma_f32 v26, v26, s31, v133
    v_mul_f32 v26, s33, v26
    v_mul_f32 v26, s32, v26
    v_exp_f32 v26, v26
    v_add_f32 v25, 1.0, v25
    v_rcp_f32 v25, v25
    v_add_f32 v26, 1.0, v26
    v_rcp_f32 v26, v26
    v_mul_f32 v132, v132, v25
    v_mul_f32 v133, v133, v26
    v_cvt_pk_bf16_f32 v34, v132, v133
    v_cvt_pk_bf16_f32 v24, v134, v135
    v_lshlrev_b32 v134, 16, v24
    v_and_b32 v135, 0xffff0000, v24
    v_add_f32 v134, v134, v22
    v_add_f32 v135, v135, v23
    v_cvt_pk_bf16_f32 v24, v134, v135
    v_lshlrev_b32 v134, 16, v24
    v_and_b32 v135, 0xffff0000, v24
    v_mul_f32 v25, v134, v134
    v_mul_f32 v25, v25, v134
    v_fma_f32 v25, v25, s31, v134
    v_mul_f32 v25, s33, v25
    v_mul_f32 v25, s32, v25
    v_exp_f32 v25, v25
    v_mul_f32 v26, v135, v135
    v_mul_f32 v26, v26, v135
    v_fma_f32 v26, v26, s31, v135
    v_mul_f32 v26, s33, v26
    v_mul_f32 v26, s32, v26
    v_exp_f32 v26, v26
    v_add_f32 v25, 1.0, v25
    v_rcp_f32 v25, v25
    v_add_f32 v26, 1.0, v26
    v_rcp_f32 v26, v26
    v_mul_f32 v134, v134, v25
    v_mul_f32 v135, v135, v26
    v_cvt_pk_bf16_f32 v35, v134, v135
    buffer_store_dwordx4 v[32:35], v10, s[12:15], s25 offen
    s_add_u32 s25, s25, 57344
    v_cvt_pk_bf16_f32 v24, v136, v137
    v_lshlrev_b32 v136, 16, v24
    v_and_b32 v137, 0xffff0000, v24
    v_add_f32 v136, v136, v16
    v_add_f32 v137, v137, v17
    v_cvt_pk_bf16_f32 v24, v136, v137
    v_lshlrev_b32 v136, 16, v24
    v_and_b32 v137, 0xffff0000, v24
    v_mul_f32 v25, v136, v136
    v_mul_f32 v25, v25, v136
    v_fma_f32 v25, v25, s31, v136
    v_mul_f32 v25, s33, v25
    v_mul_f32 v25, s32, v25
    v_exp_f32 v25, v25
    v_mul_f32 v26, v137, v137
    v_mul_f32 v26, v26, v137
    v_fma_f32 v26, v26, s31, v137
    v_mul_f32 v26, s33, v26
    v_mul_f32 v26, s32, v26
    v_exp_f32 v26, v26
    v_add_f32 v25, 1.0, v25
    v_rcp_f32 v25, v25
    v_add_f32 v26, 1.0, v26
    v_rcp_f32 v26, v26
    v_mul_f32 v136, v136, v25
    v_mul_f32 v137, v137, v26
    v_cvt_pk_bf16_f32 v36, v136, v137
    v_cvt_pk_bf16_f32 v24, v138, v139
    v_lshlrev_b32 v138, 16, v24
    v_and_b32 v139, 0xffff0000, v24
    v_add_f32 v138, v138, v18
    v_add_f32 v139, v139, v19
    v_cvt_pk_bf16_f32 v24, v138, v139
    v_lshlrev_b32 v138, 16, v24
    v_and_b32 v139, 0xffff0000, v24
    v_mul_f32 v25, v138, v138
    v_mul_f32 v25, v25, v138
    v_fma_f32 v25, v25, s31, v138
    v_mul_f32 v25, s33, v25
    v_mul_f32 v25, s32, v25
    v_exp_f32 v25, v25
    v_mul_f32 v26, v139, v139
    v_mul_f32 v26, v26, v139
    v_fma_f32 v26, v26, s31, v139
    v_mul_f32 v26, s33, v26
    v_mul_f32 v26, s32, v26
    v_exp_f32 v26, v26
    v_add_f32 v25, 1.0, v25
    v_rcp_f32 v25, v25
    v_add_f32 v26, 1.0, v26
    v_rcp_f32 v26, v26
    v_mul_f32 v138, v138, v25
    v_mul_f32 v139, v139, v26
    v_cvt_pk_bf16_f32 v37, v138, v139
    v_cvt_pk_bf16_f32 v24, v140, v141
    v_lshlrev_b32 v140, 16, v24
    v_and_b32 v141, 0xffff0000, v24
    v_add_f32 v140, v140, v20
    v_add_f32 v141, v141, v21
    v_cvt_pk_bf16_f32 v24, v140, v141
    v_lshlrev_b32 v140, 16, v24
    v_and_b32 v141, 0xffff0000, v24
    v_mul_f32 v25, v140, v140
    v_mul_f32 v25, v25, v140
    v_fma_f32 v25, v25, s31, v140
    v_mul_f32 v25, s33, v25
    v_mul_f32 v25, s32, v25
    v_exp_f32 v25, v25
    v_mul_f32 v26, v141, v141
    v_mul_f32 v26, v26, v141
    v_fma_f32 v26, v26, s31, v141
    v_mul_f32 v26, s33, v26
    v_mul_f32 v26, s32, v26
    v_exp_f32 v26, v26
    v_add_f32 v25, 1.0, v25
    v_rcp_f32 v25, v25
    v_add_f32 v26, 1.0, v26
    v_rcp_f32 v26, v26
    v_mul_f32 v140, v140, v25
    v_mul_f32 v141, v141, v26
    v_cvt_pk_bf16_f32 v38, v140, v141
    v_cvt_pk_bf16_f32 v24, v142, v143
    v_lshlrev_b32 v142, 16, v24
    v_and_b32 v143, 0xffff0000, v24
    v_add_f32 v142, v142, v22
    v_add_f32 v143, v143, v23
    v_cvt_pk_bf16_f32 v24, v142, v143
    v_lshlrev_b32 v142, 16, v24
    v_and_b32 v143, 0xffff0000, v24
    v_mul_f32 v25, v142, v142
    v_mul_f32 v25, v25, v142
    v_fma_f32 v25, v25, s31, v142
    v_mul_f32 v25, s33, v25
    v_mul_f32 v25, s32, v25
    v_exp_f32 v25, v25
    v_mul_f32 v26, v143, v143
    v_mul_f32 v26, v26, v143
    v_fma_f32 v26, v26, s31, v143
    v_mul_f32 v26, s33, v26
    v_mul_f32 v26, s32, v26
    v_exp_f32 v26, v26
    v_add_f32 v25, 1.0, v25
    v_rcp_f32 v25, v25
    v_add_f32 v26, 1.0, v26
    v_rcp_f32 v26, v26
    v_mul_f32 v142, v142, v25
    v_mul_f32 v143, v143, v26
    v_cvt_pk_bf16_f32 v39, v142, v143
    buffer_store_dwordx4 v[36:39], v10, s[12:15], s25 offen
    s_add_u32 s25, s25, 57344
    v_cvt_pk_bf16_f32 v24, v144, v145
    v_lshlrev_b32 v144, 16, v24
    v_and_b32 v145, 0xffff0000, v24
    v_add_f32 v144, v144, v16
    v_add_f32 v145, v145, v17
    v_cvt_pk_bf16_f32 v24, v144, v145
    v_lshlrev_b32 v144, 16, v24
    v_and_b32 v145, 0xffff0000, v24
    v_mul_f32 v25, v144, v144
    v_mul_f32 v25, v25, v144
    v_fma_f32 v25, v25, s31, v144
    v_mul_f32 v25, s33, v25
    v_mul_f32 v25, s32, v25
    v_exp_f32 v25, v25
    v_mul_f32 v26, v145, v145
    v_mul_f32 v26, v26, v145
    v_fma_f32 v26, v26, s31, v145
    v_mul_f32 v26, s33, v26
    v_mul_f32 v26, s32, v26
    v_exp_f32 v26, v26
    v_add_f32 v25, 1.0, v25
    v_rcp_f32 v25, v25
    v_add_f32 v26, 1.0, v26
    v_rcp_f32 v26, v26
    v_mul_f32 v144, v144, v25
    v_mul_f32 v145, v145, v26
    v_cvt_pk_bf16_f32 v40, v144, v145
    v_cvt_pk_bf16_f32 v24, v146, v147
    v_lshlrev_b32 v146, 16, v24
    v_and_b32 v147, 0xffff0000, v24
    v_add_f32 v146, v146, v18
    v_add_f32 v147, v147, v19
    v_cvt_pk_bf16_f32 v24, v146, v147
    v_lshlrev_b32 v146, 16, v24
    v_and_b32 v147, 0xffff0000, v24
    v_mul_f32 v25, v146, v146
    v_mul_f32 v25, v25, v146
    v_fma_f32 v25, v25, s31, v146
    v_mul_f32 v25, s33, v25
    v_mul_f32 v25, s32, v25
    v_exp_f32 v25, v25
    v_mul_f32 v26, v147, v147
    v_mul_f32 v26, v26, v147
    v_fma_f32 v26, v26, s31, v147
    v_mul_f32 v26, s33, v26
    v_mul_f32 v26, s32, v26
    v_exp_f32 v26, v26
    v_add_f32 v25, 1.0, v25
    v_rcp_f32 v25, v25
    v_add_f32 v26, 1.0, v26
    v_rcp_f32 v26, v26
    v_mul_f32 v146, v146, v25
    v_mul_f32 v147, v147, v26
    v_cvt_pk_bf16_f32 v41, v146, v147
    v_cvt_pk_bf16_f32 v24, v148, v149
    v_lshlrev_b32 v148, 16, v24
    v_and_b32 v149, 0xffff0000, v24
    v_add_f32 v148, v148, v20
    v_add_f32 v149, v149, v21
    v_cvt_pk_bf16_f32 v24, v148, v149
    v_lshlrev_b32 v148, 16, v24
    v_and_b32 v149, 0xffff0000, v24
    v_mul_f32 v25, v148, v148
    v_mul_f32 v25, v25, v148
    v_fma_f32 v25, v25, s31, v148
    v_mul_f32 v25, s33, v25
    v_mul_f32 v25, s32, v25
    v_exp_f32 v25, v25
    v_mul_f32 v26, v149, v149
    v_mul_f32 v26, v26, v149
    v_fma_f32 v26, v26, s31, v149
    v_mul_f32 v26, s33, v26
    v_mul_f32 v26, s32, v26
    v_exp_f32 v26, v26
    v_add_f32 v25, 1.0, v25
    v_rcp_f32 v25, v25
    v_add_f32 v26, 1.0, v26
    v_rcp_f32 v26, v26
    v_mul_f32 v148, v148, v25
    v_mul_f32 v149, v149, v26
    v_cvt_pk_bf16_f32 v42, v148, v149
    v_cvt_pk_bf16_f32 v24, v150, v151
    v_lshlrev_b32 v150, 16, v24
    v_and_b32 v151, 0xffff0000, v24
    v_add_f32 v150, v150, v22
    v_add_f32 v151, v151, v23
    v_cvt_pk_bf16_f32 v24, v150, v151
    v_lshlrev_b32 v150, 16, v24
    v_and_b32 v151, 0xffff0000, v24
    v_mul_f32 v25, v150, v150
    v_mul_f32 v25, v25, v150
    v_fma_f32 v25, v25, s31, v150
    v_mul_f32 v25, s33, v25
    v_mul_f32 v25, s32, v25
    v_exp_f32 v25, v25
    v_mul_f32 v26, v151, v151
    v_mul_f32 v26, v26, v151
    v_fma_f32 v26, v26, s31, v151
    v_mul_f32 v26, s33, v26
    v_mul_f32 v26, s32, v26
    v_exp_f32 v26, v26
    v_add_f32 v25, 1.0, v25
    v_rcp_f32 v25, v25
    v_add_f32 v26, 1.0, v26
    v_rcp_f32 v26, v26
    v_mul_f32 v150, v150, v25
    v_mul_f32 v151, v151, v26
    v_cvt_pk_bf16_f32 v43, v150, v151
    buffer_store_dwordx4 v[40:43], v10, s[12:15], s25 offen
    s_add_u32 s25, s25, 57344
    v_cvt_pk_bf16_f32 v24, v152, v153
    v_lshlrev_b32 v152, 16, v24
    v_and_b32 v153, 0xffff0000, v24
    v_add_f32 v152, v152, v16
    v_add_f32 v153, v153, v17
    v_cvt_pk_bf16_f32 v24, v152, v153
    v_lshlrev_b32 v152, 16, v24
    v_and_b32 v153, 0xffff0000, v24
    v_mul_f32 v25, v152, v152
    v_mul_f32 v25, v25, v152
    v_fma_f32 v25, v25, s31, v152
    v_mul_f32 v25, s33, v25
    v_mul_f32 v25, s32, v25
    v_exp_f32 v25, v25
    v_mul_f32 v26, v153, v153
    v_mul_f32 v26, v26, v153
    v_fma_f32 v26, v26, s31, v153
    v_mul_f32 v26, s33, v26
    v_mul_f32 v26, s32, v26
    v_exp_f32 v26, v26
    v_add_f32 v25, 1.0, v25
    v_rcp_f32 v25, v25
    v_add_f32 v26, 1.0, v26
    v_rcp_f32 v26, v26
    v_mul_f32 v152, v152, v25
    v_mul_f32 v153, v153, v26
    v_cvt_pk_bf16_f32 v44, v152, v153
    v_cvt_pk_bf16_f32 v24, v154, v155
    v_lshlrev_b32 v154, 16, v24
    v_and_b32 v155, 0xffff0000, v24
    v_add_f32 v154, v154, v18
    v_add_f32 v155, v155, v19
    v_cvt_pk_bf16_f32 v24, v154, v155
    v_lshlrev_b32 v154, 16, v24
    v_and_b32 v155, 0xffff0000, v24
    v_mul_f32 v25, v154, v154
    v_mul_f32 v25, v25, v154
    v_fma_f32 v25, v25, s31, v154
    v_mul_f32 v25, s33, v25
    v_mul_f32 v25, s32, v25
    v_exp_f32 v25, v25
    v_mul_f32 v26, v155, v155
    v_mul_f32 v26, v26, v155
    v_fma_f32 v26, v26, s31, v155
    v_mul_f32 v26, s33, v26
    v_mul_f32 v26, s32, v26
    v_exp_f32 v26, v26
    v_add_f32 v25, 1.0, v25
    v_rcp_f32 v25, v25
    v_add_f32 v26, 1.0, v26
    v_rcp_f32 v26, v26
    v_mul_f32 v154, v154, v25
    v_mul_f32 v155, v155, v26
    v_cvt_pk_bf16_f32 v45, v154, v155
    v_cvt_pk_bf16_f32 v24, v156, v157
    v_lshlrev_b32 v156, 16, v24
    v_and_b32 v157, 0xffff0000, v24
    v_add_f32 v156, v156, v20
    v_add_f32 v157, v157, v21
    v_cvt_pk_bf16_f32 v24, v156, v157
    v_lshlrev_b32 v156, 16, v24
    v_and_b32 v157, 0xffff0000, v24
    v_mul_f32 v25, v156, v156
    v_mul_f32 v25, v25, v156
    v_fma_f32 v25, v25, s31, v156
    v_mul_f32 v25, s33, v25
    v_mul_f32 v25, s32, v25
    v_exp_f32 v25, v25
    v_mul_f32 v26, v157, v157
    v_mul_f32 v26, v26, v157
    v_fma_f32 v26, v26, s31, v157
    v_mul_f32 v26, s33, v26
    v_mul_f32 v26, s32, v26
    v_exp_f32 v26, v26
    v_add_f32 v25, 1.0, v25
    v_rcp_f32 v25, v25
    v_add_f32 v26, 1.0, v26
    v_rcp_f32 v26, v26
    v_mul_f32 v156, v156, v25
    v_mul_f32 v157, v157, v26
    v_cvt_pk_bf16_f32 v46, v156, v157
    v_cvt_pk_bf16_f32 v24, v158, v159
    v_lshlrev_b32 v158, 16, v24
    v_and_b32 v159, 0xffff0000, v24
    v_add_f32 v158, v158, v22
    v_add_f32 v159, v159, v23
    v_cvt_pk_bf16_f32 v24, v158, v159
    v_lshlrev_b32 v158, 16, v24
    v_and_b32 v159, 0xffff0000, v24
    v_mul_f32 v25, v158, v158
    v_mul_f32 v25, v25, v158
    v_fma_f32 v25, v25, s31, v158
    v_mul_f32 v25, s33, v25
    v_mul_f32 v25, s32, v25
    v_exp_f32 v25, v25
    v_mul_f32 v26, v159, v159
    v_mul_f32 v26, v26, v159
    v_fma_f32 v26, v26, s31, v159
    v_mul_f32 v26, s33, v26
    v_mul_f32 v26, s32, v26
    v_exp_f32 v26, v26
    v_add_f32 v25, 1.0, v25
    v_rcp_f32 v25, v25
    v_add_f32 v26, 1.0, v26
    v_rcp_f32 v26, v26
    v_mul_f32 v158, v158, v25
    v_mul_f32 v159, v159, v26
    v_cvt_pk_bf16_f32 v47, v158, v159
    buffer_store_dwordx4 v[44:47], v10, s[12:15], s25 offen
    s_add_u32 s25, s25, 57344
    v_cvt_pk_bf16_f32 v24, v160, v161
    v_lshlrev_b32 v160, 16, v24
    v_and_b32 v161, 0xffff0000, v24
    v_add_f32 v160, v160, v16
    v_add_f32 v161, v161, v17
    v_cvt_pk_bf16_f32 v24, v160, v161
    v_lshlrev_b32 v160, 16, v24
    v_and_b32 v161, 0xffff0000, v24
    v_mul_f32 v25, v160, v160
    v_mul_f32 v25, v25, v160
    v_fma_f32 v25, v25, s31, v160
    v_mul_f32 v25, s33, v25
    v_mul_f32 v25, s32, v25
    v_exp_f32 v25, v25
    v_mul_f32 v26, v161, v161
    v_mul_f32 v26, v26, v161
    v_fma_f32 v26, v26, s31, v161
    v_mul_f32 v26, s33, v26
    v_mul_f32 v26, s32, v26
    v_exp_f32 v26, v26
    v_add_f32 v25, 1.0, v25
    v_rcp_f32 v25, v25
    v_add_f32 v26, 1.0, v26
    v_rcp_f32 v26, v26
    v_mul_f32 v160, v160, v25
    v_mul_f32 v161, v161, v26
    v_cvt_pk_bf16_f32 v32, v160, v161
    v_cvt_pk_bf16_f32 v24, v162, v163
    v_lshlrev_b32 v162, 16, v24
    v_and_b32 v163, 0xffff0000, v24
    v_add_f32 v162, v162, v18
    v_add_f32 v163, v163, v19
    v_cvt_pk_bf16_f32 v24, v162, v163
    v_lshlrev_b32 v162, 16, v24
    v_and_b32 v163, 0xffff0000, v24
    v_mul_f32 v25, v162, v162
    v_mul_f32 v25, v25, v162
    v_fma_f32 v25, v25, s31, v162
    v_mul_f32 v25, s33, v25
    v_mul_f32 v25, s32, v25
    v_exp_f32 v25, v25
    v_mul_f32 v26, v163, v163
    v_mul_f32 v26, v26, v163
    v_fma_f32 v26, v26, s31, v163
    v_mul_f32 v26, s33, v26
    v_mul_f32 v26, s32, v26
    v_exp_f32 v26, v26
    v_add_f32 v25, 1.0, v25
    v_rcp_f32 v25, v25
    v_add_f32 v26, 1.0, v26
    v_rcp_f32 v26, v26
    v_mul_f32 v162, v162, v25
    v_mul_f32 v163, v163, v26
    v_cvt_pk_bf16_f32 v33, v162, v163
    v_cvt_pk_bf16_f32 v24, v164, v165
    v_lshlrev_b32 v164, 16, v24
    v_and_b32 v165, 0xffff0000, v24
    v_add_f32 v164, v164, v20
    v_add_f32 v165, v165, v21
    v_cvt_pk_bf16_f32 v24, v164, v165
    v_lshlrev_b32 v164, 16, v24
    v_and_b32 v165, 0xffff0000, v24
    v_mul_f32 v25, v164, v164
    v_mul_f32 v25, v25, v164
    v_fma_f32 v25, v25, s31, v164
    v_mul_f32 v25, s33, v25
    v_mul_f32 v25, s32, v25
    v_exp_f32 v25, v25
    v_mul_f32 v26, v165, v165
    v_mul_f32 v26, v26, v165
    v_fma_f32 v26, v26, s31, v165
    v_mul_f32 v26, s33, v26
    v_mul_f32 v26, s32, v26
    v_exp_f32 v26, v26
    v_add_f32 v25, 1.0, v25
    v_rcp_f32 v25, v25
    v_add_f32 v26, 1.0, v26
    v_rcp_f32 v26, v26
    v_mul_f32 v164, v164, v25
    v_mul_f32 v165, v165, v26
    v_cvt_pk_bf16_f32 v34, v164, v165
    v_cvt_pk_bf16_f32 v24, v166, v167
    v_lshlrev_b32 v166, 16, v24
    v_and_b32 v167, 0xffff0000, v24
    v_add_f32 v166, v166, v22
    v_add_f32 v167, v167, v23
    v_cvt_pk_bf16_f32 v24, v166, v167
    v_lshlrev_b32 v166, 16, v24
    v_and_b32 v167, 0xffff0000, v24
    v_mul_f32 v25, v166, v166
    v_mul_f32 v25, v25, v166
    v_fma_f32 v25, v25, s31, v166
    v_mul_f32 v25, s33, v25
    v_mul_f32 v25, s32, v25
    v_exp_f32 v25, v25
    v_mul_f32 v26, v167, v167
    v_mul_f32 v26, v26, v167
    v_fma_f32 v26, v26, s31, v167
    v_mul_f32 v26, s33, v26
    v_mul_f32 v26, s32, v26
    v_exp_f32 v26, v26
    v_add_f32 v25, 1.0, v25
    v_rcp_f32 v25, v25
    v_add_f32 v26, 1.0, v26
    v_rcp_f32 v26, v26
    v_mul_f32 v166, v166, v25
    v_mul_f32 v167, v167, v26
    v_cvt_pk_bf16_f32 v35, v166, v167
    buffer_store_dwordx4 v[32:35], v10, s[12:15], s25 offen
    s_add_u32 s25, s25, 57344
    v_cvt_pk_bf16_f32 v24, v168, v169
    v_lshlrev_b32 v168, 16, v24
    v_and_b32 v169, 0xffff0000, v24
    v_add_f32 v168, v168, v16
    v_add_f32 v169, v169, v17
    v_cvt_pk_bf16_f32 v24, v168, v169
    v_lshlrev_b32 v168, 16, v24
    v_and_b32 v169, 0xffff0000, v24
    v_mul_f32 v25, v168, v168
    v_mul_f32 v25, v25, v168
    v_fma_f32 v25, v25, s31, v168
    v_mul_f32 v25, s33, v25
    v_mul_f32 v25, s32, v25
    v_exp_f32 v25, v25
    v_mul_f32 v26, v169, v169
    v_mul_f32 v26, v26, v169
    v_fma_f32 v26, v26, s31, v169
    v_mul_f32 v26, s33, v26
    v_mul_f32 v26, s32, v26
    v_exp_f32 v26, v26
    v_add_f32 v25, 1.0, v25
    v_rcp_f32 v25, v25
    v_add_f32 v26, 1.0, v26
    v_rcp_f32 v26, v26
    v_mul_f32 v168, v168, v25
    v_mul_f32 v169, v169, v26
    v_cvt_pk_bf16_f32 v36, v168, v169
    v_cvt_pk_bf16_f32 v24, v170, v171
    v_lshlrev_b32 v170, 16, v24
    v_and_b32 v171, 0xffff0000, v24
    v_add_f32 v170, v170, v18
    v_add_f32 v171, v171, v19
    v_cvt_pk_bf16_f32 v24, v170, v171
    v_lshlrev_b32 v170, 16, v24
    v_and_b32 v171, 0xffff0000, v24
    v_mul_f32 v25, v170, v170
    v_mul_f32 v25, v25, v170
    v_fma_f32 v25, v25, s31, v170
    v_mul_f32 v25, s33, v25
    v_mul_f32 v25, s32, v25
    v_exp_f32 v25, v25
    v_mul_f32 v26, v171, v171
    v_mul_f32 v26, v26, v171
    v_fma_f32 v26, v26, s31, v171
    v_mul_f32 v26, s33, v26
    v_mul_f32 v26, s32, v26
    v_exp_f32 v26, v26
    v_add_f32 v25, 1.0, v25
    v_rcp_f32 v25, v25
    v_add_f32 v26, 1.0, v26
    v_rcp_f32 v26, v26
    v_mul_f32 v170, v170, v25
    v_mul_f32 v171, v171, v26
    v_cvt_pk_bf16_f32 v37, v170, v171
    v_cvt_pk_bf16_f32 v24, v172, v173
    v_lshlrev_b32 v172, 16, v24
    v_and_b32 v173, 0xffff0000, v24
    v_add_f32 v172, v172, v20
    v_add_f32 v173, v173, v21
    v_cvt_pk_bf16_f32 v24, v172, v173
    v_lshlrev_b32 v172, 16, v24
    v_and_b32 v173, 0xffff0000, v24
    v_mul_f32 v25, v172, v172
    v_mul_f32 v25, v25, v172
    v_fma_f32 v25, v25, s31, v172
    v_mul_f32 v25, s33, v25
    v_mul_f32 v25, s32, v25
    v_exp_f32 v25, v25
    v_mul_f32 v26, v173, v173
    v_mul_f32 v26, v26, v173
    v_fma_f32 v26, v26, s31, v173
    v_mul_f32 v26, s33, v26
    v_mul_f32 v26, s32, v26
    v_exp_f32 v26, v26
    v_add_f32 v25, 1.0, v25
    v_rcp_f32 v25, v25
    v_add_f32 v26, 1.0, v26
    v_rcp_f32 v26, v26
    v_mul_f32 v172, v172, v25
    v_mul_f32 v173, v173, v26
    v_cvt_pk_bf16_f32 v38, v172, v173
    v_cvt_pk_bf16_f32 v24, v174, v175
    v_lshlrev_b32 v174, 16, v24
    v_and_b32 v175, 0xffff0000, v24
    v_add_f32 v174, v174, v22
    v_add_f32 v175, v175, v23
    v_cvt_pk_bf16_f32 v24, v174, v175
    v_lshlrev_b32 v174, 16, v24
    v_and_b32 v175, 0xffff0000, v24
    v_mul_f32 v25, v174, v174
    v_mul_f32 v25, v25, v174
    v_fma_f32 v25, v25, s31, v174
    v_mul_f32 v25, s33, v25
    v_mul_f32 v25, s32, v25
    v_exp_f32 v25, v25
    v_mul_f32 v26, v175, v175
    v_mul_f32 v26, v26, v175
    v_fma_f32 v26, v26, s31, v175
    v_mul_f32 v26, s33, v26
    v_mul_f32 v26, s32, v26
    v_exp_f32 v26, v26
    v_add_f32 v25, 1.0, v25
    v_rcp_f32 v25, v25
    v_add_f32 v26, 1.0, v26
    v_rcp_f32 v26, v26
    v_mul_f32 v174, v174, v25
    v_mul_f32 v175, v175, v26
    v_cvt_pk_bf16_f32 v39, v174, v175
    buffer_store_dwordx4 v[36:39], v10, s[12:15], s25 offen
    s_add_u32 s25, s25, 57344
    v_cvt_pk_bf16_f32 v24, v176, v177
    v_lshlrev_b32 v176, 16, v24
    v_and_b32 v177, 0xffff0000, v24
    v_add_f32 v176, v176, v16
    v_add_f32 v177, v177, v17
    v_cvt_pk_bf16_f32 v24, v176, v177
    v_lshlrev_b32 v176, 16, v24
    v_and_b32 v177, 0xffff0000, v24
    v_mul_f32 v25, v176, v176
    v_mul_f32 v25, v25, v176
    v_fma_f32 v25, v25, s31, v176
    v_mul_f32 v25, s33, v25
    v_mul_f32 v25, s32, v25
    v_exp_f32 v25, v25
    v_mul_f32 v26, v177, v177
    v_mul_f32 v26, v26, v177
    v_fma_f32 v26, v26, s31, v177
    v_mul_f32 v26, s33, v26
    v_mul_f32 v26, s32, v26
    v_exp_f32 v26, v26
    v_add_f32 v25, 1.0, v25
    v_rcp_f32 v25, v25
    v_add_f32 v26, 1.0, v26
    v_rcp_f32 v26, v26
    v_mul_f32 v176, v176, v25
    v_mul_f32 v177, v177, v26
    v_cvt_pk_bf16_f32 v40, v176, v177
    v_cvt_pk_bf16_f32 v24, v178, v179
    v_lshlrev_b32 v178, 16, v24
    v_and_b32 v179, 0xffff0000, v24
    v_add_f32 v178, v178, v18
    v_add_f32 v179, v179, v19
    v_cvt_pk_bf16_f32 v24, v178, v179
    v_lshlrev_b32 v178, 16, v24
    v_and_b32 v179, 0xffff0000, v24
    v_mul_f32 v25, v178, v178
    v_mul_f32 v25, v25, v178
    v_fma_f32 v25, v25, s31, v178
    v_mul_f32 v25, s33, v25
    v_mul_f32 v25, s32, v25
    v_exp_f32 v25, v25
    v_mul_f32 v26, v179, v179
    v_mul_f32 v26, v26, v179
    v_fma_f32 v26, v26, s31, v179
    v_mul_f32 v26, s33, v26
    v_mul_f32 v26, s32, v26
    v_exp_f32 v26, v26
    v_add_f32 v25, 1.0, v25
    v_rcp_f32 v25, v25
    v_add_f32 v26, 1.0, v26
    v_rcp_f32 v26, v26
    v_mul_f32 v178, v178, v25
    v_mul_f32 v179, v179, v26
    v_cvt_pk_bf16_f32 v41, v178, v179
    v_cvt_pk_bf16_f32 v24, v180, v181
    v_lshlrev_b32 v180, 16, v24
    v_and_b32 v181, 0xffff0000, v24
    v_add_f32 v180, v180, v20
    v_add_f32 v181, v181, v21
    v_cvt_pk_bf16_f32 v24, v180, v181
    v_lshlrev_b32 v180, 16, v24
    v_and_b32 v181, 0xffff0000, v24
    v_mul_f32 v25, v180, v180
    v_mul_f32 v25, v25, v180
    v_fma_f32 v25, v25, s31, v180
    v_mul_f32 v25, s33, v25
    v_mul_f32 v25, s32, v25
    v_exp_f32 v25, v25
    v_mul_f32 v26, v181, v181
    v_mul_f32 v26, v26, v181
    v_fma_f32 v26, v26, s31, v181
    v_mul_f32 v26, s33, v26
    v_mul_f32 v26, s32, v26
    v_exp_f32 v26, v26
    v_add_f32 v25, 1.0, v25
    v_rcp_f32 v25, v25
    v_add_f32 v26, 1.0, v26
    v_rcp_f32 v26, v26
    v_mul_f32 v180, v180, v25
    v_mul_f32 v181, v181, v26
    v_cvt_pk_bf16_f32 v42, v180, v181
    v_cvt_pk_bf16_f32 v24, v182, v183
    v_lshlrev_b32 v182, 16, v24
    v_and_b32 v183, 0xffff0000, v24
    v_add_f32 v182, v182, v22
    v_add_f32 v183, v183, v23
    v_cvt_pk_bf16_f32 v24, v182, v183
    v_lshlrev_b32 v182, 16, v24
    v_and_b32 v183, 0xffff0000, v24
    v_mul_f32 v25, v182, v182
    v_mul_f32 v25, v25, v182
    v_fma_f32 v25, v25, s31, v182
    v_mul_f32 v25, s33, v25
    v_mul_f32 v25, s32, v25
    v_exp_f32 v25, v25
    v_mul_f32 v26, v183, v183
    v_mul_f32 v26, v26, v183
    v_fma_f32 v26, v26, s31, v183
    v_mul_f32 v26, s33, v26
    v_mul_f32 v26, s32, v26
    v_exp_f32 v26, v26
    v_add_f32 v25, 1.0, v25
    v_rcp_f32 v25, v25
    v_add_f32 v26, 1.0, v26
    v_rcp_f32 v26, v26
    v_mul_f32 v182, v182, v25
    v_mul_f32 v183, v183, v26
    v_cvt_pk_bf16_f32 v43, v182, v183
    buffer_store_dwordx4 v[40:43], v10, s[12:15], s25 offen
    s_add_u32 s25, s25, 57344
    v_cvt_pk_bf16_f32 v24, v184, v185
    v_lshlrev_b32 v184, 16, v24
    v_and_b32 v185, 0xffff0000, v24
    v_add_f32 v184, v184, v16
    v_add_f32 v185, v185, v17
    v_cvt_pk_bf16_f32 v24, v184, v185
    v_lshlrev_b32 v184, 16, v24
    v_and_b32 v185, 0xffff0000, v24
    v_mul_f32 v25, v184, v184
    v_mul_f32 v25, v25, v184
    v_fma_f32 v25, v25, s31, v184
    v_mul_f32 v25, s33, v25
    v_mul_f32 v25, s32, v25
    v_exp_f32 v25, v25
    v_mul_f32 v26, v185, v185
    v_mul_f32 v26, v26, v185
    v_fma_f32 v26, v26, s31, v185
    v_mul_f32 v26, s33, v26
    v_mul_f32 v26, s32, v26
    v_exp_f32 v26, v26
    v_add_f32 v25, 1.0, v25
    v_rcp_f32 v25, v25
    v_add_f32 v26, 1.0, v26
    v_rcp_f32 v26, v26
    v_mul_f32 v184, v184, v25
    v_mul_f32 v185, v185, v26
    v_cvt_pk_bf16_f32 v44, v184, v185
    v_cvt_pk_bf16_f32 v24, v186, v187
    v_lshlrev_b32 v186, 16, v24
    v_and_b32 v187, 0xffff0000, v24
    v_add_f32 v186, v186, v18
    v_add_f32 v187, v187, v19
    v_cvt_pk_bf16_f32 v24, v186, v187
    v_lshlrev_b32 v186, 16, v24
    v_and_b32 v187, 0xffff0000, v24
    v_mul_f32 v25, v186, v186
    v_mul_f32 v25, v25, v186
    v_fma_f32 v25, v25, s31, v186
    v_mul_f32 v25, s33, v25
    v_mul_f32 v25, s32, v25
    v_exp_f32 v25, v25
    v_mul_f32 v26, v187, v187
    v_mul_f32 v26, v26, v187
    v_fma_f32 v26, v26, s31, v187
    v_mul_f32 v26, s33, v26
    v_mul_f32 v26, s32, v26
    v_exp_f32 v26, v26
    v_add_f32 v25, 1.0, v25
    v_rcp_f32 v25, v25
    v_add_f32 v26, 1.0, v26
    v_rcp_f32 v26, v26
    v_mul_f32 v186, v186, v25
    v_mul_f32 v187, v187, v26
    v_cvt_pk_bf16_f32 v45, v186, v187
    v_cvt_pk_bf16_f32 v24, v188, v189
    v_lshlrev_b32 v188, 16, v24
    v_and_b32 v189, 0xffff0000, v24
    v_add_f32 v188, v188, v20
    v_add_f32 v189, v189, v21
    v_cvt_pk_bf16_f32 v24, v188, v189
    v_lshlrev_b32 v188, 16, v24
    v_and_b32 v189, 0xffff0000, v24
    v_mul_f32 v25, v188, v188
    v_mul_f32 v25, v25, v188
    v_fma_f32 v25, v25, s31, v188
    v_mul_f32 v25, s33, v25
    v_mul_f32 v25, s32, v25
    v_exp_f32 v25, v25
    v_mul_f32 v26, v189, v189
    v_mul_f32 v26, v26, v189
    v_fma_f32 v26, v26, s31, v189
    v_mul_f32 v26, s33, v26
    v_mul_f32 v26, s32, v26
    v_exp_f32 v26, v26
    v_add_f32 v25, 1.0, v25
    v_rcp_f32 v25, v25
    v_add_f32 v26, 1.0, v26
    v_rcp_f32 v26, v26
    v_mul_f32 v188, v188, v25
    v_mul_f32 v189, v189, v26
    v_cvt_pk_bf16_f32 v46, v188, v189
    v_cvt_pk_bf16_f32 v24, v190, v191
    v_lshlrev_b32 v190, 16, v24
    v_and_b32 v191, 0xffff0000, v24
    v_add_f32 v190, v190, v22
    v_add_f32 v191, v191, v23
    v_cvt_pk_bf16_f32 v24, v190, v191
    v_lshlrev_b32 v190, 16, v24
    v_and_b32 v191, 0xffff0000, v24
    v_mul_f32 v25, v190, v190
    v_mul_f32 v25, v25, v190
    v_fma_f32 v25, v25, s31, v190
    v_mul_f32 v25, s33, v25
    v_mul_f32 v25, s32, v25
    v_exp_f32 v25, v25
    v_mul_f32 v26, v191, v191
    v_mul_f32 v26, v26, v191
    v_fma_f32 v26, v26, s31, v191
    v_mul_f32 v26, s33, v26
    v_mul_f32 v26, s32, v26
    v_exp_f32 v26, v26
    v_add_f32 v25, 1.0, v25
    v_rcp_f32 v25, v25
    v_add_f32 v26, 1.0, v26
    v_rcp_f32 v26, v26
    v_mul_f32 v190, v190, v25
    v_mul_f32 v191, v191, v26
    v_cvt_pk_bf16_f32 v47, v190, v191
    buffer_store_dwordx4 v[44:47], v10, s[12:15], s25 offen
    s_add_u32 s25, s25, 57344
mlp1_end:
    s_endpgm
.globl mlp2_kernel
.p2align 8
.type mlp2_kernel,@function
mlp2_kernel:
    s_cmp_ge_u32 s2, 256
    s_cbranch_scc1 mlp2_kernel_end
    s_load_dwordx2 s[4:5], s[0:1], 128
    s_load_dwordx2 s[8:9], s[0:1], 112
    s_load_dwordx2 s[10:11], s[0:1], 88
    v_lshrrev_b32 v1, 6, v0
    v_and_b32 v2, 63, v0
    s_nop 0
    v_readfirstlane_b32 s3, v1
    s_and_b32 s6, s2, 7
    s_lshl_b32 s6, s6, 2
    s_bfe_u32 s7, s2, 0x20003
    s_add_u32 s6, s6, s7
    s_lshr_b32 s7, s2, 5
    s_waitcnt lgkmcnt(0)
    s_mov_b32 s12, s4
    s_mov_b32 s13, s5
    s_and_b32 s13, s13, 0xffff
    s_mov_b32 s14, 268435455
    s_mov_b32 s15, 0x00020000
    v_and_b32 v3, 15, v2
    v_lshrrev_b32 v4, 4, v2
    v_lshlrev_b32 v6, 4, v2
    v_mov_b32 v7, v6
    s_mul_i32 s21, s6, 229376
    s_mul_i32 s22, s3, 14336
    s_add_u32 s21, s21, s22
    s_add_u32 s24, s21, 142606336
    s_add_u32 s25, s24, 57344
    s_add_u32 s26, s24, 114688
    s_add_u32 s27, s24, 172032
    s_mul_i32 s28, s3, 458752
    s_lshl_b32 s29, s7, 12
    s_add_u32 s28, s28, s29
    s_add_u32 s28, s28, 23068672
    buffer_load_dwordx4 a[0:3], v7, s[12:15], s24 offen
    buffer_load_dwordx4 a[4:7], v7, s[12:15], s25 offen
    buffer_load_dwordx4 a[8:11], v7, s[12:15], s26 offen
    buffer_load_dwordx4 a[12:15], v7, s[12:15], s27 offen
    buffer_load_dwordx4 a[16:19], v6, s[12:15], s28 offen offset:0
    buffer_load_dwordx4 a[20:23], v6, s[12:15], s28 offen offset:1024
    buffer_load_dwordx4 a[24:27], v6, s[12:15], s28 offen offset:2048
    buffer_load_dwordx4 a[28:31], v6, s[12:15], s28 offen offset:3072
    v_add_u32 v7, 1024, v7
    s_add_u32 s28, s28, 32768
    buffer_load_dwordx4 a[32:35], v7, s[12:15], s24 offen
    buffer_load_dwordx4 a[36:39], v7, s[12:15], s25 offen
    buffer_load_dwordx4 a[40:43], v7, s[12:15], s26 offen
    buffer_load_dwordx4 a[44:47], v7, s[12:15], s27 offen
    buffer_load_dwordx4 a[48:51], v6, s[12:15], s28 offen offset:0
    buffer_load_dwordx4 a[52:55], v6, s[12:15], s28 offen offset:1024
    buffer_load_dwordx4 a[56:59], v6, s[12:15], s28 offen offset:2048
    buffer_load_dwordx4 a[60:63], v6, s[12:15], s28 offen offset:3072
    v_add_u32 v7, 1024, v7
    s_add_u32 s28, s28, 32768
    buffer_load_dwordx4 a[64:67], v7, s[12:15], s24 offen
    buffer_load_dwordx4 a[68:71], v7, s[12:15], s25 offen
    buffer_load_dwordx4 a[72:75], v7, s[12:15], s26 offen
    buffer_load_dwordx4 a[76:79], v7, s[12:15], s27 offen
    buffer_load_dwordx4 a[80:83], v6, s[12:15], s28 offen offset:0
    buffer_load_dwordx4 a[84:87], v6, s[12:15], s28 offen offset:1024
    buffer_load_dwordx4 a[88:91], v6, s[12:15], s28 offen offset:2048
    buffer_load_dwordx4 a[92:95], v6, s[12:15], s28 offen offset:3072
    v_add_u32 v7, 1024, v7
    s_add_u32 s28, s28, 32768
    buffer_load_dwordx4 a[96:99], v7, s[12:15], s24 offen
    buffer_load_dwordx4 a[100:103], v7, s[12:15], s25 offen
    buffer_load_dwordx4 a[104:107], v7, s[12:15], s26 offen
    buffer_load_dwordx4 a[108:111], v7, s[12:15], s27 offen
    buffer_load_dwordx4 a[112:115], v6, s[12:15], s28 offen offset:0
    buffer_load_dwordx4 a[116:119], v6, s[12:15], s28 offen offset:1024
    buffer_load_dwordx4 a[120:123], v6, s[12:15], s28 offen offset:2048
    buffer_load_dwordx4 a[124:127], v6, s[12:15], s28 offen offset:3072
    v_add_u32 v7, 1024, v7
    s_add_u32 s28, s28, 32768
    buffer_load_dwordx4 a[128:131], v7, s[12:15], s24 offen
    buffer_load_dwordx4 a[132:135], v7, s[12:15], s25 offen
    buffer_load_dwordx4 a[136:139], v7, s[12:15], s26 offen
    buffer_load_dwordx4 a[140:143], v7, s[12:15], s27 offen
    buffer_load_dwordx4 a[144:147], v6, s[12:15], s28 offen offset:0
    buffer_load_dwordx4 a[148:151], v6, s[12:15], s28 offen offset:1024
    buffer_load_dwordx4 a[152:155], v6, s[12:15], s28 offen offset:2048
    buffer_load_dwordx4 a[156:159], v6, s[12:15], s28 offen offset:3072
    v_add_u32 v7, 1024, v7
    s_add_u32 s28, s28, 32768
    buffer_load_dwordx4 a[160:163], v7, s[12:15], s24 offen
    buffer_load_dwordx4 a[164:167], v7, s[12:15], s25 offen
    buffer_load_dwordx4 a[168:171], v7, s[12:15], s26 offen
    buffer_load_dwordx4 a[172:175], v7, s[12:15], s27 offen
    buffer_load_dwordx4 a[176:179], v6, s[12:15], s28 offen offset:0
    buffer_load_dwordx4 a[180:183], v6, s[12:15], s28 offen offset:1024
    buffer_load_dwordx4 a[184:187], v6, s[12:15], s28 offen offset:2048
    buffer_load_dwordx4 a[188:191], v6, s[12:15], s28 offen offset:3072
    v_add_u32 v7, 1024, v7
    s_add_u32 s28, s28, 32768
    buffer_load_dwordx4 a[192:195], v7, s[12:15], s24 offen
    buffer_load_dwordx4 a[196:199], v7, s[12:15], s25 offen
    buffer_load_dwordx4 a[200:203], v7, s[12:15], s26 offen
    buffer_load_dwordx4 a[204:207], v7, s[12:15], s27 offen
    buffer_load_dwordx4 a[208:211], v6, s[12:15], s28 offen offset:0
    buffer_load_dwordx4 a[212:215], v6, s[12:15], s28 offen offset:1024
    buffer_load_dwordx4 a[216:219], v6, s[12:15], s28 offen offset:2048
    buffer_load_dwordx4 a[220:223], v6, s[12:15], s28 offen offset:3072
    v_add_u32 v7, 1024, v7
    s_add_u32 s28, s28, 32768
    buffer_load_dwordx4 a[224:227], v7, s[12:15], s24 offen
    buffer_load_dwordx4 a[228:231], v7, s[12:15], s25 offen
    buffer_load_dwordx4 a[232:235], v7, s[12:15], s26 offen
    buffer_load_dwordx4 a[236:239], v7, s[12:15], s27 offen
    buffer_load_dwordx4 a[240:243], v6, s[12:15], s28 offen offset:0
    buffer_load_dwordx4 a[244:247], v6, s[12:15], s28 offen offset:1024
    buffer_load_dwordx4 a[248:251], v6, s[12:15], s28 offen offset:2048
    buffer_load_dwordx4 a[252:255], v6, s[12:15], s28 offen offset:3072
    v_add_u32 v7, 1024, v7
    s_add_u32 s28, s28, 32768
    s_waitcnt vmcnt(56)
    v_mfma_f32_16x16x32_bf16 v[128:131], a[16:19], a[0:3], 0
    v_mfma_f32_16x16x32_bf16 v[132:135], a[20:23], a[0:3], 0
    v_mfma_f32_16x16x32_bf16 v[136:139], a[24:27], a[0:3], 0
    v_mfma_f32_16x16x32_bf16 v[140:143], a[28:31], a[0:3], 0
    v_mfma_f32_16x16x32_bf16 v[144:147], a[16:19], a[4:7], 0
    v_mfma_f32_16x16x32_bf16 v[148:151], a[20:23], a[4:7], 0
    v_mfma_f32_16x16x32_bf16 v[152:155], a[24:27], a[4:7], 0
    v_mfma_f32_16x16x32_bf16 v[156:159], a[28:31], a[4:7], 0
    v_mfma_f32_16x16x32_bf16 v[160:163], a[16:19], a[8:11], 0
    v_mfma_f32_16x16x32_bf16 v[164:167], a[20:23], a[8:11], 0
    v_mfma_f32_16x16x32_bf16 v[168:171], a[24:27], a[8:11], 0
    v_mfma_f32_16x16x32_bf16 v[172:175], a[28:31], a[8:11], 0
    v_mfma_f32_16x16x32_bf16 v[176:179], a[16:19], a[12:15], 0
    v_mfma_f32_16x16x32_bf16 v[180:183], a[20:23], a[12:15], 0
    v_mfma_f32_16x16x32_bf16 v[184:187], a[24:27], a[12:15], 0
    v_mfma_f32_16x16x32_bf16 v[188:191], a[28:31], a[12:15], 0
    buffer_load_dwordx4 a[0:3], v7, s[12:15], s24 offen
    buffer_load_dwordx4 a[4:7], v7, s[12:15], s25 offen
    buffer_load_dwordx4 a[8:11], v7, s[12:15], s26 offen
    buffer_load_dwordx4 a[12:15], v7, s[12:15], s27 offen
    buffer_load_dwordx4 a[16:19], v6, s[12:15], s28 offen offset:0
    buffer_load_dwordx4 a[20:23], v6, s[12:15], s28 offen offset:1024
    buffer_load_dwordx4 a[24:27], v6, s[12:15], s28 offen offset:2048
    buffer_load_dwordx4 a[28:31], v6, s[12:15], s28 offen offset:3072
    v_add_u32 v7, 1024, v7
    s_add_u32 s28, s28, 32768
    s_waitcnt vmcnt(56)
    v_mfma_f32_16x16x32_bf16 v[128:131], a[48:51], a[32:35], v[128:131]
    v_mfma_f32_16x16x32_bf16 v[132:135], a[52:55], a[32:35], v[132:135]
    v_mfma_f32_16x16x32_bf16 v[136:139], a[56:59], a[32:35], v[136:139]
    v_mfma_f32_16x16x32_bf16 v[140:143], a[60:63], a[32:35], v[140:143]
    v_mfma_f32_16x16x32_bf16 v[144:147], a[48:51], a[36:39], v[144:147]
    v_mfma_f32_16x16x32_bf16 v[148:151], a[52:55], a[36:39], v[148:151]
    v_mfma_f32_16x16x32_bf16 v[152:155], a[56:59], a[36:39], v[152:155]
    v_mfma_f32_16x16x32_bf16 v[156:159], a[60:63], a[36:39], v[156:159]
    v_mfma_f32_16x16x32_bf16 v[160:163], a[48:51], a[40:43], v[160:163]
    v_mfma_f32_16x16x32_bf16 v[164:167], a[52:55], a[40:43], v[164:167]
    v_mfma_f32_16x16x32_bf16 v[168:171], a[56:59], a[40:43], v[168:171]
    v_mfma_f32_16x16x32_bf16 v[172:175], a[60:63], a[40:43], v[172:175]
    v_mfma_f32_16x16x32_bf16 v[176:179], a[48:51], a[44:47], v[176:179]
    v_mfma_f32_16x16x32_bf16 v[180:183], a[52:55], a[44:47], v[180:183]
    v_mfma_f32_16x16x32_bf16 v[184:187], a[56:59], a[44:47], v[184:187]
    v_mfma_f32_16x16x32_bf16 v[188:191], a[60:63], a[44:47], v[188:191]
    buffer_load_dwordx4 a[32:35], v7, s[12:15], s24 offen
    buffer_load_dwordx4 a[36:39], v7, s[12:15], s25 offen
    buffer_load_dwordx4 a[40:43], v7, s[12:15], s26 offen
    buffer_load_dwordx4 a[44:47], v7, s[12:15], s27 offen
    buffer_load_dwordx4 a[48:51], v6, s[12:15], s28 offen offset:0
    buffer_load_dwordx4 a[52:55], v6, s[12:15], s28 offen offset:1024
    buffer_load_dwordx4 a[56:59], v6, s[12:15], s28 offen offset:2048
    buffer_load_dwordx4 a[60:63], v6, s[12:15], s28 offen offset:3072
    v_add_u32 v7, 1024, v7
    s_add_u32 s28, s28, 32768
    s_waitcnt vmcnt(56)
    v_mfma_f32_16x16x32_bf16 v[128:131], a[80:83], a[64:67], v[128:131]
    v_mfma_f32_16x16x32_bf16 v[132:135], a[84:87], a[64:67], v[132:135]
    v_mfma_f32_16x16x32_bf16 v[136:139], a[88:91], a[64:67], v[136:139]
    v_mfma_f32_16x16x32_bf16 v[140:143], a[92:95], a[64:67], v[140:143]
    v_mfma_f32_16x16x32_bf16 v[144:147], a[80:83], a[68:71], v[144:147]
    v_mfma_f32_16x16x32_bf16 v[148:151], a[84:87], a[68:71], v[148:151]
    v_mfma_f32_16x16x32_bf16 v[152:155], a[88:91], a[68:71], v[152:155]
    v_mfma_f32_16x16x32_bf16 v[156:159], a[92:95], a[68:71], v[156:159]
    v_mfma_f32_16x16x32_bf16 v[160:163], a[80:83], a[72:75], v[160:163]
    v_mfma_f32_16x16x32_bf16 v[164:167], a[84:87], a[72:75], v[164:167]
    v_mfma_f32_16x16x32_bf16 v[168:171], a[88:91], a[72:75], v[168:171]
    v_mfma_f32_16x16x32_bf16 v[172:175], a[92:95], a[72:75], v[172:175]
    v_mfma_f32_16x16x32_bf16 v[176:179], a[80:83], a[76:79], v[176:179]
    v_mfma_f32_16x16x32_bf16 v[180:183], a[84:87], a[76:79], v[180:183]
    v_mfma_f32_16x16x32_bf16 v[184:187], a[88:91], a[76:79], v[184:187]
    v_mfma_f32_16x16x32_bf16 v[188:191], a[92:95], a[76:79], v[188:191]
    buffer_load_dwordx4 a[64:67], v7, s[12:15], s24 offen
    buffer_load_dwordx4 a[68:71], v7, s[12:15], s25 offen
    buffer_load_dwordx4 a[72:75], v7, s[12:15], s26 offen
    buffer_load_dwordx4 a[76:79], v7, s[12:15], s27 offen
    buffer_load_dwordx4 a[80:83], v6, s[12:15], s28 offen offset:0
    buffer_load_dwordx4 a[84:87], v6, s[12:15], s28 offen offset:1024
    buffer_load_dwordx4 a[88:91], v6, s[12:15], s28 offen offset:2048
    buffer_load_dwordx4 a[92:95], v6, s[12:15], s28 offen offset:3072
    v_add_u32 v7, 1024, v7
    s_add_u32 s28, s28, 32768
    s_waitcnt vmcnt(56)
    v_mfma_f32_16x16x32_bf16 v[128:131], a[112:115], a[96:99], v[128:131]
    v_mfma_f32_16x16x32_bf16 v[132:135], a[116:119], a[96:99], v[132:135]
    v_mfma_f32_16x16x32_bf16 v[136:139], a[120:123], a[96:99], v[136:139]
    v_mfma_f32_16x16x32_bf16 v[140:143], a[124:127], a[96:99], v[140:143]
    v_mfma_f32_16x16x32_bf16 v[144:147], a[112:115], a[100:103], v[144:147]
    v_mfma_f32_16x16x32_bf16 v[148:151], a[116:119], a[100:103], v[148:151]
    v_mfma_f32_16x16x32_bf16 v[152:155], a[120:123], a[100:103], v[152:155]
    v_mfma_f32_16x16x32_bf16 v[156:159], a[124:127], a[100:103], v[156:159]
    v_mfma_f32_16x16x32_bf16 v[160:163], a[112:115], a[104:107], v[160:163]
    v_mfma_f32_16x16x32_bf16 v[164:167], a[116:119], a[104:107], v[164:167]
    v_mfma_f32_16x16x32_bf16 v[168:171], a[120:123], a[104:107], v[168:171]
    v_mfma_f32_16x16x32_bf16 v[172:175], a[124:127], a[104:107], v[172:175]
    v_mfma_f32_16x16x32_bf16 v[176:179], a[112:115], a[108:111], v[176:179]
    v_mfma_f32_16x16x32_bf16 v[180:183], a[116:119], a[108:111], v[180:183]
    v_mfma_f32_16x16x32_bf16 v[184:187], a[120:123], a[108:111], v[184:187]
    v_mfma_f32_16x16x32_bf16 v[188:191], a[124:127], a[108:111], v[188:191]
    buffer_load_dwordx4 a[96:99], v7, s[12:15], s24 offen
    buffer_load_dwordx4 a[100:103], v7, s[12:15], s25 offen
    buffer_load_dwordx4 a[104:107], v7, s[12:15], s26 offen
    buffer_load_dwordx4 a[108:111], v7, s[12:15], s27 offen
    buffer_load_dwordx4 a[112:115], v6, s[12:15], s28 offen offset:0
    buffer_load_dwordx4 a[116:119], v6, s[12:15], s28 offen offset:1024
    buffer_load_dwordx4 a[120:123], v6, s[12:15], s28 offen offset:2048
    buffer_load_dwordx4 a[124:127], v6, s[12:15], s28 offen offset:3072
    v_add_u32 v7, 1024, v7
    s_add_u32 s28, s28, 32768
    s_waitcnt vmcnt(56)
    v_mfma_f32_16x16x32_bf16 v[128:131], a[144:147], a[128:131], v[128:131]
    v_mfma_f32_16x16x32_bf16 v[132:135], a[148:151], a[128:131], v[132:135]
    v_mfma_f32_16x16x32_bf16 v[136:139], a[152:155], a[128:131], v[136:139]
    v_mfma_f32_16x16x32_bf16 v[140:143], a[156:159], a[128:131], v[140:143]
    v_mfma_f32_16x16x32_bf16 v[144:147], a[144:147], a[132:135], v[144:147]
    v_mfma_f32_16x16x32_bf16 v[148:151], a[148:151], a[132:135], v[148:151]
    v_mfma_f32_16x16x32_bf16 v[152:155], a[152:155], a[132:135], v[152:155]
    v_mfma_f32_16x16x32_bf16 v[156:159], a[156:159], a[132:135], v[156:159]
    v_mfma_f32_16x16x32_bf16 v[160:163], a[144:147], a[136:139], v[160:163]
    v_mfma_f32_16x16x32_bf16 v[164:167], a[148:151], a[136:139], v[164:167]
    v_mfma_f32_16x16x32_bf16 v[168:171], a[152:155], a[136:139], v[168:171]
    v_mfma_f32_16x16x32_bf16 v[172:175], a[156:159], a[136:139], v[172:175]
    v_mfma_f32_16x16x32_bf16 v[176:179], a[144:147], a[140:143], v[176:179]
    v_mfma_f32_16x16x32_bf16 v[180:183], a[148:151], a[140:143], v[180:183]
    v_mfma_f32_16x16x32_bf16 v[184:187], a[152:155], a[140:143], v[184:187]
    v_mfma_f32_16x16x32_bf16 v[188:191], a[156:159], a[140:143], v[188:191]
    buffer_load_dwordx4 a[128:131], v7, s[12:15], s24 offen
    buffer_load_dwordx4 a[132:135], v7, s[12:15], s25 offen
    buffer_load_dwordx4 a[136:139], v7, s[12:15], s26 offen
    buffer_load_dwordx4 a[140:143], v7, s[12:15], s27 offen
    buffer_load_dwordx4 a[144:147], v6, s[12:15], s28 offen offset:0
    buffer_load_dwordx4 a[148:151], v6, s[12:15], s28 offen offset:1024
    buffer_load_dwordx4 a[152:155], v6, s[12:15], s28 offen offset:2048
    buffer_load_dwordx4 a[156:159], v6, s[12:15], s28 offen offset:3072
    v_add_u32 v7, 1024, v7
    s_add_u32 s28, s28, 32768
    s_waitcnt vmcnt(56)
    v_mfma_f32_16x16x32_bf16 v[128:131], a[176:179], a[160:163], v[128:131]
    v_mfma_f32_16x16x32_bf16 v[132:135], a[180:183], a[160:163], v[132:135]
    v_mfma_f32_16x16x32_bf16 v[136:139], a[184:187], a[160:163], v[136:139]
    v_mfma_f32_16x16x32_bf16 v[140:143], a[188:191], a[160:163], v[140:143]
    v_mfma_f32_16x16x32_bf16 v[144:147], a[176:179], a[164:167], v[144:147]
    v_mfma_f32_16x16x32_bf16 v[148:151], a[180:183], a[164:167], v[148:151]
    v_mfma_f32_16x16x32_bf16 v[152:155], a[184:187], a[164:167], v[152:155]
    v_mfma_f32_16x16x32_bf16 v[156:159], a[188:191], a[164:167], v[156:159]
    v_mfma_f32_16x16x32_bf16 v[160:163], a[176:179], a[168:171], v[160:163]
    v_mfma_f32_16x16x32_bf16 v[164:167], a[180:183], a[168:171], v[164:167]
    v_mfma_f32_16x16x32_bf16 v[168:171], a[184:187], a[168:171], v[168:171]
    v_mfma_f32_16x16x32_bf16 v[172:175], a[188:191], a[168:171], v[172:175]
    v_mfma_f32_16x16x32_bf16 v[176:179], a[176:179], a[172:175], v[176:179]
    v_mfma_f32_16x16x32_bf16 v[180:183], a[180:183], a[172:175], v[180:183]
    v_mfma_f32_16x16x32_bf16 v[184:187], a[184:187], a[172:175], v[184:187]
    v_mfma_f32_16x16x32_bf16 v[188:191], a[188:191], a[172:175], v[188:191]
    buffer_load_dwordx4 a[160:163], v7, s[12:15], s24 offen
    buffer_load_dwordx4 a[164:167], v7, s[12:15], s25 offen
    buffer_load_dwordx4 a[168:171], v7, s[12:15], s26 offen
    buffer_load_dwordx4 a[172:175], v7, s[12:15], s27 offen
    buffer_load_dwordx4 a[176:179], v6, s[12:15], s28 offen offset:0
    buffer_load_dwordx4 a[180:183], v6, s[12:15], s28 offen offset:1024
    buffer_load_dwordx4 a[184:187], v6, s[12:15], s28 offen offset:2048
    buffer_load_dwordx4 a[188:191], v6, s[12:15], s28 offen offset:3072
    v_add_u32 v7, 1024, v7
    s_add_u32 s28, s28, 32768
    s_waitcnt vmcnt(56)
    v_mfma_f32_16x16x32_bf16 v[128:131], a[208:211], a[192:195], v[128:131]
    v_mfma_f32_16x16x32_bf16 v[132:135], a[212:215], a[192:195], v[132:135]
    v_mfma_f32_16x16x32_bf16 v[136:139], a[216:219], a[192:195], v[136:139]
    v_mfma_f32_16x16x32_bf16 v[140:143], a[220:223], a[192:195], v[140:143]
    v_mfma_f32_16x16x32_bf16 v[144:147], a[208:211], a[196:199], v[144:147]
    v_mfma_f32_16x16x32_bf16 v[148:151], a[212:215], a[196:199], v[148:151]
    v_mfma_f32_16x16x32_bf16 v[152:155], a[216:219], a[196:199], v[152:155]
    v_mfma_f32_16x16x32_bf16 v[156:159], a[220:223], a[196:199], v[156:159]
    v_mfma_f32_16x16x32_bf16 v[160:163], a[208:211], a[200:203], v[160:163]
    v_mfma_f32_16x16x32_bf16 v[164:167], a[212:215], a[200:203], v[164:167]
    v_mfma_f32_16x16x32_bf16 v[168:171], a[216:219], a[200:203], v[168:171]
    v_mfma_f32_16x16x32_bf16 v[172:175], a[220:223], a[200:203], v[172:175]
    v_mfma_f32_16x16x32_bf16 v[176:179], a[208:211], a[204:207], v[176:179]
    v_mfma_f32_16x16x32_bf16 v[180:183], a[212:215], a[204:207], v[180:183]
    v_mfma_f32_16x16x32_bf16 v[184:187], a[216:219], a[204:207], v[184:187]
    v_mfma_f32_16x16x32_bf16 v[188:191], a[220:223], a[204:207], v[188:191]
    s_waitcnt vmcnt(48)
    v_mfma_f32_16x16x32_bf16 v[128:131], a[240:243], a[224:227], v[128:131]
    v_mfma_f32_16x16x32_bf16 v[132:135], a[244:247], a[224:227], v[132:135]
    v_mfma_f32_16x16x32_bf16 v[136:139], a[248:251], a[224:227], v[136:139]
    v_mfma_f32_16x16x32_bf16 v[140:143], a[252:255], a[224:227], v[140:143]
    v_mfma_f32_16x16x32_bf16 v[144:147], a[240:243], a[228:231], v[144:147]
    v_mfma_f32_16x16x32_bf16 v[148:151], a[244:247], a[228:231], v[148:151]
    v_mfma_f32_16x16x32_bf16 v[152:155], a[248:251], a[228:231], v[152:155]
    v_mfma_f32_16x16x32_bf16 v[156:159], a[252:255], a[228:231], v[156:159]
    v_mfma_f32_16x16x32_bf16 v[160:163], a[240:243], a[232:235], v[160:163]
    v_mfma_f32_16x16x32_bf16 v[164:167], a[244:247], a[232:235], v[164:167]
    v_mfma_f32_16x16x32_bf16 v[168:171], a[248:251], a[232:235], v[168:171]
    v_mfma_f32_16x16x32_bf16 v[172:175], a[252:255], a[232:235], v[172:175]
    v_mfma_f32_16x16x32_bf16 v[176:179], a[240:243], a[236:239], v[176:179]
    v_mfma_f32_16x16x32_bf16 v[180:183], a[244:247], a[236:239], v[180:183]
    v_mfma_f32_16x16x32_bf16 v[184:187], a[248:251], a[236:239], v[184:187]
    v_mfma_f32_16x16x32_bf16 v[188:191], a[252:255], a[236:239], v[188:191]
    s_waitcnt vmcnt(40)
    v_mfma_f32_16x16x32_bf16 v[128:131], a[16:19], a[0:3], v[128:131]
    v_mfma_f32_16x16x32_bf16 v[132:135], a[20:23], a[0:3], v[132:135]
    v_mfma_f32_16x16x32_bf16 v[136:139], a[24:27], a[0:3], v[136:139]
    v_mfma_f32_16x16x32_bf16 v[140:143], a[28:31], a[0:3], v[140:143]
    v_mfma_f32_16x16x32_bf16 v[144:147], a[16:19], a[4:7], v[144:147]
    v_mfma_f32_16x16x32_bf16 v[148:151], a[20:23], a[4:7], v[148:151]
    v_mfma_f32_16x16x32_bf16 v[152:155], a[24:27], a[4:7], v[152:155]
    v_mfma_f32_16x16x32_bf16 v[156:159], a[28:31], a[4:7], v[156:159]
    v_mfma_f32_16x16x32_bf16 v[160:163], a[16:19], a[8:11], v[160:163]
    v_mfma_f32_16x16x32_bf16 v[164:167], a[20:23], a[8:11], v[164:167]
    v_mfma_f32_16x16x32_bf16 v[168:171], a[24:27], a[8:11], v[168:171]
    v_mfma_f32_16x16x32_bf16 v[172:175], a[28:31], a[8:11], v[172:175]
    v_mfma_f32_16x16x32_bf16 v[176:179], a[16:19], a[12:15], v[176:179]
    v_mfma_f32_16x16x32_bf16 v[180:183], a[20:23], a[12:15], v[180:183]
    v_mfma_f32_16x16x32_bf16 v[184:187], a[24:27], a[12:15], v[184:187]
    v_mfma_f32_16x16x32_bf16 v[188:191], a[28:31], a[12:15], v[188:191]
    s_waitcnt vmcnt(32)
    v_mfma_f32_16x16x32_bf16 v[128:131], a[48:51], a[32:35], v[128:131]
    v_mfma_f32_16x16x32_bf16 v[132:135], a[52:55], a[32:35], v[132:135]
    v_mfma_f32_16x16x32_bf16 v[136:139], a[56:59], a[32:35], v[136:139]
    v_mfma_f32_16x16x32_bf16 v[140:143], a[60:63], a[32:35], v[140:143]
    v_mfma_f32_16x16x32_bf16 v[144:147], a[48:51], a[36:39], v[144:147]
    v_mfma_f32_16x16x32_bf16 v[148:151], a[52:55], a[36:39], v[148:151]
    v_mfma_f32_16x16x32_bf16 v[152:155], a[56:59], a[36:39], v[152:155]
    v_mfma_f32_16x16x32_bf16 v[156:159], a[60:63], a[36:39], v[156:159]
    v_mfma_f32_16x16x32_bf16 v[160:163], a[48:51], a[40:43], v[160:163]
    v_mfma_f32_16x16x32_bf16 v[164:167], a[52:55], a[40:43], v[164:167]
    v_mfma_f32_16x16x32_bf16 v[168:171], a[56:59], a[40:43], v[168:171]
    v_mfma_f32_16x16x32_bf16 v[172:175], a[60:63], a[40:43], v[172:175]
    v_mfma_f32_16x16x32_bf16 v[176:179], a[48:51], a[44:47], v[176:179]
    v_mfma_f32_16x16x32_bf16 v[180:183], a[52:55], a[44:47], v[180:183]
    v_mfma_f32_16x16x32_bf16 v[184:187], a[56:59], a[44:47], v[184:187]
    v_mfma_f32_16x16x32_bf16 v[188:191], a[60:63], a[44:47], v[188:191]
    s_waitcnt vmcnt(24)
    v_mfma_f32_16x16x32_bf16 v[128:131], a[80:83], a[64:67], v[128:131]
    v_mfma_f32_16x16x32_bf16 v[132:135], a[84:87], a[64:67], v[132:135]
    v_mfma_f32_16x16x32_bf16 v[136:139], a[88:91], a[64:67], v[136:139]
    v_mfma_f32_16x16x32_bf16 v[140:143], a[92:95], a[64:67], v[140:143]
    v_mfma_f32_16x16x32_bf16 v[144:147], a[80:83], a[68:71], v[144:147]
    v_mfma_f32_16x16x32_bf16 v[148:151], a[84:87], a[68:71], v[148:151]
    v_mfma_f32_16x16x32_bf16 v[152:155], a[88:91], a[68:71], v[152:155]
    v_mfma_f32_16x16x32_bf16 v[156:159], a[92:95], a[68:71], v[156:159]
    v_mfma_f32_16x16x32_bf16 v[160:163], a[80:83], a[72:75], v[160:163]
    v_mfma_f32_16x16x32_bf16 v[164:167], a[84:87], a[72:75], v[164:167]
    v_mfma_f32_16x16x32_bf16 v[168:171], a[88:91], a[72:75], v[168:171]
    v_mfma_f32_16x16x32_bf16 v[172:175], a[92:95], a[72:75], v[172:175]
    v_mfma_f32_16x16x32_bf16 v[176:179], a[80:83], a[76:79], v[176:179]
    v_mfma_f32_16x16x32_bf16 v[180:183], a[84:87], a[76:79], v[180:183]
    v_mfma_f32_16x16x32_bf16 v[184:187], a[88:91], a[76:79], v[184:187]
    v_mfma_f32_16x16x32_bf16 v[188:191], a[92:95], a[76:79], v[188:191]
    s_waitcnt vmcnt(16)
    v_mfma_f32_16x16x32_bf16 v[128:131], a[112:115], a[96:99], v[128:131]
    v_mfma_f32_16x16x32_bf16 v[132:135], a[116:119], a[96:99], v[132:135]
    v_mfma_f32_16x16x32_bf16 v[136:139], a[120:123], a[96:99], v[136:139]
    v_mfma_f32_16x16x32_bf16 v[140:143], a[124:127], a[96:99], v[140:143]
    v_mfma_f32_16x16x32_bf16 v[144:147], a[112:115], a[100:103], v[144:147]
    v_mfma_f32_16x16x32_bf16 v[148:151], a[116:119], a[100:103], v[148:151]
    v_mfma_f32_16x16x32_bf16 v[152:155], a[120:123], a[100:103], v[152:155]
    v_mfma_f32_16x16x32_bf16 v[156:159], a[124:127], a[100:103], v[156:159]
    v_mfma_f32_16x16x32_bf16 v[160:163], a[112:115], a[104:107], v[160:163]
    v_mfma_f32_16x16x32_bf16 v[164:167], a[116:119], a[104:107], v[164:167]
    v_mfma_f32_16x16x32_bf16 v[168:171], a[120:123], a[104:107], v[168:171]
    v_mfma_f32_16x16x32_bf16 v[172:175], a[124:127], a[104:107], v[172:175]
    v_mfma_f32_16x16x32_bf16 v[176:179], a[112:115], a[108:111], v[176:179]
    v_mfma_f32_16x16x32_bf16 v[180:183], a[116:119], a[108:111], v[180:183]
    v_mfma_f32_16x16x32_bf16 v[184:187], a[120:123], a[108:111], v[184:187]
    v_mfma_f32_16x16x32_bf16 v[188:191], a[124:127], a[108:111], v[188:191]
    s_waitcnt vmcnt(8)
    v_mfma_f32_16x16x32_bf16 v[128:131], a[144:147], a[128:131], v[128:131]
    v_mfma_f32_16x16x32_bf16 v[132:135], a[148:151], a[128:131], v[132:135]
    v_mfma_f32_16x16x32_bf16 v[136:139], a[152:155], a[128:131], v[136:139]
    v_mfma_f32_16x16x32_bf16 v[140:143], a[156:159], a[128:131], v[140:143]
    v_mfma_f32_16x16x32_bf16 v[144:147], a[144:147], a[132:135], v[144:147]
    v_mfma_f32_16x16x32_bf16 v[148:151], a[148:151], a[132:135], v[148:151]
    v_mfma_f32_16x16x32_bf16 v[152:155], a[152:155], a[132:135], v[152:155]
    v_mfma_f32_16x16x32_bf16 v[156:159], a[156:159], a[132:135], v[156:159]
    v_mfma_f32_16x16x32_bf16 v[160:163], a[144:147], a[136:139], v[160:163]
    v_mfma_f32_16x16x32_bf16 v[164:167], a[148:151], a[136:139], v[164:167]
    v_mfma_f32_16x16x32_bf16 v[168:171], a[152:155], a[136:139], v[168:171]
    v_mfma_f32_16x16x32_bf16 v[172:175], a[156:159], a[136:139], v[172:175]
    v_mfma_f32_16x16x32_bf16 v[176:179], a[144:147], a[140:143], v[176:179]
    v_mfma_f32_16x16x32_bf16 v[180:183], a[148:151], a[140:143], v[180:183]
    v_mfma_f32_16x16x32_bf16 v[184:187], a[152:155], a[140:143], v[184:187]
    v_mfma_f32_16x16x32_bf16 v[188:191], a[156:159], a[140:143], v[188:191]
    s_waitcnt vmcnt(0)
    v_mfma_f32_16x16x32_bf16 v[128:131], a[176:179], a[160:163], v[128:131]
    v_mfma_f32_16x16x32_bf16 v[132:135], a[180:183], a[160:163], v[132:135]
    v_mfma_f32_16x16x32_bf16 v[136:139], a[184:187], a[160:163], v[136:139]
    v_mfma_f32_16x16x32_bf16 v[140:143], a[188:191], a[160:163], v[140:143]
    v_mfma_f32_16x16x32_bf16 v[144:147], a[176:179], a[164:167], v[144:147]
    v_mfma_f32_16x16x32_bf16 v[148:151], a[180:183], a[164:167], v[148:151]
    v_mfma_f32_16x16x32_bf16 v[152:155], a[184:187], a[164:167], v[152:155]
    v_mfma_f32_16x16x32_bf16 v[156:159], a[188:191], a[164:167], v[156:159]
    v_mfma_f32_16x16x32_bf16 v[160:163], a[176:179], a[168:171], v[160:163]
    v_mfma_f32_16x16x32_bf16 v[164:167], a[180:183], a[168:171], v[164:167]
    v_mfma_f32_16x16x32_bf16 v[168:171], a[184:187], a[168:171], v[168:171]
    v_mfma_f32_16x16x32_bf16 v[172:175], a[188:191], a[168:171], v[172:175]
    v_mfma_f32_16x16x32_bf16 v[176:179], a[176:179], a[172:175], v[176:179]
    v_mfma_f32_16x16x32_bf16 v[180:183], a[180:183], a[172:175], v[180:183]
    v_mfma_f32_16x16x32_bf16 v[184:187], a[184:187], a[172:175], v[184:187]
    v_mfma_f32_16x16x32_bf16 v[188:191], a[188:191], a[172:175], v[188:191]
    s_nop 7
    s_lshl_b32 s21, s3, 14
    v_add_u32 v8, s21, v6
    ds_write_b128 v8, v[128:131] offset:0
    ds_write_b128 v8, v[132:135] offset:1024
    ds_write_b128 v8, v[136:139] offset:2048
    ds_write_b128 v8, v[140:143] offset:3072
    ds_write_b128 v8, v[144:147] offset:4096
    ds_write_b128 v8, v[148:151] offset:5120
    ds_write_b128 v8, v[152:155] offset:6144
    ds_write_b128 v8, v[156:159] offset:7168
    ds_write_b128 v8, v[160:163] offset:8192
    ds_write_b128 v8, v[164:167] offset:9216
    ds_write_b128 v8, v[168:171] offset:10240
    ds_write_b128 v8, v[172:175] offset:11264
    ds_write_b128 v8, v[176:179] offset:12288
    ds_write_b128 v8, v[180:183] offset:13312
    ds_write_b128 v8, v[184:187] offset:14336
    ds_write_b128 v8, v[188:191] offset:15360
    s_waitcnt vmcnt(0) lgkmcnt(0)
    s_barrier
    s_lshl_b32 s21, s3, 12
    v_add_u32 v8, s21, v6
    ds_read_b128 v[32:35], v8 offset:0
    ds_read_b128 v[36:39], v8 offset:1024
    ds_read_b128 v[40:43], v8 offset:2048
    ds_read_b128 v[44:47], v8 offset:3072
    ds_read_b128 v[48:51], v8 offset:16384
    ds_read_b128 v[52:55], v8 offset:17408
    ds_read_b128 v[56:59], v8 offset:18432
    ds_read_b128 v[60:63], v8 offset:19456
    ds_read_b128 v[64:67], v8 offset:32768
    ds_read_b128 v[68:71], v8 offset:33792
    ds_read_b128 v[72:75], v8 offset:34816
    ds_read_b128 v[76:79], v8 offset:35840
    ds_read_b128 v[80:83], v8 offset:49152
    ds_read_b128 v[84:87], v8 offset:50176
    ds_read_b128 v[88:91], v8 offset:51200
    ds_read_b128 v[92:95], v8 offset:52224
    s_waitcnt lgkmcnt(0)
    v_add_f32 v32, v32, v48
    v_add_f32 v32, v32, v64
    v_add_f32 v32, v32, v80
    v_add_f32 v33, v33, v49
    v_add_f32 v33, v33, v65
    v_add_f32 v33, v33, v81
    v_add_f32 v34, v34, v50
    v_add_f32 v34, v34, v66
    v_add_f32 v34, v34, v82
    v_add_f32 v35, v35, v51
    v_add_f32 v35, v35, v67
    v_add_f32 v35, v35, v83
    v_add_f32 v36, v36, v52
    v_add_f32 v36, v36, v68
    v_add_f32 v36, v36, v84
    v_add_f32 v37, v37, v53
    v_add_f32 v37, v37, v69
    v_add_f32 v37, v37, v85
    v_add_f32 v38, v38, v54
    v_add_f32 v38, v38, v70
    v_add_f32 v38, v38, v86
    v_add_f32 v39, v39, v55
    v_add_f32 v39, v39, v71
    v_add_f32 v39, v39, v87
    v_add_f32 v40, v40, v56
    v_add_f32 v40, v40, v72
    v_add_f32 v40, v40, v88
    v_add_f32 v41, v41, v57
    v_add_f32 v41, v41, v73
    v_add_f32 v41, v41, v89
    v_add_f32 v42, v42, v58
    v_add_f32 v42, v42, v74
    v_add_f32 v42, v42, v90
    v_add_f32 v43, v43, v59
    v_add_f32 v43, v43, v75
    v_add_f32 v43, v43, v91
    v_add_f32 v44, v44, v60
    v_add_f32 v44, v44, v76
    v_add_f32 v44, v44, v92
    v_add_f32 v45, v45, v61
    v_add_f32 v45, v45, v77
    v_add_f32 v45, v45, v93
    v_add_f32 v46, v46, v62
    v_add_f32 v46, v46, v78
    v_add_f32 v46, v46, v94
    v_add_f32 v47, v47, v63
    v_add_f32 v47, v47, v79
    v_add_f32 v47, v47, v95
    s_lshl_b32 s21, s6, 6
    s_lshl_b32 s22, s3, 4
    s_add_u32 s21, s21, s22
    s_lshl_b32 s21, s21, 10
    s_lshl_b32 s22, s7, 7
    s_add_u32 s21, s21, s22
    v_lshlrev_b32 v9, 10, v3
    v_lshl_add_u32 v9, v4, 3, v9
    s_mov_b32 s16, s8
    s_mov_b32 s17, s9
    s_and_b32 s17, s17, 0xffff
    s_mov_b32 s18, 2097152
    s_mov_b32 s19, 0x00020000
    s_mov_b32 s36, s10
    s_mov_b32 s37, s11
    s_and_b32 s37, s37, 0xffff
    s_mov_b32 s38, 1024
    s_mov_b32 s39, 0x00020000
    s_add_u32 s23, s21, 136314880
    v_lshlrev_b32 v10, 3, v4
    v_lshlrev_b32 v11, 4, v4
    s_lshl_b32 s24, s7, 8
    s_add_u32 s24, s24, 10240
    buffer_load_dwordx2 v[48:49], v9, s[12:15], s23 offen offset:0
    buffer_load_dwordx2 v[56:57], v10, s[36:39], s22 offen offset:0
    buffer_load_dwordx4 v[64:67], v11, s[12:15], s24 offen offset:0
    buffer_load_dwordx2 v[50:51], v9, s[12:15], s23 offen offset:32
    buffer_load_dwordx2 v[58:59], v10, s[36:39], s22 offen offset:32
    buffer_load_dwordx4 v[68:71], v11, s[12:15], s24 offen offset:64
    buffer_load_dwordx2 v[52:53], v9, s[12:15], s23 offen offset:64
    buffer_load_dwordx2 v[60:61], v10, s[36:39], s22 offen offset:64
    buffer_load_dwordx4 v[72:75], v11, s[12:15], s24 offen offset:128
    buffer_load_dwordx2 v[54:55], v9, s[12:15], s23 offen offset:96
    buffer_load_dwordx2 v[62:63], v10, s[36:39], s22 offen offset:96
    buffer_load_dwordx4 v[76:79], v11, s[12:15], s24 offen offset:192
    s_waitcnt vmcnt(0)
    v_cvt_pk_bf16_f32 v12, v32, v33
    v_lshlrev_b32 v32, 16, v12
    v_and_b32 v33, 0xffff0000, v12
    v_lshlrev_b32 v13, 16, v56
    v_and_b32 v14, 0xffff0000, v56
    v_add_f32 v32, v32, v13
    v_add_f32 v33, v33, v14
    v_cvt_pk_bf16_f32 v12, v32, v33
    v_lshlrev_b32 v32, 16, v12
    v_and_b32 v33, 0xffff0000, v12
    v_mul_f32 v32, v32, v64
    v_mul_f32 v33, v33, v65
    v_cvt_pk_bf16_f32 v12, v32, v33
    v_lshlrev_b32 v32, 16, v12
    v_and_b32 v33, 0xffff0000, v12
    v_lshlrev_b32 v13, 16, v48
    v_and_b32 v14, 0xffff0000, v48
    v_add_f32 v32, v32, v13
    v_add_f32 v33, v33, v14
    v_cvt_pk_bf16_f32 v80, v32, v33
    v_cvt_pk_bf16_f32 v12, v34, v35
    v_lshlrev_b32 v34, 16, v12
    v_and_b32 v35, 0xffff0000, v12
    v_lshlrev_b32 v13, 16, v57
    v_and_b32 v14, 0xffff0000, v57
    v_add_f32 v34, v34, v13
    v_add_f32 v35, v35, v14
    v_cvt_pk_bf16_f32 v12, v34, v35
    v_lshlrev_b32 v34, 16, v12
    v_and_b32 v35, 0xffff0000, v12
    v_mul_f32 v34, v34, v66
    v_mul_f32 v35, v35, v67
    v_cvt_pk_bf16_f32 v12, v34, v35
    v_lshlrev_b32 v34, 16, v12
    v_and_b32 v35, 0xffff0000, v12
    v_lshlrev_b32 v13, 16, v49
    v_and_b32 v14, 0xffff0000, v49
    v_add_f32 v34, v34, v13
    v_add_f32 v35, v35, v14
    v_cvt_pk_bf16_f32 v81, v34, v35
    buffer_store_dwordx2 v[80:81], v9, s[16:19], s21 offen offset:0
    v_cvt_pk_bf16_f32 v12, v36, v37
    v_lshlrev_b32 v36, 16, v12
    v_and_b32 v37, 0xffff0000, v12
    v_lshlrev_b32 v13, 16, v58
    v_and_b32 v14, 0xffff0000, v58
    v_add_f32 v36, v36, v13
    v_add_f32 v37, v37, v14
    v_cvt_pk_bf16_f32 v12, v36, v37
    v_lshlrev_b32 v36, 16, v12
    v_and_b32 v37, 0xffff0000, v12
    v_mul_f32 v36, v36, v68
    v_mul_f32 v37, v37, v69
    v_cvt_pk_bf16_f32 v12, v36, v37
    v_lshlrev_b32 v36, 16, v12
    v_and_b32 v37, 0xffff0000, v12
    v_lshlrev_b32 v13, 16, v50
    v_and_b32 v14, 0xffff0000, v50
    v_add_f32 v36, v36, v13
    v_add_f32 v37, v37, v14
    v_cvt_pk_bf16_f32 v82, v36, v37
    v_cvt_pk_bf16_f32 v12, v38, v39
    v_lshlrev_b32 v38, 16, v12
    v_and_b32 v39, 0xffff0000, v12
    v_lshlrev_b32 v13, 16, v59
    v_and_b32 v14, 0xffff0000, v59
    v_add_f32 v38, v38, v13
    v_add_f32 v39, v39, v14
    v_cvt_pk_bf16_f32 v12, v38, v39
    v_lshlrev_b32 v38, 16, v12
    v_and_b32 v39, 0xffff0000, v12
    v_mul_f32 v38, v38, v70
    v_mul_f32 v39, v39, v71
    v_cvt_pk_bf16_f32 v12, v38, v39
    v_lshlrev_b32 v38, 16, v12
    v_and_b32 v39, 0xffff0000, v12
    v_lshlrev_b32 v13, 16, v51
    v_and_b32 v14, 0xffff0000, v51
    v_add_f32 v38, v38, v13
    v_add_f32 v39, v39, v14
    v_cvt_pk_bf16_f32 v83, v38, v39
    buffer_store_dwordx2 v[82:83], v9, s[16:19], s21 offen offset:32
    v_cvt_pk_bf16_f32 v12, v40, v41
    v_lshlrev_b32 v40, 16, v12
    v_and_b32 v41, 0xffff0000, v12
    v_lshlrev_b32 v13, 16, v60
    v_and_b32 v14, 0xffff0000, v60
    v_add_f32 v40, v40, v13
    v_add_f32 v41, v41, v14
    v_cvt_pk_bf16_f32 v12, v40, v41
    v_lshlrev_b32 v40, 16, v12
    v_and_b32 v41, 0xffff0000, v12
    v_mul_f32 v40, v40, v72
    v_mul_f32 v41, v41, v73
    v_cvt_pk_bf16_f32 v12, v40, v41
    v_lshlrev_b32 v40, 16, v12
    v_and_b32 v41, 0xffff0000, v12
    v_lshlrev_b32 v13, 16, v52
    v_and_b32 v14, 0xffff0000, v52
    v_add_f32 v40, v40, v13
    v_add_f32 v41, v41, v14
    v_cvt_pk_bf16_f32 v84, v40, v41
    v_cvt_pk_bf16_f32 v12, v42, v43
    v_lshlrev_b32 v42, 16, v12
    v_and_b32 v43, 0xffff0000, v12
    v_lshlrev_b32 v13, 16, v61
    v_and_b32 v14, 0xffff0000, v61
    v_add_f32 v42, v42, v13
    v_add_f32 v43, v43, v14
    v_cvt_pk_bf16_f32 v12, v42, v43
    v_lshlrev_b32 v42, 16, v12
    v_and_b32 v43, 0xffff0000, v12
    v_mul_f32 v42, v42, v74
    v_mul_f32 v43, v43, v75
    v_cvt_pk_bf16_f32 v12, v42, v43
    v_lshlrev_b32 v42, 16, v12
    v_and_b32 v43, 0xffff0000, v12
    v_lshlrev_b32 v13, 16, v53
    v_and_b32 v14, 0xffff0000, v53
    v_add_f32 v42, v42, v13
    v_add_f32 v43, v43, v14
    v_cvt_pk_bf16_f32 v85, v42, v43
    buffer_store_dwordx2 v[84:85], v9, s[16:19], s21 offen offset:64
    v_cvt_pk_bf16_f32 v12, v44, v45
    v_lshlrev_b32 v44, 16, v12
    v_and_b32 v45, 0xffff0000, v12
    v_lshlrev_b32 v13, 16, v62
    v_and_b32 v14, 0xffff0000, v62
    v_add_f32 v44, v44, v13
    v_add_f32 v45, v45, v14
    v_cvt_pk_bf16_f32 v12, v44, v45
    v_lshlrev_b32 v44, 16, v12
    v_and_b32 v45, 0xffff0000, v12
    v_mul_f32 v44, v44, v76
    v_mul_f32 v45, v45, v77
    v_cvt_pk_bf16_f32 v12, v44, v45
    v_lshlrev_b32 v44, 16, v12
    v_and_b32 v45, 0xffff0000, v12
    v_lshlrev_b32 v13, 16, v54
    v_and_b32 v14, 0xffff0000, v54
    v_add_f32 v44, v44, v13
    v_add_f32 v45, v45, v14
    v_cvt_pk_bf16_f32 v86, v44, v45
    v_cvt_pk_bf16_f32 v12, v46, v47
    v_lshlrev_b32 v46, 16, v12
    v_and_b32 v47, 0xffff0000, v12
    v_lshlrev_b32 v13, 16, v63
    v_and_b32 v14, 0xffff0000, v63
    v_add_f32 v46, v46, v13
    v_add_f32 v47, v47, v14
    v_cvt_pk_bf16_f32 v12, v46, v47
    v_lshlrev_b32 v46, 16, v12
    v_and_b32 v47, 0xffff0000, v12
    v_mul_f32 v46, v46, v78
    v_mul_f32 v47, v47, v79
    v_cvt_pk_bf16_f32 v12, v46, v47
    v_lshlrev_b32 v46, 16, v12
    v_and_b32 v47, 0xffff0000, v12
    v_lshlrev_b32 v13, 16, v55
    v_and_b32 v14, 0xffff0000, v55
    v_add_f32 v46, v46, v13
    v_add_f32 v47, v47, v14
    v_cvt_pk_bf16_f32 v87, v46, v47
    buffer_store_dwordx2 v[86:87], v9, s[16:19], s21 offen offset:96
mlp2_kernel_end:
    s_endpgm
.section .rodata,"a"
.p2align 6
.amdhsa_kernel prep_kernel
  .amdhsa_next_free_vgpr 144
  .amdhsa_next_free_sgpr 102
  .amdhsa_accum_offset 144
  .amdhsa_group_segment_fixed_size 0
  .amdhsa_kernarg_size 136
  .amdhsa_user_sgpr_count 2
  .amdhsa_user_sgpr_kernarg_segment_ptr 1
  .amdhsa_system_sgpr_workgroup_id_x 1
.end_amdhsa_kernel
.p2align 6
.amdhsa_kernel ln1_kernel
  .amdhsa_next_free_vgpr 96
  .amdhsa_next_free_sgpr 102
  .amdhsa_accum_offset 96
  .amdhsa_group_segment_fixed_size 0
  .amdhsa_kernarg_size 136
  .amdhsa_user_sgpr_count 2
  .amdhsa_user_sgpr_kernarg_segment_ptr 1
  .amdhsa_system_sgpr_workgroup_id_x 1
.end_amdhsa_kernel
.p2align 6
.amdhsa_kernel main_kernel
  .amdhsa_next_free_vgpr 512
  .amdhsa_next_free_sgpr 102
  .amdhsa_accum_offset 256
  .amdhsa_group_segment_fixed_size 0
  .amdhsa_kernarg_size 136
  .amdhsa_user_sgpr_count 2
  .amdhsa_user_sgpr_kernarg_segment_ptr 1
  .amdhsa_system_sgpr_workgroup_id_x 1
.end_amdhsa_kernel
.p2align 6
.amdhsa_kernel oproj_kernel
  .amdhsa_next_free_vgpr 448
  .amdhsa_next_free_sgpr 102
  .amdhsa_accum_offset 192
  .amdhsa_group_segment_fixed_size 0
  .amdhsa_kernarg_size 136
  .amdhsa_user_sgpr_count 2
  .amdhsa_user_sgpr_kernarg_segment_ptr 1
  .amdhsa_system_sgpr_workgroup_id_x 1
.end_amdhsa_kernel
.p2align 6
.amdhsa_kernel ln2_kernel
  .amdhsa_next_free_vgpr 128
  .amdhsa_next_free_sgpr 102
  .amdhsa_accum_offset 128
  .amdhsa_group_segment_fixed_size 0
  .amdhsa_kernarg_size 136
  .amdhsa_user_sgpr_count 2
  .amdhsa_user_sgpr_kernarg_segment_ptr 1
  .amdhsa_system_sgpr_workgroup_id_x 1
.end_amdhsa_kernel
.p2align 6
.amdhsa_kernel mlp1_kernel
  .amdhsa_next_free_vgpr 320
  .amdhsa_next_free_sgpr 102
  .amdhsa_accum_offset 192
  .amdhsa_group_segment_fixed_size 0
  .amdhsa_kernarg_size 136
  .amdhsa_user_sgpr_count 2
  .amdhsa_user_sgpr_kernarg_segment_ptr 1
  .amdhsa_system_sgpr_workgroup_id_x 1
.end_amdhsa_kernel
.p2align 6
.amdhsa_kernel mlp2_kernel
  .amdhsa_next_free_vgpr 448
  .amdhsa_next_free_sgpr 102
  .amdhsa_accum_offset 192
  .amdhsa_group_segment_fixed_size 0
  .amdhsa_kernarg_size 136
  .amdhsa_user_sgpr_count 2
  .amdhsa_user_sgpr_kernarg_segment_ptr 1
  .amdhsa_system_sgpr_workgroup_id_x 1
.end_amdhsa_kernel
```
